```python
import torch

def _softmax(x, axis=-1):
    return torch.softmax(x, dim=axis)
def _gelu(x):
    return torch.nn.functional.gelu(x, approximate="tanh")
def _silu(x):
    return torch.nn.functional.silu(x)
def _sigmoid(x):
    return torch.sigmoid(x)
def _layernorm(x, axis=-1, eps=1e-5):
    m = x.mean(dim=axis, keepdim=True)
    v = x.var(dim=axis, keepdim=True, unbiased=False)
    return (x - m) / torch.sqrt(v + eps)
def _scatter_add(tgt, idx, src, axis=0):
    return tgt.clone().index_add_(axis, idx, src)
def _segment_sum(src, seg, n):
    out = torch.zeros((n,) + src.shape[1:], dtype=src.dtype)
    return out.index_add_(0, seg, src)
def _pad(x, pw):
    flat = tuple(v for pair in reversed(pw) for v in pair)
    return torch.nn.functional.pad(x, flat)

kernel_name = 'gated_mix__linear_kernel_hedgehog__mixer_s_mlp__prompt'

def setup_inputs():

    _w = (lambda a: (lambda t: t.to(torch.bfloat16) if t.is_floating_point() else t)(torch.as_tensor(a)))
    def _A_setup():
        B, S, D, H = 1, 2048, 1024, 32
        Dh = D // H
        return {
            "x": _w((lambda *s: torch.randn(*s, dtype=torch.bfloat16) * 0.05)(B, S, D)),
            "wqkv": _w((lambda *s: torch.randn(*s, dtype=torch.bfloat16) * 1.6)(D, 3 * D)),
            "w_phi": _w((lambda *s: torch.randn(*s, dtype=torch.bfloat16) * 1.6)(H, Dh, Dh) * (Dh ** -0.5)),
            "wo": _w((lambda *s: torch.randn(*s, dtype=torch.bfloat16) * 0.8)(D, D)),
        }
    _A_in = _A_setup()

    def _B_setup():
        B, S, D, F = 1, 2048, 1024, 3584
        return {
            "x":  _w((lambda *s: torch.randn(*s, dtype=torch.bfloat16) * 0.05)(B, S, D)),
            "w1": _w((lambda *s: torch.randn(*s, dtype=torch.bfloat16) * 3.2)(D, D) * (D ** -0.5)),
            "w2": _w((lambda *s: torch.randn(*s, dtype=torch.bfloat16) * 3.2)(D, D) * (D ** -0.5)),
            "w3": _w((lambda *s: torch.randn(*s, dtype=torch.bfloat16) * 3.2)(D, F) * (D ** -0.5)),
            "w4": _w((lambda *s: torch.randn(*s, dtype=torch.bfloat16) * 1.6)(F, D) * (F ** -0.5)),
        }
    _B_in = _B_setup()

    return {
        "A_x": _A_in["x"],
        "A_wqkv": _A_in["wqkv"],
        "A_w_phi": _A_in["w_phi"],
        "A_wo": _A_in["wo"],
        "B_x": _B_in["x"],
        "B_w1": _B_in["w1"],
        "B_w2": _B_in["w2"],
        "B_w3": _B_in["w3"],
        "B_w4": _B_in["w4"],
        "gate_w": _w((lambda *s: torch.randn(*s, dtype=torch.bfloat16) * 0.05)(1024) * 16.0),
    }

def reference(A_x, A_wqkv, A_w_phi, A_wo, B_x, B_w1, B_w2, B_w3, B_w4, gate_w):
    def _A_ref(x, wqkv, w_phi, wo):
        B, S, D = x.shape
        H = 32; Dh = D // H
        qkv = (lambda x, *d: x.permute(*d))((x @ wqkv).reshape(B, S, 3, H, Dh), 2, 0, 3, 1, 4)
        q, k, v = qkv[0], qkv[1], qkv[2]
        pq = torch.einsum("bhsd,hdf->bhsf", q, w_phi)
        pk = torch.einsum("bhsd,hdf->bhsf", k, w_phi)
        phi_q = torch.concatenate([_softmax(pq, axis=-1), _softmax(-pq, axis=-1)], axis=-1)
        phi_k = torch.concatenate([_softmax(pk, axis=-1), _softmax(-pk, axis=-1)], axis=-1)
        kv = torch.einsum("bhsf,bhsd->bhfd", phi_k, v)
        z  = torch.einsum("bhsf->bhf", phi_k)
        num = torch.einsum("bhqf,bhfd->bhqd", phi_q, kv)
        den = torch.einsum("bhqf,bhf->bhq", phi_q, z)[..., None] + 1e-6
        o = num / den
        return (lambda x, *d: x.permute(*d))(o, 0, 2, 1, 3).reshape(B, S, D) @ wo

    def _B_ref(x, w1, w2, w3, w4):
        B, S, D = x.shape
        h = _gelu(_layernorm(x, axis=-1) @ w1)
        c = D // 4
        g0 = _pad(h[:, :, 0*c:1*c], ((0, 0), (1, 0), (0, 0)))[:, :S, :]
        g1 = _pad(h[:, :, 1*c:2*c], ((0, 0), (0, 1), (0, 0)))[:, 1:, :]
        g2 = _pad(h[:, :, 2*c:3*c], ((0, 0), (2, 0), (0, 0)))[:, :S, :]
        g3 = _pad(h[:, :, 3*c:   ], ((0, 0), (0, 2), (0, 0)))[:, 2:, :]
        hs = torch.concatenate([g0, g1, g2, g3], axis=-1) @ w2
        x1 = x + hs
        h2 = _gelu(_layernorm(x1, axis=-1) @ w3) @ w4
        return x1 + h2

    x = A_x
    g = _sigmoid((x * gate_w).sum(-1, keepdims=True))
    a = _A_ref(x, A_wqkv, A_w_phi, A_wo)
    b = _B_ref(x, B_w1, B_w2, B_w3, B_w4)
    return g * a + (1 - g) * b
```

```asm
; @launch kernel=l0_kernel grid=(512,1,1) block=(512,1,1) lds=0
; @launch kernel=l1_kernel grid=(256,1,1) block=(768,1,1) lds=147456
; @launch kernel=l2_kernel grid=(252,1,1) block=(768,1,1) lds=147456
; @launch kernel=l3_kernel grid=(256,1,1) block=(768,1,1) lds=147456
; @launch kernel=l4_kernel grid=(256,1,1) block=(768,1,1) lds=147456
.amdgcn_target "amdgcn-amd-amdhsa--gfx950"
.text
.globl l0_kernel
.p2align 8
.type l0_kernel,@function
l0_kernel:
    s_cmp_ge_u32 s2, 512
    s_cbranch_scc1 l0_kernel_end_1
    s_load_dwordx2 s[40:41], s[0:1], 96
    v_and_b32 v1, 63, v0
    v_lshrrev_b32 v2, 6, v0
    s_nop 0
    v_readfirstlane_b32 s24, v2
    v_lshlrev_b32 v3, 4, v1
    s_load_dwordx2 s[60:61], s[0:1], 48
    s_waitcnt lgkmcnt(0)
    s_mov_b32 s48, s60
    s_mov_b32 s49, s61
    s_and_b32 s49, s49, 0xffff
    s_mov_b32 s50, 2097152
    s_mov_b32 s51, 0x00020000
    s_lshl_b32 s30, s24, 9
    s_lshl_b32 s36, s2, 12
    s_add_u32 s30, s30, s36
    v_lshlrev_b32 v50, 3, v1
    buffer_load_dwordx2 v[52:53], v50, s[48:51], s30 offen
    s_cmp_ge_u32 s2, 256
    s_cbranch_scc1 l0_kernel_gate_2
    s_load_dwordx2 s[4:5], s[0:1], 0
    s_waitcnt lgkmcnt(0)
    s_mov_b32 s8, s4
    s_mov_b32 s9, s5
    s_and_b32 s9, s9, 0xffff
    s_mov_b32 s10, 4194304
    s_mov_b32 s11, 0x00020000
    s_mov_b32 s16, s40
    s_mov_b32 s17, s41
    s_and_b32 s17, s17, 0xffff
    s_mov_b32 s18, 4194304
    s_mov_b32 s19, 0x00020000
    s_cmp_ge_u32 s2, 4
    s_cbranch_scc1 l0_kernel_ng_3
    s_cmp_lg_u32 s24, 0
    s_cbranch_scc1 l0_kernel_ng_3
    s_add_u32 s20, s40, 16777216
    s_addc_u32 s21, s41, 0
    s_and_b32 s21, s21, 0xffff
    s_mov_b32 s22, 4202496
    s_mov_b32 s23, 0x00020000
    s_lshl_b32 s29, s2, 11
    s_cmp_ge_u32 s2, 2
    s_cselect_b32 s30, 4194304, 0
    s_add_u32 s29, s29, s30
    v_mov_b32 v40, 0
    v_mov_b32 v41, 0
    v_mov_b32 v42, 0
    v_mov_b32 v43, 0
    buffer_store_dwordx4 v[40:43], v3, s[20:23], s29 offen
    buffer_store_dwordx4 v[40:43], v3, s[20:23], s29 offen offset:1024
l0_kernel_ng_3:
    s_cmp_lg_u32 s2, 4
    s_cbranch_scc1 l0_kernel_nf_4
    s_add_u32 s20, s40, 53477376
    s_addc_u32 s21, s41, 0
    s_and_b32 s21, s21, 0xffff
    s_mov_b32 s22, 16384
    s_mov_b32 s23, 0x00020000
    s_lshl_b32 s29, s24, 11
    v_mov_b32 v40, 0
    v_mov_b32 v41, 0
    v_mov_b32 v42, 0
    v_mov_b32 v43, 0
    buffer_store_dwordx4 v[40:43], v3, s[20:23], s29 offen
    buffer_store_dwordx4 v[40:43], v3, s[20:23], s29 offen offset:1024
l0_kernel_nf_4:
    s_lshl_b32 s29, s2, 3
    s_add_u32 s29, s29, s24
    s_lshl_b32 s29, s29, 11
    buffer_load_dwordx4 v[4:7], v3, s[8:11], s29 offen
    buffer_load_dwordx4 v[8:11], v3, s[8:11], s29 offen offset:1024
    s_waitcnt vmcnt(0)
    v_lshlrev_b32 v16, 16, v4
    v_and_b32 v17, 0xffff0000, v4
    v_lshlrev_b32 v18, 16, v5
    v_and_b32 v19, 0xffff0000, v5
    v_lshlrev_b32 v20, 16, v6
    v_and_b32 v21, 0xffff0000, v6
    v_lshlrev_b32 v22, 16, v7
    v_and_b32 v23, 0xffff0000, v7
    v_lshlrev_b32 v24, 16, v8
    v_and_b32 v25, 0xffff0000, v8
    v_lshlrev_b32 v26, 16, v9
    v_and_b32 v27, 0xffff0000, v9
    v_lshlrev_b32 v28, 16, v10
    v_and_b32 v29, 0xffff0000, v10
    v_lshlrev_b32 v30, 16, v11
    v_and_b32 v31, 0xffff0000, v11
    v_add_f32 v32, v16, v17
    v_add_f32 v32, v32, v18
    v_add_f32 v32, v32, v19
    v_add_f32 v32, v32, v20
    v_add_f32 v32, v32, v21
    v_add_f32 v32, v32, v22
    v_add_f32 v32, v32, v23
    v_add_f32 v32, v32, v24
    v_add_f32 v32, v32, v25
    v_add_f32 v32, v32, v26
    v_add_f32 v32, v32, v27
    v_add_f32 v32, v32, v28
    v_add_f32 v32, v32, v29
    v_add_f32 v32, v32, v30
    v_add_f32 v32, v32, v31
    s_nop 1
    v_mov_b32_dpp v33, v32 quad_perm:[1,0,3,2] row_mask:0xf bank_mask:0xf
    v_add_f32 v32, v32, v33
    s_nop 1
    v_mov_b32_dpp v33, v32 quad_perm:[2,3,0,1] row_mask:0xf bank_mask:0xf
    v_add_f32 v32, v32, v33
    s_nop 1
    v_mov_b32_dpp v33, v32 row_half_mirror row_mask:0xf bank_mask:0xf
    v_add_f32 v32, v32, v33
    s_nop 1
    v_mov_b32_dpp v33, v32 row_mirror row_mask:0xf bank_mask:0xf
    v_add_f32 v32, v32, v33
    v_mov_b32 v33, v32
    s_nop 1
    v_permlane16_swap_b32 v32, v33
    v_add_f32 v32, v32, v33
    v_mov_b32 v33, v32
    s_nop 1
    v_permlane32_swap_b32 v32, v33
    v_add_f32 v32, v32, v33
    v_mul_f32 v32, 0x3a800000, v32
    v_sub_f32 v34, v16, v32
    v_mul_f32 v35, v34, v34
    v_sub_f32 v34, v17, v32
    v_fmac_f32 v35, v34, v34
    v_sub_f32 v34, v18, v32
    v_fmac_f32 v35, v34, v34
    v_sub_f32 v34, v19, v32
    v_fmac_f32 v35, v34, v34
    v_sub_f32 v34, v20, v32
    v_fmac_f32 v35, v34, v34
    v_sub_f32 v34, v21, v32
    v_fmac_f32 v35, v34, v34
    v_sub_f32 v34, v22, v32
    v_fmac_f32 v35, v34, v34
    v_sub_f32 v34, v23, v32
    v_fmac_f32 v35, v34, v34
    v_sub_f32 v34, v24, v32
    v_fmac_f32 v35, v34, v34
    v_sub_f32 v34, v25, v32
    v_fmac_f32 v35, v34, v34
    v_sub_f32 v34, v26, v32
    v_fmac_f32 v35, v34, v34
    v_sub_f32 v34, v27, v32
    v_fmac_f32 v35, v34, v34
    v_sub_f32 v34, v28, v32
    v_fmac_f32 v35, v34, v34
    v_sub_f32 v34, v29, v32
    v_fmac_f32 v35, v34, v34
    v_sub_f32 v34, v30, v32
    v_fmac_f32 v35, v34, v34
    v_sub_f32 v34, v31, v32
    v_fmac_f32 v35, v34, v34
    s_nop 1
    v_mov_b32_dpp v33, v35 quad_perm:[1,0,3,2] row_mask:0xf bank_mask:0xf
    v_add_f32 v35, v35, v33
    s_nop 1
    v_mov_b32_dpp v33, v35 quad_perm:[2,3,0,1] row_mask:0xf bank_mask:0xf
    v_add_f32 v35, v35, v33
    s_nop 1
    v_mov_b32_dpp v33, v35 row_half_mirror row_mask:0xf bank_mask:0xf
    v_add_f32 v35, v35, v33
    s_nop 1
    v_mov_b32_dpp v33, v35 row_mirror row_mask:0xf bank_mask:0xf
    v_add_f32 v35, v35, v33
    v_mov_b32 v33, v35
    s_nop 1
    v_permlane16_swap_b32 v35, v33
    v_add_f32 v35, v35, v33
    v_mov_b32 v33, v35
    s_nop 1
    v_permlane32_swap_b32 v35, v33
    v_add_f32 v35, v35, v33
    v_mul_f32 v35, 0x3a800000, v35
    v_cvt_pk_bf16_f32 v33, v32, v35
    v_lshlrev_b32 v32, 16, v33
    v_and_b32 v35, 0xffff0000, v33
    v_add_f32 v35, 0x3727c5ac, v35
    v_cvt_pk_bf16_f32 v33, v35, v35
    v_lshlrev_b32 v35, 16, v33
    v_sqrt_f32 v35, v35
    s_nop 0
    v_cvt_pk_bf16_f32 v33, v35, v35
    v_lshlrev_b32 v35, 16, v33
    v_rcp_f32 v35, v35
    v_sub_f32 v16, v16, v32
    v_sub_f32 v17, v17, v32
    v_sub_f32 v18, v18, v32
    v_sub_f32 v19, v19, v32
    v_sub_f32 v20, v20, v32
    v_sub_f32 v21, v21, v32
    v_sub_f32 v22, v22, v32
    v_sub_f32 v23, v23, v32
    v_sub_f32 v24, v24, v32
    v_sub_f32 v25, v25, v32
    v_sub_f32 v26, v26, v32
    v_sub_f32 v27, v27, v32
    v_sub_f32 v28, v28, v32
    v_sub_f32 v29, v29, v32
    v_sub_f32 v30, v30, v32
    v_sub_f32 v31, v31, v32
    v_cvt_pk_bf16_f32 v33, v16, v17
    v_lshlrev_b32 v16, 16, v33
    v_and_b32 v17, 0xffff0000, v33
    v_cvt_pk_bf16_f32 v33, v18, v19
    v_lshlrev_b32 v18, 16, v33
    v_and_b32 v19, 0xffff0000, v33
    v_cvt_pk_bf16_f32 v33, v20, v21
    v_lshlrev_b32 v20, 16, v33
    v_and_b32 v21, 0xffff0000, v33
    v_cvt_pk_bf16_f32 v33, v22, v23
    v_lshlrev_b32 v22, 16, v33
    v_and_b32 v23, 0xffff0000, v33
    v_cvt_pk_bf16_f32 v33, v24, v25
    v_lshlrev_b32 v24, 16, v33
    v_and_b32 v25, 0xffff0000, v33
    v_cvt_pk_bf16_f32 v33, v26, v27
    v_lshlrev_b32 v26, 16, v33
    v_and_b32 v27, 0xffff0000, v33
    v_cvt_pk_bf16_f32 v33, v28, v29
    v_lshlrev_b32 v28, 16, v33
    v_and_b32 v29, 0xffff0000, v33
    v_cvt_pk_bf16_f32 v33, v30, v31
    v_lshlrev_b32 v30, 16, v33
    v_and_b32 v31, 0xffff0000, v33
    v_mul_f32 v16, v16, v35
    v_mul_f32 v17, v17, v35
    v_mul_f32 v18, v18, v35
    v_mul_f32 v19, v19, v35
    v_mul_f32 v20, v20, v35
    v_mul_f32 v21, v21, v35
    v_mul_f32 v22, v22, v35
    v_mul_f32 v23, v23, v35
    v_mul_f32 v24, v24, v35
    v_mul_f32 v25, v25, v35
    v_mul_f32 v26, v26, v35
    v_mul_f32 v27, v27, v35
    v_mul_f32 v28, v28, v35
    v_mul_f32 v29, v29, v35
    v_mul_f32 v30, v30, v35
    v_mul_f32 v31, v31, v35
    v_cvt_pk_bf16_f32 v4, v16, v17
    v_cvt_pk_bf16_f32 v5, v18, v19
    v_cvt_pk_bf16_f32 v6, v20, v21
    v_cvt_pk_bf16_f32 v7, v22, v23
    v_cvt_pk_bf16_f32 v8, v24, v25
    v_cvt_pk_bf16_f32 v9, v26, v27
    v_cvt_pk_bf16_f32 v10, v28, v29
    v_cvt_pk_bf16_f32 v11, v30, v31
    buffer_store_dwordx4 v[4:7], v3, s[16:19], s29 offen
    buffer_store_dwordx4 v[8:11], v3, s[16:19], s29 offen offset:1024
    s_endpgm
l0_kernel_gate_2:
    s_load_dwordx2 s[4:5], s[0:1], 0
    s_load_dwordx2 s[6:7], s[0:1], 72
    s_waitcnt lgkmcnt(0)
    s_mov_b32 s8, s4
    s_mov_b32 s9, s5
    s_and_b32 s9, s9, 0xffff
    s_mov_b32 s10, 4194304
    s_mov_b32 s11, 0x00020000
    s_mov_b32 s12, s6
    s_mov_b32 s13, s7
    s_and_b32 s13, s13, 0xffff
    s_mov_b32 s14, 2048
    s_mov_b32 s15, 0x00020000
    s_add_u32 s16, s40, 48234496
    s_addc_u32 s17, s41, 0
    s_and_b32 s17, s17, 0xffff
    s_mov_b32 s18, 8192
    s_mov_b32 s19, 0x00020000
    s_sub_u32 s29, s2, 256
    s_lshl_b32 s29, s29, 3
    s_add_u32 s29, s29, s24
    s_lshl_b32 s30, s29, 11
    buffer_load_dwordx4 v[4:7], v3, s[8:11], s30 offen
    buffer_load_dwordx4 v[8:11], v3, s[8:11], s30 offen offset:1024
    buffer_load_dwordx4 v[40:43], v3, s[12:15], 0 offen
    buffer_load_dwordx4 v[44:47], v3, s[12:15], 0 offen offset:1024
    s_waitcnt vmcnt(0)
    v_lshlrev_b32 v16, 16, v4
    v_and_b32 v17, 0xffff0000, v4
    v_lshlrev_b32 v18, 16, v5
    v_and_b32 v19, 0xffff0000, v5
    v_lshlrev_b32 v20, 16, v6
    v_and_b32 v21, 0xffff0000, v6
    v_lshlrev_b32 v22, 16, v7
    v_and_b32 v23, 0xffff0000, v7
    v_lshlrev_b32 v24, 16, v8
    v_and_b32 v25, 0xffff0000, v8
    v_lshlrev_b32 v26, 16, v9
    v_and_b32 v27, 0xffff0000, v9
    v_lshlrev_b32 v28, 16, v10
    v_and_b32 v29, 0xffff0000, v10
    v_lshlrev_b32 v30, 16, v11
    v_and_b32 v31, 0xffff0000, v11
    v_lshlrev_b32 v48, 16, v40
    v_and_b32 v49, 0xffff0000, v40
    v_lshlrev_b32 v50, 16, v41
    v_and_b32 v51, 0xffff0000, v41
    v_lshlrev_b32 v52, 16, v42
    v_and_b32 v53, 0xffff0000, v42
    v_lshlrev_b32 v54, 16, v43
    v_and_b32 v55, 0xffff0000, v43
    v_lshlrev_b32 v56, 16, v44
    v_and_b32 v57, 0xffff0000, v44
    v_lshlrev_b32 v58, 16, v45
    v_and_b32 v59, 0xffff0000, v45
    v_lshlrev_b32 v60, 16, v46
    v_and_b32 v61, 0xffff0000, v46
    v_lshlrev_b32 v62, 16, v47
    v_and_b32 v63, 0xffff0000, v47
    v_mul_f32 v16, v16, v48
    v_mul_f32 v17, v17, v49
    v_mul_f32 v18, v18, v50
    v_mul_f32 v19, v19, v51
    v_mul_f32 v20, v20, v52
    v_mul_f32 v21, v21, v53
    v_mul_f32 v22, v22, v54
    v_mul_f32 v23, v23, v55
    v_mul_f32 v24, v24, v56
    v_mul_f32 v25, v25, v57
    v_mul_f32 v26, v26, v58
    v_mul_f32 v27, v27, v59
    v_mul_f32 v28, v28, v60
    v_mul_f32 v29, v29, v61
    v_mul_f32 v30, v30, v62
    v_mul_f32 v31, v31, v63
    v_cvt_pk_bf16_f32 v33, v16, v17
    v_lshlrev_b32 v16, 16, v33
    v_and_b32 v17, 0xffff0000, v33
    v_cvt_pk_bf16_f32 v33, v18, v19
    v_lshlrev_b32 v18, 16, v33
    v_and_b32 v19, 0xffff0000, v33
    v_cvt_pk_bf16_f32 v33, v20, v21
    v_lshlrev_b32 v20, 16, v33
    v_and_b32 v21, 0xffff0000, v33
    v_cvt_pk_bf16_f32 v33, v22, v23
    v_lshlrev_b32 v22, 16, v33
    v_and_b32 v23, 0xffff0000, v33
    v_cvt_pk_bf16_f32 v33, v24, v25
    v_lshlrev_b32 v24, 16, v33
    v_and_b32 v25, 0xffff0000, v33
    v_cvt_pk_bf16_f32 v33, v26, v27
    v_lshlrev_b32 v26, 16, v33
    v_and_b32 v27, 0xffff0000, v33
    v_cvt_pk_bf16_f32 v33, v28, v29
    v_lshlrev_b32 v28, 16, v33
    v_and_b32 v29, 0xffff0000, v33
    v_cvt_pk_bf16_f32 v33, v30, v31
    v_lshlrev_b32 v30, 16, v33
    v_and_b32 v31, 0xffff0000, v33
    v_add_f32 v32, v16, v17
    v_add_f32 v32, v32, v18
    v_add_f32 v32, v32, v19
    v_add_f32 v32, v32, v20
    v_add_f32 v32, v32, v21
    v_add_f32 v32, v32, v22
    v_add_f32 v32, v32, v23
    v_add_f32 v32, v32, v24
    v_add_f32 v32, v32, v25
    v_add_f32 v32, v32, v26
    v_add_f32 v32, v32, v27
    v_add_f32 v32, v32, v28
    v_add_f32 v32, v32, v29
    v_add_f32 v32, v32, v30
    v_add_f32 v32, v32, v31
    s_nop 1
    v_mov_b32_dpp v33, v32 quad_perm:[1,0,3,2] row_mask:0xf bank_mask:0xf
    v_add_f32 v32, v32, v33
    s_nop 1
    v_mov_b32_dpp v33, v32 quad_perm:[2,3,0,1] row_mask:0xf bank_mask:0xf
    v_add_f32 v32, v32, v33
    s_nop 1
    v_mov_b32_dpp v33, v32 row_half_mirror row_mask:0xf bank_mask:0xf
    v_add_f32 v32, v32, v33
    s_nop 1
    v_mov_b32_dpp v33, v32 row_mirror row_mask:0xf bank_mask:0xf
    v_add_f32 v32, v32, v33
    v_mov_b32 v33, v32
    s_nop 1
    v_permlane16_swap_b32 v32, v33
    v_add_f32 v32, v32, v33
    v_mov_b32 v33, v32
    s_nop 1
    v_permlane32_swap_b32 v32, v33
    v_add_f32 v32, v32, v33
    v_cvt_pk_bf16_f32 v33, v32, v32
    v_lshlrev_b32 v32, 16, v33
    v_mul_f32 v32, 0xbfb8aa3b, v32
    v_exp_f32 v32, v32
    s_nop 0
    v_add_f32 v32, 1.0, v32
    v_rcp_f32 v32, v32
    s_nop 0
    v_cvt_pk_bf16_f32 v33, v32, v32
    v_lshlrev_b32 v32, 16, v33
    s_lshl_b32 s30, s29, 2
    v_cmp_eq_u32 vcc, 0, v1
    s_nop 0
    s_and_saveexec_b64 s[56:57], vcc
    v_mov_b32 v34, 0
    buffer_store_dword v32, v34, s[16:19], s30 offen
l0_kernel_end_1:
    s_endpgm
.text
.globl l1_kernel
.p2align 8
.type l1_kernel,@function
l1_kernel:
    s_cmp_ge_u32 s2, 256
    s_cbranch_scc1 l1_kernel_end_1
    s_and_b32 s70, s2, 7
    s_lshr_b32 s71, s2, 3
    s_sub_u32 s29, s71, 0
    s_mul_hi_u32 s30, s29, 536870912
    s_mul_i32 s35, s30, 8
    s_sub_u32 s35, s29, s35
    s_lshr_b32 s34, s70, 2
    s_mul_i32 s34, s34, 4
    s_add_u32 s34, s34, s30
    s_and_b32 s30, s70, 3
    s_mul_i32 s30, s30, 8
    s_add_u32 s35, s35, s30
    s_cmp_ge_u32 s35, 24
    s_cbranch_scc1 l1_kernel_w1_2
    s_cmp_ge_u32 s35, 8
    s_cbranch_scc1 l1_kernel_kv_3
    s_load_dwordx2 s[40:41], s[0:1], 96
    s_load_dwordx2 s[6:7], s[0:1], 8
    s_load_dwordx2 s[4:5], s[0:1], 0
    s_waitcnt lgkmcnt(0)
    s_mov_b32 s8, s4
    s_mov_b32 s9, s5
    s_and_b32 s9, s9, 0xffff
    s_mov_b32 s10, 4194304
    s_mov_b32 s11, 0x00020000
    s_mov_b32 s12, s6
    s_mov_b32 s13, s7
    s_and_b32 s13, s13, 0xffff
    s_mov_b32 s14, 6291456
    s_mov_b32 s15, 0x00020000
    s_add_u32 s16, s40, 4194304
    s_addc_u32 s17, s41, 0
    s_and_b32 s17, s17, 0xffff
    s_mov_b32 s18, 4194304
    s_mov_b32 s19, 0x00020000
    s_mov_b32 s31, 0
    s_mov_b32 s32, 0
    s_mov_b32 s33, 16
    v_mov_b32 v146, v0
    v_lshrrev_b32 v148, 6, v0
    s_nop 0
    v_readfirstlane_b32 s24, v148
    s_nop 0
    s_cmp_lt_u32 s24, 8
    s_cbranch_scc1 l1_kernel_comp_4
    s_cmp_lt_u32 s24, 12
    s_cbranch_scc1 l1_kernel_lok_5
    s_endpgm
l1_kernel_lok_5:
    s_sub_u32 s24, s24, 8
    v_and_b32 v4, 63, v0
    s_mul_i32 s27, s24, 8192
    s_mul_i32 s28, s24, 4096
    s_add_u32 s28, s28, 32768
    v_lshrrev_b32 v6, 3, v4
    v_lshrrev_b32 v7, 4, v4
    v_and_b32 v8, 7, v4
    s_mul_i32 s29, s34, 256
    s_mul_i32 s30, s24, 64
    s_add_u32 s29, s29, s30
    s_mov_b32 s30, 2048
    v_add_u32 v9, s29, v6
    v_mul_lo_u32 v9, v9, s30
    v_xor_b32 v10, v7, v8
    v_lshlrev_b32 v10, 4, v10
    v_add_u32 v12, v9, v10
    v_add_u32 v9, s29, v6
    v_add_u32 v9, 8, v9
    v_mul_lo_u32 v9, v9, s30
    v_or_b32 v10, 4, v7
    v_xor_b32 v10, v10, v8
    v_lshlrev_b32 v10, 4, v10
    v_add_u32 v13, v9, v10
    v_add_u32 v9, s29, v6
    v_add_u32 v9, 16, v9
    v_mul_lo_u32 v9, v9, s30
    v_xor_b32 v10, v7, v8
    v_lshlrev_b32 v10, 4, v10
    v_add_u32 v14, v9, v10
    v_add_u32 v9, s29, v6
    v_add_u32 v9, 24, v9
    v_mul_lo_u32 v9, v9, s30
    v_or_b32 v10, 4, v7
    v_xor_b32 v10, v10, v8
    v_lshlrev_b32 v10, 4, v10
    v_add_u32 v15, v9, v10
    v_add_u32 v9, s29, v6
    v_add_u32 v9, 32, v9
    v_mul_lo_u32 v9, v9, s30
    v_xor_b32 v10, v7, v8
    v_lshlrev_b32 v10, 4, v10
    v_add_u32 v16, v9, v10
    v_add_u32 v9, s29, v6
    v_add_u32 v9, 40, v9
    v_mul_lo_u32 v9, v9, s30
    v_or_b32 v10, 4, v7
    v_xor_b32 v10, v10, v8
    v_lshlrev_b32 v10, 4, v10
    v_add_u32 v17, v9, v10
    v_add_u32 v9, s29, v6
    v_add_u32 v9, 48, v9
    v_mul_lo_u32 v9, v9, s30
    v_xor_b32 v10, v7, v8
    v_lshlrev_b32 v10, 4, v10
    v_add_u32 v18, v9, v10
    v_add_u32 v9, s29, v6
    v_add_u32 v9, 56, v9
    v_mul_lo_u32 v9, v9, s30
    v_or_b32 v10, 4, v7
    v_xor_b32 v10, v10, v8
    v_lshlrev_b32 v10, 4, v10
    v_add_u32 v19, v9, v10
    v_lshrrev_b32 v6, 4, v4
    v_and_b32 v8, 15, v4
    v_lshlrev_b32 v7, 2, v6
    v_xor_b32 v8, v8, v7
    v_lshlrev_b32 v8, 4, v8
    s_mul_i32 s30, s35, 256
    s_mul_i32 s29, s24, 16
    v_add_u32 v8, s30, v8
    s_mov_b32 s30, 6144
    v_add_u32 v9, s29, v6
    v_mul_lo_u32 v9, v9, s30
    v_add_u32 v20, v9, v8
    v_add_u32 v9, s29, v6
    v_add_u32 v9, 4, v9
    v_mul_lo_u32 v9, v9, s30
    v_add_u32 v21, v9, v8
    v_add_u32 v9, s29, v6
    v_add_u32 v9, 8, v9
    v_mul_lo_u32 v9, v9, s30
    v_add_u32 v22, v9, v8
    v_add_u32 v9, s29, v6
    v_add_u32 v9, 12, v9
    v_mul_lo_u32 v9, v9, s30
    v_add_u32 v23, v9, v8
    s_add_u32 m0, s27, 0
    s_nop 0
    buffer_load_dwordx4 v12, s[8:11], s31 offen lds
    s_add_u32 m0, s27, 1024
    s_nop 0
    buffer_load_dwordx4 v13, s[8:11], s31 offen lds
    s_add_u32 m0, s27, 2048
    s_nop 0
    buffer_load_dwordx4 v14, s[8:11], s31 offen lds
    s_add_u32 m0, s27, 3072
    s_nop 0
    buffer_load_dwordx4 v15, s[8:11], s31 offen lds
    s_add_u32 m0, s27, 4096
    s_nop 0
    buffer_load_dwordx4 v16, s[8:11], s31 offen lds
    s_add_u32 m0, s27, 5120
    s_nop 0
    buffer_load_dwordx4 v17, s[8:11], s31 offen lds
    s_add_u32 m0, s27, 6144
    s_nop 0
    buffer_load_dwordx4 v18, s[8:11], s31 offen lds
    s_add_u32 m0, s27, 7168
    s_nop 0
    buffer_load_dwordx4 v19, s[8:11], s31 offen lds
    s_add_u32 m0, s28, 0
    s_nop 0
    buffer_load_dwordx4 v20, s[12:15], s32 offen lds
    s_add_u32 m0, s28, 1024
    s_nop 0
    buffer_load_dwordx4 v21, s[12:15], s32 offen lds
    s_add_u32 m0, s28, 2048
    s_nop 0
    buffer_load_dwordx4 v22, s[12:15], s32 offen lds
    s_add_u32 m0, s28, 3072
    s_nop 0
    buffer_load_dwordx4 v23, s[12:15], s32 offen lds
    s_add_u32 s31, s31, 128
    s_add_u32 s32, s32, 393216
    s_add_u32 m0, s27, 49152
    s_nop 0
    buffer_load_dwordx4 v12, s[8:11], s31 offen lds
    s_add_u32 m0, s27, 50176
    s_nop 0
    buffer_load_dwordx4 v13, s[8:11], s31 offen lds
    s_add_u32 m0, s27, 51200
    s_nop 0
    buffer_load_dwordx4 v14, s[8:11], s31 offen lds
    s_add_u32 m0, s27, 52224
    s_nop 0
    buffer_load_dwordx4 v15, s[8:11], s31 offen lds
    s_add_u32 m0, s27, 53248
    s_nop 0
    buffer_load_dwordx4 v16, s[8:11], s31 offen lds
    s_add_u32 m0, s27, 54272
    s_nop 0
    buffer_load_dwordx4 v17, s[8:11], s31 offen lds
    s_add_u32 m0, s27, 55296
    s_nop 0
    buffer_load_dwordx4 v18, s[8:11], s31 offen lds
    s_add_u32 m0, s27, 56320
    s_nop 0
    buffer_load_dwordx4 v19, s[8:11], s31 offen lds
    s_add_u32 m0, s28, 49152
    s_nop 0
    buffer_load_dwordx4 v20, s[12:15], s32 offen lds
    s_add_u32 m0, s28, 50176
    s_nop 0
    buffer_load_dwordx4 v21, s[12:15], s32 offen lds
    s_add_u32 m0, s28, 51200
    s_nop 0
    buffer_load_dwordx4 v22, s[12:15], s32 offen lds
    s_add_u32 m0, s28, 52224
    s_nop 0
    buffer_load_dwordx4 v23, s[12:15], s32 offen lds
    s_add_u32 s31, s31, 128
    s_add_u32 s32, s32, 393216
l1_kernel_lloop_6:
    s_cmp_lt_u32 s33, 2
    s_cbranch_scc1 l1_kernel_w0_8
    s_waitcnt vmcnt(12)
    s_branch l1_kernel_w1_9
l1_kernel_w0_8:
    s_waitcnt vmcnt(0)
l1_kernel_w1_9:
    s_barrier
    s_cmp_le_u32 s33, 2
    s_cbranch_scc1 l1_kernel_nd_10
    s_add_u32 m0, s27, 98304
    s_nop 0
    buffer_load_dwordx4 v12, s[8:11], s31 offen lds
    s_add_u32 m0, s27, 99328
    s_nop 0
    buffer_load_dwordx4 v13, s[8:11], s31 offen lds
    s_add_u32 m0, s27, 100352
    s_nop 0
    buffer_load_dwordx4 v14, s[8:11], s31 offen lds
    s_add_u32 m0, s27, 101376
    s_nop 0
    buffer_load_dwordx4 v15, s[8:11], s31 offen lds
    s_add_u32 m0, s27, 102400
    s_nop 0
    buffer_load_dwordx4 v16, s[8:11], s31 offen lds
    s_add_u32 m0, s27, 103424
    s_nop 0
    buffer_load_dwordx4 v17, s[8:11], s31 offen lds
    s_add_u32 m0, s27, 104448
    s_nop 0
    buffer_load_dwordx4 v18, s[8:11], s31 offen lds
    s_add_u32 m0, s27, 105472
    s_nop 0
    buffer_load_dwordx4 v19, s[8:11], s31 offen lds
    s_add_u32 m0, s28, 98304
    s_nop 0
    buffer_load_dwordx4 v20, s[12:15], s32 offen lds
    s_add_u32 m0, s28, 99328
    s_nop 0
    buffer_load_dwordx4 v21, s[12:15], s32 offen lds
    s_add_u32 m0, s28, 100352
    s_nop 0
    buffer_load_dwordx4 v22, s[12:15], s32 offen lds
    s_add_u32 m0, s28, 101376
    s_nop 0
    buffer_load_dwordx4 v23, s[12:15], s32 offen lds
    s_add_u32 s31, s31, 128
    s_add_u32 s32, s32, 393216
l1_kernel_nd_10:
    s_sub_u32 s33, s33, 1
    s_cmp_eq_u32 s33, 0
    s_cbranch_scc1 l1_kernel_ldone_7
    s_cmp_lt_u32 s33, 2
    s_cbranch_scc1 l1_kernel_w0_11
    s_waitcnt vmcnt(12)
    s_branch l1_kernel_w1_12
l1_kernel_w0_11:
    s_waitcnt vmcnt(0)
l1_kernel_w1_12:
    s_barrier
    s_cmp_le_u32 s33, 2
    s_cbranch_scc1 l1_kernel_nd_13
    s_add_u32 m0, s27, 0
    s_nop 0
    buffer_load_dwordx4 v12, s[8:11], s31 offen lds
    s_add_u32 m0, s27, 1024
    s_nop 0
    buffer_load_dwordx4 v13, s[8:11], s31 offen lds
    s_add_u32 m0, s27, 2048
    s_nop 0
    buffer_load_dwordx4 v14, s[8:11], s31 offen lds
    s_add_u32 m0, s27, 3072
    s_nop 0
    buffer_load_dwordx4 v15, s[8:11], s31 offen lds
    s_add_u32 m0, s27, 4096
    s_nop 0
    buffer_load_dwordx4 v16, s[8:11], s31 offen lds
    s_add_u32 m0, s27, 5120
    s_nop 0
    buffer_load_dwordx4 v17, s[8:11], s31 offen lds
    s_add_u32 m0, s27, 6144
    s_nop 0
    buffer_load_dwordx4 v18, s[8:11], s31 offen lds
    s_add_u32 m0, s27, 7168
    s_nop 0
    buffer_load_dwordx4 v19, s[8:11], s31 offen lds
    s_add_u32 m0, s28, 0
    s_nop 0
    buffer_load_dwordx4 v20, s[12:15], s32 offen lds
    s_add_u32 m0, s28, 1024
    s_nop 0
    buffer_load_dwordx4 v21, s[12:15], s32 offen lds
    s_add_u32 m0, s28, 2048
    s_nop 0
    buffer_load_dwordx4 v22, s[12:15], s32 offen lds
    s_add_u32 m0, s28, 3072
    s_nop 0
    buffer_load_dwordx4 v23, s[12:15], s32 offen lds
    s_add_u32 s31, s31, 128
    s_add_u32 s32, s32, 393216
l1_kernel_nd_13:
    s_sub_u32 s33, s33, 1
    s_cmp_eq_u32 s33, 0
    s_cbranch_scc1 l1_kernel_ldone_7
    s_cmp_lt_u32 s33, 2
    s_cbranch_scc1 l1_kernel_w0_14
    s_waitcnt vmcnt(12)
    s_branch l1_kernel_w1_15
l1_kernel_w0_14:
    s_waitcnt vmcnt(0)
l1_kernel_w1_15:
    s_barrier
    s_cmp_le_u32 s33, 2
    s_cbranch_scc1 l1_kernel_nd_16
    s_add_u32 m0, s27, 49152
    s_nop 0
    buffer_load_dwordx4 v12, s[8:11], s31 offen lds
    s_add_u32 m0, s27, 50176
    s_nop 0
    buffer_load_dwordx4 v13, s[8:11], s31 offen lds
    s_add_u32 m0, s27, 51200
    s_nop 0
    buffer_load_dwordx4 v14, s[8:11], s31 offen lds
    s_add_u32 m0, s27, 52224
    s_nop 0
    buffer_load_dwordx4 v15, s[8:11], s31 offen lds
    s_add_u32 m0, s27, 53248
    s_nop 0
    buffer_load_dwordx4 v16, s[8:11], s31 offen lds
    s_add_u32 m0, s27, 54272
    s_nop 0
    buffer_load_dwordx4 v17, s[8:11], s31 offen lds
    s_add_u32 m0, s27, 55296
    s_nop 0
    buffer_load_dwordx4 v18, s[8:11], s31 offen lds
    s_add_u32 m0, s27, 56320
    s_nop 0
    buffer_load_dwordx4 v19, s[8:11], s31 offen lds
    s_add_u32 m0, s28, 49152
    s_nop 0
    buffer_load_dwordx4 v20, s[12:15], s32 offen lds
    s_add_u32 m0, s28, 50176
    s_nop 0
    buffer_load_dwordx4 v21, s[12:15], s32 offen lds
    s_add_u32 m0, s28, 51200
    s_nop 0
    buffer_load_dwordx4 v22, s[12:15], s32 offen lds
    s_add_u32 m0, s28, 52224
    s_nop 0
    buffer_load_dwordx4 v23, s[12:15], s32 offen lds
    s_add_u32 s31, s31, 128
    s_add_u32 s32, s32, 393216
l1_kernel_nd_16:
    s_sub_u32 s33, s33, 1
    s_cmp_eq_u32 s33, 0
    s_cbranch_scc0 l1_kernel_lloop_6
l1_kernel_ldone_7:
    s_endpgm
l1_kernel_comp_4:
    v_and_b32 v148, 63, v146
    s_lshr_b32 s25, s24, 1
    s_and_b32 s26, s24, 1
    v_and_b32 v150, 31, v148
    v_lshrrev_b32 v151, 5, v148
    v_lshrrev_b32 v152, 1, v148
    v_and_b32 v152, 7, v152
    s_mul_i32 s29, s25, 64
    v_add_u32 v153, s29, v150
    v_lshlrev_b32 v153, 7, v153
    v_add_u32 v154, 0, v151
    v_xor_b32 v154, v154, v152
    v_lshlrev_b32 v154, 4, v154
    v_add_u32 v128, v153, v154
    v_add_u32 v132, 49152, v128
    v_add_u32 v136, 98304, v128
    v_add_u32 v154, 2, v151
    v_xor_b32 v154, v154, v152
    v_lshlrev_b32 v154, 4, v154
    v_add_u32 v129, v153, v154
    v_add_u32 v133, 49152, v129
    v_add_u32 v137, 98304, v129
    v_add_u32 v154, 4, v151
    v_xor_b32 v154, v154, v152
    v_lshlrev_b32 v154, 4, v154
    v_add_u32 v130, v153, v154
    v_add_u32 v134, 49152, v130
    v_add_u32 v138, 98304, v130
    v_add_u32 v154, 6, v151
    v_xor_b32 v154, v154, v152
    v_lshlrev_b32 v154, 4, v154
    v_add_u32 v131, v153, v154
    v_add_u32 v135, 49152, v131
    v_add_u32 v139, 98304, v131
    v_lshrrev_b32 v150, 4, v148
    v_and_b32 v151, 15, v148
    v_lshrrev_b32 v151, 2, v151
    v_and_b32 v152, 3, v148
    v_lshrrev_b32 v153, 1, v150
    v_lshlrev_b32 v153, 3, v153
    v_add_u32 v153, v153, v151
    v_mul_u32_u24 v153, 256, v153
    v_and_b32 v154, 1, v150
    v_lshlrev_b32 v154, 1, v154
    v_lshrrev_b32 v155, 1, v152
    v_add_u32 v154, v154, v155
    s_mul_i32 s29, s26, 8
    v_add_u32 v154, s29, v154
    v_lshlrev_b32 v155, 2, v151
    v_and_b32 v152, 1, v152
    v_lshlrev_b32 v152, 3, v152
    v_add_u32 v153, v153, v152
    v_add_u32 v153, 32768, v153
    v_add_u32 v140, 0, v154
    v_xor_b32 v140, v140, v155
    v_lshlrev_b32 v140, 4, v140
    v_add_u32 v140, v140, v153
    v_add_u32 v142, 49152, v140
    v_add_u32 v144, 98304, v140
    v_add_u32 v141, 4, v154
    v_xor_b32 v141, v141, v155
    v_lshlrev_b32 v141, 4, v141
    v_add_u32 v141, v141, v153
    v_add_u32 v143, 49152, v141
    v_add_u32 v145, 98304, v141
    v_mov_b32 v0, 0
    v_mov_b32 v1, 0
    v_mov_b32 v2, 0
    v_mov_b32 v3, 0
    v_mov_b32 v4, 0
    v_mov_b32 v5, 0
    v_mov_b32 v6, 0
    v_mov_b32 v7, 0
    v_mov_b32 v8, 0
    v_mov_b32 v9, 0
    v_mov_b32 v10, 0
    v_mov_b32 v11, 0
    v_mov_b32 v12, 0
    v_mov_b32 v13, 0
    v_mov_b32 v14, 0
    v_mov_b32 v15, 0
    v_mov_b32 v16, 0
    v_mov_b32 v17, 0
    v_mov_b32 v18, 0
    v_mov_b32 v19, 0
    v_mov_b32 v20, 0
    v_mov_b32 v21, 0
    v_mov_b32 v22, 0
    v_mov_b32 v23, 0
    v_mov_b32 v24, 0
    v_mov_b32 v25, 0
    v_mov_b32 v26, 0
    v_mov_b32 v27, 0
    v_mov_b32 v28, 0
    v_mov_b32 v29, 0
    v_mov_b32 v30, 0
    v_mov_b32 v31, 0
    v_mov_b32 v32, 0
    v_mov_b32 v33, 0
    v_mov_b32 v34, 0
    v_mov_b32 v35, 0
    v_mov_b32 v36, 0
    v_mov_b32 v37, 0
    v_mov_b32 v38, 0
    v_mov_b32 v39, 0
    v_mov_b32 v40, 0
    v_mov_b32 v41, 0
    v_mov_b32 v42, 0
    v_mov_b32 v43, 0
    v_mov_b32 v44, 0
    v_mov_b32 v45, 0
    v_mov_b32 v46, 0
    v_mov_b32 v47, 0
    v_mov_b32 v48, 0
    v_mov_b32 v49, 0
    v_mov_b32 v50, 0
    v_mov_b32 v51, 0
    v_mov_b32 v52, 0
    v_mov_b32 v53, 0
    v_mov_b32 v54, 0
    v_mov_b32 v55, 0
    v_mov_b32 v56, 0
    v_mov_b32 v57, 0
    v_mov_b32 v58, 0
    v_mov_b32 v59, 0
    v_mov_b32 v60, 0
    v_mov_b32 v61, 0
    v_mov_b32 v62, 0
    v_mov_b32 v63, 0
    v_mov_b32 v80, 0
    v_mov_b32 v81, 0
    v_mov_b32 v82, 0
    v_mov_b32 v83, 0
    v_mov_b32 v84, 0
    v_mov_b32 v85, 0
    v_mov_b32 v86, 0
    v_mov_b32 v87, 0
    v_mov_b32 v112, 0
    v_mov_b32 v113, 0
    v_mov_b32 v114, 0
    v_mov_b32 v115, 0
    v_mov_b32 v116, 0
    v_mov_b32 v117, 0
    v_mov_b32 v118, 0
    v_mov_b32 v119, 0
    v_mov_b32 v88, 0
    v_mov_b32 v89, 0
    v_mov_b32 v90, 0
    v_mov_b32 v91, 0
    v_mov_b32 v92, 0
    v_mov_b32 v93, 0
    v_mov_b32 v94, 0
    v_mov_b32 v95, 0
    v_mov_b32 v120, 0
    v_mov_b32 v121, 0
    v_mov_b32 v122, 0
    v_mov_b32 v123, 0
    v_mov_b32 v124, 0
    v_mov_b32 v125, 0
    v_mov_b32 v126, 0
    v_mov_b32 v127, 0
l1_kernel_loop_17:
    s_waitcnt lgkmcnt(0)
    s_barrier
    ds_read_b128 v[64:67], v128 offset:0
    ds_read_b128 v[68:71], v128 offset:4096
    ds_read_b64_tr_b16 v[96:97], v140 offset:0
    ds_read_b64_tr_b16 v[98:99], v140 offset:1024
    ds_read_b64_tr_b16 v[100:101], v141 offset:0
    ds_read_b64_tr_b16 v[102:103], v141 offset:1024
    v_mfma_f32_32x32x16_bf16 v[0:15], v[112:115], v[80:83], v[0:15]
    v_mfma_f32_32x32x16_bf16 v[16:31], v[112:115], v[84:87], v[16:31]
    v_mfma_f32_32x32x16_bf16 v[32:47], v[116:119], v[80:83], v[32:47]
    v_mfma_f32_32x32x16_bf16 v[48:63], v[116:119], v[84:87], v[48:63]
    ds_read_b128 v[72:75], v129 offset:0
    ds_read_b128 v[76:79], v129 offset:4096
    ds_read_b64_tr_b16 v[104:105], v140 offset:4096
    ds_read_b64_tr_b16 v[106:107], v140 offset:5120
    ds_read_b64_tr_b16 v[108:109], v141 offset:4096
    ds_read_b64_tr_b16 v[110:111], v141 offset:5120
    v_mfma_f32_32x32x16_bf16 v[0:15], v[120:123], v[88:91], v[0:15]
    v_mfma_f32_32x32x16_bf16 v[16:31], v[120:123], v[92:95], v[16:31]
    v_mfma_f32_32x32x16_bf16 v[32:47], v[124:127], v[88:91], v[32:47]
    v_mfma_f32_32x32x16_bf16 v[48:63], v[124:127], v[92:95], v[48:63]
    ds_read_b128 v[80:83], v130 offset:0
    ds_read_b128 v[84:87], v130 offset:4096
    ds_read_b64_tr_b16 v[112:113], v140 offset:8192
    ds_read_b64_tr_b16 v[114:115], v140 offset:9216
    ds_read_b64_tr_b16 v[116:117], v141 offset:8192
    ds_read_b64_tr_b16 v[118:119], v141 offset:9216
    s_waitcnt lgkmcnt(12)
    v_mfma_f32_32x32x16_bf16 v[0:15], v[96:99], v[64:67], v[0:15]
    v_mfma_f32_32x32x16_bf16 v[16:31], v[96:99], v[68:71], v[16:31]
    v_mfma_f32_32x32x16_bf16 v[32:47], v[100:103], v[64:67], v[32:47]
    v_mfma_f32_32x32x16_bf16 v[48:63], v[100:103], v[68:71], v[48:63]
    ds_read_b128 v[88:91], v131 offset:0
    ds_read_b128 v[92:95], v131 offset:4096
    ds_read_b64_tr_b16 v[120:121], v140 offset:12288
    ds_read_b64_tr_b16 v[122:123], v140 offset:13312
    ds_read_b64_tr_b16 v[124:125], v141 offset:12288
    ds_read_b64_tr_b16 v[126:127], v141 offset:13312
    s_waitcnt lgkmcnt(12)
    v_mfma_f32_32x32x16_bf16 v[0:15], v[104:107], v[72:75], v[0:15]
    v_mfma_f32_32x32x16_bf16 v[16:31], v[104:107], v[76:79], v[16:31]
    v_mfma_f32_32x32x16_bf16 v[32:47], v[108:111], v[72:75], v[32:47]
    v_mfma_f32_32x32x16_bf16 v[48:63], v[108:111], v[76:79], v[48:63]
    s_sub_u32 s33, s33, 1
    s_cmp_eq_u32 s33, 0
    s_cbranch_scc1 l1_kernel_exit_18
    s_waitcnt lgkmcnt(0)
    s_barrier
    ds_read_b128 v[64:67], v132 offset:0
    ds_read_b128 v[68:71], v132 offset:4096
    ds_read_b64_tr_b16 v[96:97], v142 offset:0
    ds_read_b64_tr_b16 v[98:99], v142 offset:1024
    ds_read_b64_tr_b16 v[100:101], v143 offset:0
    ds_read_b64_tr_b16 v[102:103], v143 offset:1024
    v_mfma_f32_32x32x16_bf16 v[0:15], v[112:115], v[80:83], v[0:15]
    v_mfma_f32_32x32x16_bf16 v[16:31], v[112:115], v[84:87], v[16:31]
    v_mfma_f32_32x32x16_bf16 v[32:47], v[116:119], v[80:83], v[32:47]
    v_mfma_f32_32x32x16_bf16 v[48:63], v[116:119], v[84:87], v[48:63]
    ds_read_b128 v[72:75], v133 offset:0
    ds_read_b128 v[76:79], v133 offset:4096
    ds_read_b64_tr_b16 v[104:105], v142 offset:4096
    ds_read_b64_tr_b16 v[106:107], v142 offset:5120
    ds_read_b64_tr_b16 v[108:109], v143 offset:4096
    ds_read_b64_tr_b16 v[110:111], v143 offset:5120
    v_mfma_f32_32x32x16_bf16 v[0:15], v[120:123], v[88:91], v[0:15]
    v_mfma_f32_32x32x16_bf16 v[16:31], v[120:123], v[92:95], v[16:31]
    v_mfma_f32_32x32x16_bf16 v[32:47], v[124:127], v[88:91], v[32:47]
    v_mfma_f32_32x32x16_bf16 v[48:63], v[124:127], v[92:95], v[48:63]
    ds_read_b128 v[80:83], v134 offset:0
    ds_read_b128 v[84:87], v134 offset:4096
    ds_read_b64_tr_b16 v[112:113], v142 offset:8192
    ds_read_b64_tr_b16 v[114:115], v142 offset:9216
    ds_read_b64_tr_b16 v[116:117], v143 offset:8192
    ds_read_b64_tr_b16 v[118:119], v143 offset:9216
    s_waitcnt lgkmcnt(12)
    v_mfma_f32_32x32x16_bf16 v[0:15], v[96:99], v[64:67], v[0:15]
    v_mfma_f32_32x32x16_bf16 v[16:31], v[96:99], v[68:71], v[16:31]
    v_mfma_f32_32x32x16_bf16 v[32:47], v[100:103], v[64:67], v[32:47]
    v_mfma_f32_32x32x16_bf16 v[48:63], v[100:103], v[68:71], v[48:63]
    ds_read_b128 v[88:91], v135 offset:0
    ds_read_b128 v[92:95], v135 offset:4096
    ds_read_b64_tr_b16 v[120:121], v142 offset:12288
    ds_read_b64_tr_b16 v[122:123], v142 offset:13312
    ds_read_b64_tr_b16 v[124:125], v143 offset:12288
    ds_read_b64_tr_b16 v[126:127], v143 offset:13312
    s_waitcnt lgkmcnt(12)
    v_mfma_f32_32x32x16_bf16 v[0:15], v[104:107], v[72:75], v[0:15]
    v_mfma_f32_32x32x16_bf16 v[16:31], v[104:107], v[76:79], v[16:31]
    v_mfma_f32_32x32x16_bf16 v[32:47], v[108:111], v[72:75], v[32:47]
    v_mfma_f32_32x32x16_bf16 v[48:63], v[108:111], v[76:79], v[48:63]
    s_sub_u32 s33, s33, 1
    s_cmp_eq_u32 s33, 0
    s_cbranch_scc1 l1_kernel_exit_18
    s_waitcnt lgkmcnt(0)
    s_barrier
    ds_read_b128 v[64:67], v136 offset:0
    ds_read_b128 v[68:71], v136 offset:4096
    ds_read_b64_tr_b16 v[96:97], v144 offset:0
    ds_read_b64_tr_b16 v[98:99], v144 offset:1024
    ds_read_b64_tr_b16 v[100:101], v145 offset:0
    ds_read_b64_tr_b16 v[102:103], v145 offset:1024
    v_mfma_f32_32x32x16_bf16 v[0:15], v[112:115], v[80:83], v[0:15]
    v_mfma_f32_32x32x16_bf16 v[16:31], v[112:115], v[84:87], v[16:31]
    v_mfma_f32_32x32x16_bf16 v[32:47], v[116:119], v[80:83], v[32:47]
    v_mfma_f32_32x32x16_bf16 v[48:63], v[116:119], v[84:87], v[48:63]
    ds_read_b128 v[72:75], v137 offset:0
    ds_read_b128 v[76:79], v137 offset:4096
    ds_read_b64_tr_b16 v[104:105], v144 offset:4096
    ds_read_b64_tr_b16 v[106:107], v144 offset:5120
    ds_read_b64_tr_b16 v[108:109], v145 offset:4096
    ds_read_b64_tr_b16 v[110:111], v145 offset:5120
    v_mfma_f32_32x32x16_bf16 v[0:15], v[120:123], v[88:91], v[0:15]
    v_mfma_f32_32x32x16_bf16 v[16:31], v[120:123], v[92:95], v[16:31]
    v_mfma_f32_32x32x16_bf16 v[32:47], v[124:127], v[88:91], v[32:47]
    v_mfma_f32_32x32x16_bf16 v[48:63], v[124:127], v[92:95], v[48:63]
    ds_read_b128 v[80:83], v138 offset:0
    ds_read_b128 v[84:87], v138 offset:4096
    ds_read_b64_tr_b16 v[112:113], v144 offset:8192
    ds_read_b64_tr_b16 v[114:115], v144 offset:9216
    ds_read_b64_tr_b16 v[116:117], v145 offset:8192
    ds_read_b64_tr_b16 v[118:119], v145 offset:9216
    s_waitcnt lgkmcnt(12)
    v_mfma_f32_32x32x16_bf16 v[0:15], v[96:99], v[64:67], v[0:15]
    v_mfma_f32_32x32x16_bf16 v[16:31], v[96:99], v[68:71], v[16:31]
    v_mfma_f32_32x32x16_bf16 v[32:47], v[100:103], v[64:67], v[32:47]
    v_mfma_f32_32x32x16_bf16 v[48:63], v[100:103], v[68:71], v[48:63]
    ds_read_b128 v[88:91], v139 offset:0
    ds_read_b128 v[92:95], v139 offset:4096
    ds_read_b64_tr_b16 v[120:121], v144 offset:12288
    ds_read_b64_tr_b16 v[122:123], v144 offset:13312
    ds_read_b64_tr_b16 v[124:125], v145 offset:12288
    ds_read_b64_tr_b16 v[126:127], v145 offset:13312
    s_waitcnt lgkmcnt(12)
    v_mfma_f32_32x32x16_bf16 v[0:15], v[104:107], v[72:75], v[0:15]
    v_mfma_f32_32x32x16_bf16 v[16:31], v[104:107], v[76:79], v[16:31]
    v_mfma_f32_32x32x16_bf16 v[32:47], v[108:111], v[72:75], v[32:47]
    v_mfma_f32_32x32x16_bf16 v[48:63], v[108:111], v[76:79], v[48:63]
    s_sub_u32 s33, s33, 1
    s_cmp_eq_u32 s33, 0
    s_cbranch_scc0 l1_kernel_loop_17
l1_kernel_exit_18:
    s_waitcnt lgkmcnt(6)
    v_mfma_f32_32x32x16_bf16 v[0:15], v[112:115], v[80:83], v[0:15]
    v_mfma_f32_32x32x16_bf16 v[16:31], v[112:115], v[84:87], v[16:31]
    v_mfma_f32_32x32x16_bf16 v[32:47], v[116:119], v[80:83], v[32:47]
    v_mfma_f32_32x32x16_bf16 v[48:63], v[116:119], v[84:87], v[48:63]
    s_waitcnt lgkmcnt(0)
    v_mfma_f32_32x32x16_bf16 v[0:15], v[120:123], v[88:91], v[0:15]
    v_mfma_f32_32x32x16_bf16 v[16:31], v[120:123], v[92:95], v[16:31]
    v_mfma_f32_32x32x16_bf16 v[32:47], v[124:127], v[88:91], v[32:47]
    v_mfma_f32_32x32x16_bf16 v[48:63], v[124:127], v[92:95], v[48:63]
    s_barrier
    v_and_b32 v64, 63, v146
    v_and_b32 v65, 31, v64
    v_lshrrev_b32 v66, 5, v64
    s_mul_i32 s36, s24, 8192
    v_lshlrev_b32 v68, 7, v65
    v_add_u32 v68, s36, v68
    v_and_b32 v69, 7, v65
    v_lshrrev_b32 v70, 3, v64
    v_and_b32 v71, 7, v64
    v_lshlrev_b32 v80, 7, v70
    v_lshl_add_u32 v80, v71, 4, v80
    v_add_u32 v80, s36, v80
    s_mul_i32 s29, s34, 256
    s_mul_i32 s30, s25, 64
    s_add_u32 s29, s29, s30
    s_mov_b32 s53, s29
    v_add_u32 v67, s29, v70
    s_mov_b32 s30, 2048
    v_mul_lo_u32 v67, v67, s30
    v_xor_b32 v71, v71, v70
    v_lshlrev_b32 v71, 4, v71
    s_mul_i32 s54, s35, 128
    s_mul_i32 s30, s26, 64
    s_add_u32 s54, s54, s30
    s_lshl_b32 s29, s54, 1
    v_add3_u32 v67, v67, v71, s29
    v_add_u32 v81, 0, v66
    v_xor_b32 v81, v81, v69
    v_lshl_add_u32 v81, v81, 4, v68
    v_add_u32 v82, 2, v66
    v_xor_b32 v82, v82, v69
    v_lshl_add_u32 v82, v82, 4, v68
    v_add_u32 v83, 4, v66
    v_xor_b32 v83, v83, v69
    v_lshl_add_u32 v83, v83, 4, v68
    v_add_u32 v84, 6, v66
    v_xor_b32 v84, v84, v69
    v_lshl_add_u32 v84, v84, 4, v68
    v_cvt_pk_bf16_f32 v72, v0, v1
    v_cvt_pk_bf16_f32 v73, v2, v3
    v_cvt_pk_bf16_f32 v74, v4, v5
    v_cvt_pk_bf16_f32 v75, v6, v7
    v_cvt_pk_bf16_f32 v76, v8, v9
    v_cvt_pk_bf16_f32 v77, v10, v11
    v_cvt_pk_bf16_f32 v78, v12, v13
    v_cvt_pk_bf16_f32 v79, v14, v15
    v_permlane32_swap_b32 v72, v74
    v_permlane32_swap_b32 v73, v75
    v_permlane32_swap_b32 v76, v78
    v_permlane32_swap_b32 v77, v79
    ds_write_b128 v81, v[72:75] offset:0
    ds_write_b128 v82, v[76:79] offset:0
    v_cvt_pk_bf16_f32 v72, v32, v33
    v_cvt_pk_bf16_f32 v73, v34, v35
    v_cvt_pk_bf16_f32 v74, v36, v37
    v_cvt_pk_bf16_f32 v75, v38, v39
    v_cvt_pk_bf16_f32 v76, v40, v41
    v_cvt_pk_bf16_f32 v77, v42, v43
    v_cvt_pk_bf16_f32 v78, v44, v45
    v_cvt_pk_bf16_f32 v79, v46, v47
    v_permlane32_swap_b32 v72, v74
    v_permlane32_swap_b32 v73, v75
    v_permlane32_swap_b32 v76, v78
    v_permlane32_swap_b32 v77, v79
    ds_write_b128 v83, v[72:75] offset:0
    ds_write_b128 v84, v[76:79] offset:0
    v_cvt_pk_bf16_f32 v72, v16, v17
    v_cvt_pk_bf16_f32 v73, v18, v19
    v_cvt_pk_bf16_f32 v74, v20, v21
    v_cvt_pk_bf16_f32 v75, v22, v23
    v_cvt_pk_bf16_f32 v76, v24, v25
    v_cvt_pk_bf16_f32 v77, v26, v27
    v_cvt_pk_bf16_f32 v78, v28, v29
    v_cvt_pk_bf16_f32 v79, v30, v31
    v_permlane32_swap_b32 v72, v74
    v_permlane32_swap_b32 v73, v75
    v_permlane32_swap_b32 v76, v78
    v_permlane32_swap_b32 v77, v79
    ds_write_b128 v81, v[72:75] offset:4096
    ds_write_b128 v82, v[76:79] offset:4096
    v_cvt_pk_bf16_f32 v72, v48, v49
    v_cvt_pk_bf16_f32 v73, v50, v51
    v_cvt_pk_bf16_f32 v74, v52, v53
    v_cvt_pk_bf16_f32 v75, v54, v55
    v_cvt_pk_bf16_f32 v76, v56, v57
    v_cvt_pk_bf16_f32 v77, v58, v59
    v_cvt_pk_bf16_f32 v78, v60, v61
    v_cvt_pk_bf16_f32 v79, v62, v63
    v_permlane32_swap_b32 v72, v74
    v_permlane32_swap_b32 v73, v75
    v_permlane32_swap_b32 v76, v78
    v_permlane32_swap_b32 v77, v79
    ds_write_b128 v83, v[72:75] offset:4096
    ds_write_b128 v84, v[76:79] offset:4096
    s_waitcnt lgkmcnt(0)
    ds_read_b128 v[0:3], v80 offset:0
    ds_read_b128 v[4:7], v80 offset:1024
    ds_read_b128 v[8:11], v80 offset:2048
    ds_read_b128 v[12:15], v80 offset:3072
    ds_read_b128 v[16:19], v80 offset:4096
    ds_read_b128 v[20:23], v80 offset:5120
    ds_read_b128 v[24:27], v80 offset:6144
    ds_read_b128 v[28:31], v80 offset:7168
    s_waitcnt lgkmcnt(7)
    buffer_store_dwordx4 v[0:3], v67, s[16:19], 0 offen
    v_add_u32 v67, 16384, v67
    s_waitcnt lgkmcnt(6)
    buffer_store_dwordx4 v[4:7], v67, s[16:19], 0 offen
    v_add_u32 v67, 16384, v67
    s_waitcnt lgkmcnt(5)
    buffer_store_dwordx4 v[8:11], v67, s[16:19], 0 offen
    v_add_u32 v67, 16384, v67
    s_waitcnt lgkmcnt(4)
    buffer_store_dwordx4 v[12:15], v67, s[16:19], 0 offen
    v_add_u32 v67, 16384, v67
    s_waitcnt lgkmcnt(3)
    buffer_store_dwordx4 v[16:19], v67, s[16:19], 0 offen
    v_add_u32 v67, 16384, v67
    s_waitcnt lgkmcnt(2)
    buffer_store_dwordx4 v[20:23], v67, s[16:19], 0 offen
    v_add_u32 v67, 16384, v67
    s_waitcnt lgkmcnt(1)
    buffer_store_dwordx4 v[24:27], v67, s[16:19], 0 offen
    v_add_u32 v67, 16384, v67
    s_waitcnt lgkmcnt(0)
    buffer_store_dwordx4 v[28:31], v67, s[16:19], 0 offen
    s_endpgm
l1_kernel_kv_3:
    s_sub_u32 s35, s35, 8
    s_load_dwordx2 s[60:61], s[0:1], 16
    s_load_dwordx2 s[40:41], s[0:1], 96
    s_load_dwordx2 s[6:7], s[0:1], 8
    s_load_dwordx2 s[4:5], s[0:1], 0
    s_waitcnt lgkmcnt(0)
    s_mov_b32 s8, s4
    s_mov_b32 s9, s5
    s_and_b32 s9, s9, 0xffff
    s_mov_b32 s10, 4194304
    s_mov_b32 s11, 0x00020000
    s_mov_b32 s12, s6
    s_mov_b32 s13, s7
    s_and_b32 s13, s13, 0xffff
    s_mov_b32 s14, 6291456
    s_mov_b32 s15, 0x00020000
    s_add_u32 s16, s40, 49348608
    s_addc_u32 s17, s41, 0
    s_and_b32 s17, s17, 0xffff
    s_mov_b32 s18, 2162688
    s_mov_b32 s19, 0x00020000
    s_mov_b32 s31, 0
    s_mov_b32 s32, 0
    s_mov_b32 s33, 16
    v_mov_b32 v146, v0
    v_lshrrev_b32 v148, 6, v0
    s_nop 0
    v_readfirstlane_b32 s24, v148
    s_nop 0
    s_cmp_lt_u32 s24, 8
    s_cbranch_scc1 l1_kernel_comp_19
    s_cmp_lt_u32 s24, 12
    s_cbranch_scc1 l1_kernel_lok_20
    s_endpgm
l1_kernel_lok_20:
    s_sub_u32 s24, s24, 8
    v_and_b32 v4, 63, v0
    s_mul_i32 s27, s24, 8192
    s_mul_i32 s28, s24, 4096
    s_add_u32 s28, s28, 32768
    v_lshrrev_b32 v6, 3, v4
    v_lshrrev_b32 v7, 4, v4
    v_and_b32 v8, 7, v4
    s_mul_i32 s29, s34, 256
    s_mul_i32 s30, s24, 64
    s_add_u32 s29, s29, s30
    s_mov_b32 s30, 2048
    v_add_u32 v9, s29, v6
    v_mul_lo_u32 v9, v9, s30
    v_xor_b32 v10, v7, v8
    v_lshlrev_b32 v10, 4, v10
    v_add_u32 v12, v9, v10
    v_add_u32 v9, s29, v6
    v_add_u32 v9, 8, v9
    v_mul_lo_u32 v9, v9, s30
    v_or_b32 v10, 4, v7
    v_xor_b32 v10, v10, v8
    v_lshlrev_b32 v10, 4, v10
    v_add_u32 v13, v9, v10
    v_add_u32 v9, s29, v6
    v_add_u32 v9, 16, v9
    v_mul_lo_u32 v9, v9, s30
    v_xor_b32 v10, v7, v8
    v_lshlrev_b32 v10, 4, v10
    v_add_u32 v14, v9, v10
    v_add_u32 v9, s29, v6
    v_add_u32 v9, 24, v9
    v_mul_lo_u32 v9, v9, s30
    v_or_b32 v10, 4, v7
    v_xor_b32 v10, v10, v8
    v_lshlrev_b32 v10, 4, v10
    v_add_u32 v15, v9, v10
    v_add_u32 v9, s29, v6
    v_add_u32 v9, 32, v9
    v_mul_lo_u32 v9, v9, s30
    v_xor_b32 v10, v7, v8
    v_lshlrev_b32 v10, 4, v10
    v_add_u32 v16, v9, v10
    v_add_u32 v9, s29, v6
    v_add_u32 v9, 40, v9
    v_mul_lo_u32 v9, v9, s30
    v_or_b32 v10, 4, v7
    v_xor_b32 v10, v10, v8
    v_lshlrev_b32 v10, 4, v10
    v_add_u32 v17, v9, v10
    v_add_u32 v9, s29, v6
    v_add_u32 v9, 48, v9
    v_mul_lo_u32 v9, v9, s30
    v_xor_b32 v10, v7, v8
    v_lshlrev_b32 v10, 4, v10
    v_add_u32 v18, v9, v10
    v_add_u32 v9, s29, v6
    v_add_u32 v9, 56, v9
    v_mul_lo_u32 v9, v9, s30
    v_or_b32 v10, 4, v7
    v_xor_b32 v10, v10, v8
    v_lshlrev_b32 v10, 4, v10
    v_add_u32 v19, v9, v10
    v_lshrrev_b32 v6, 4, v4
    v_and_b32 v8, 15, v4
    v_lshlrev_b32 v7, 2, v6
    v_xor_b32 v8, v8, v7
    v_bfe_u32 v9, v8, 2, 1
    v_lshrrev_b32 v10, 3, v8
    v_and_b32 v8, 3, v8
    v_lshlrev_b32 v8, 4, v8
    v_lshl_add_u32 v8, v9, 11, v8
    v_lshl_add_u32 v8, v10, 6, v8
    s_lshl_b32 s30, s35, 7
    s_add_u32 s30, s30, 2048
    s_mul_i32 s29, s24, 16
    v_add_u32 v8, s30, v8
    s_mov_b32 s30, 6144
    v_add_u32 v9, s29, v6
    v_mul_lo_u32 v9, v9, s30
    v_add_u32 v20, v9, v8
    v_add_u32 v9, s29, v6
    v_add_u32 v9, 4, v9
    v_mul_lo_u32 v9, v9, s30
    v_add_u32 v21, v9, v8
    v_add_u32 v9, s29, v6
    v_add_u32 v9, 8, v9
    v_mul_lo_u32 v9, v9, s30
    v_add_u32 v22, v9, v8
    v_add_u32 v9, s29, v6
    v_add_u32 v9, 12, v9
    v_mul_lo_u32 v9, v9, s30
    v_add_u32 v23, v9, v8
    s_add_u32 m0, s27, 0
    s_nop 0
    buffer_load_dwordx4 v12, s[8:11], s31 offen lds
    s_add_u32 m0, s27, 1024
    s_nop 0
    buffer_load_dwordx4 v13, s[8:11], s31 offen lds
    s_add_u32 m0, s27, 2048
    s_nop 0
    buffer_load_dwordx4 v14, s[8:11], s31 offen lds
    s_add_u32 m0, s27, 3072
    s_nop 0
    buffer_load_dwordx4 v15, s[8:11], s31 offen lds
    s_add_u32 m0, s27, 4096
    s_nop 0
    buffer_load_dwordx4 v16, s[8:11], s31 offen lds
    s_add_u32 m0, s27, 5120
    s_nop 0
    buffer_load_dwordx4 v17, s[8:11], s31 offen lds
    s_add_u32 m0, s27, 6144
    s_nop 0
    buffer_load_dwordx4 v18, s[8:11], s31 offen lds
    s_add_u32 m0, s27, 7168
    s_nop 0
    buffer_load_dwordx4 v19, s[8:11], s31 offen lds
    s_add_u32 m0, s28, 0
    s_nop 0
    buffer_load_dwordx4 v20, s[12:15], s32 offen lds
    s_add_u32 m0, s28, 1024
    s_nop 0
    buffer_load_dwordx4 v21, s[12:15], s32 offen lds
    s_add_u32 m0, s28, 2048
    s_nop 0
    buffer_load_dwordx4 v22, s[12:15], s32 offen lds
    s_add_u32 m0, s28, 3072
    s_nop 0
    buffer_load_dwordx4 v23, s[12:15], s32 offen lds
    s_add_u32 s31, s31, 128
    s_add_u32 s32, s32, 393216
    s_add_u32 m0, s27, 49152
    s_nop 0
    buffer_load_dwordx4 v12, s[8:11], s31 offen lds
    s_add_u32 m0, s27, 50176
    s_nop 0
    buffer_load_dwordx4 v13, s[8:11], s31 offen lds
    s_add_u32 m0, s27, 51200
    s_nop 0
    buffer_load_dwordx4 v14, s[8:11], s31 offen lds
    s_add_u32 m0, s27, 52224
    s_nop 0
    buffer_load_dwordx4 v15, s[8:11], s31 offen lds
    s_add_u32 m0, s27, 53248
    s_nop 0
    buffer_load_dwordx4 v16, s[8:11], s31 offen lds
    s_add_u32 m0, s27, 54272
    s_nop 0
    buffer_load_dwordx4 v17, s[8:11], s31 offen lds
    s_add_u32 m0, s27, 55296
    s_nop 0
    buffer_load_dwordx4 v18, s[8:11], s31 offen lds
    s_add_u32 m0, s27, 56320
    s_nop 0
    buffer_load_dwordx4 v19, s[8:11], s31 offen lds
    s_add_u32 m0, s28, 49152
    s_nop 0
    buffer_load_dwordx4 v20, s[12:15], s32 offen lds
    s_add_u32 m0, s28, 50176
    s_nop 0
    buffer_load_dwordx4 v21, s[12:15], s32 offen lds
    s_add_u32 m0, s28, 51200
    s_nop 0
    buffer_load_dwordx4 v22, s[12:15], s32 offen lds
    s_add_u32 m0, s28, 52224
    s_nop 0
    buffer_load_dwordx4 v23, s[12:15], s32 offen lds
    s_add_u32 s31, s31, 128
    s_add_u32 s32, s32, 393216
l1_kernel_lloop_21:
    s_cmp_lt_u32 s33, 2
    s_cbranch_scc1 l1_kernel_w0_23
    s_waitcnt vmcnt(12)
    s_branch l1_kernel_w1_24
l1_kernel_w0_23:
    s_waitcnt vmcnt(0)
l1_kernel_w1_24:
    s_barrier
    s_cmp_le_u32 s33, 2
    s_cbranch_scc1 l1_kernel_nd_25
    s_add_u32 m0, s27, 98304
    s_nop 0
    buffer_load_dwordx4 v12, s[8:11], s31 offen lds
    s_add_u32 m0, s27, 99328
    s_nop 0
    buffer_load_dwordx4 v13, s[8:11], s31 offen lds
    s_add_u32 m0, s27, 100352
    s_nop 0
    buffer_load_dwordx4 v14, s[8:11], s31 offen lds
    s_add_u32 m0, s27, 101376
    s_nop 0
    buffer_load_dwordx4 v15, s[8:11], s31 offen lds
    s_add_u32 m0, s27, 102400
    s_nop 0
    buffer_load_dwordx4 v16, s[8:11], s31 offen lds
    s_add_u32 m0, s27, 103424
    s_nop 0
    buffer_load_dwordx4 v17, s[8:11], s31 offen lds
    s_add_u32 m0, s27, 104448
    s_nop 0
    buffer_load_dwordx4 v18, s[8:11], s31 offen lds
    s_add_u32 m0, s27, 105472
    s_nop 0
    buffer_load_dwordx4 v19, s[8:11], s31 offen lds
    s_add_u32 m0, s28, 98304
    s_nop 0
    buffer_load_dwordx4 v20, s[12:15], s32 offen lds
    s_add_u32 m0, s28, 99328
    s_nop 0
    buffer_load_dwordx4 v21, s[12:15], s32 offen lds
    s_add_u32 m0, s28, 100352
    s_nop 0
    buffer_load_dwordx4 v22, s[12:15], s32 offen lds
    s_add_u32 m0, s28, 101376
    s_nop 0
    buffer_load_dwordx4 v23, s[12:15], s32 offen lds
    s_add_u32 s31, s31, 128
    s_add_u32 s32, s32, 393216
l1_kernel_nd_25:
    s_sub_u32 s33, s33, 1
    s_cmp_eq_u32 s33, 0
    s_cbranch_scc1 l1_kernel_ldone_22
    s_cmp_lt_u32 s33, 2
    s_cbranch_scc1 l1_kernel_w0_26
    s_waitcnt vmcnt(12)
    s_branch l1_kernel_w1_27
l1_kernel_w0_26:
    s_waitcnt vmcnt(0)
l1_kernel_w1_27:
    s_barrier
    s_cmp_le_u32 s33, 2
    s_cbranch_scc1 l1_kernel_nd_28
    s_add_u32 m0, s27, 0
    s_nop 0
    buffer_load_dwordx4 v12, s[8:11], s31 offen lds
    s_add_u32 m0, s27, 1024
    s_nop 0
    buffer_load_dwordx4 v13, s[8:11], s31 offen lds
    s_add_u32 m0, s27, 2048
    s_nop 0
    buffer_load_dwordx4 v14, s[8:11], s31 offen lds
    s_add_u32 m0, s27, 3072
    s_nop 0
    buffer_load_dwordx4 v15, s[8:11], s31 offen lds
    s_add_u32 m0, s27, 4096
    s_nop 0
    buffer_load_dwordx4 v16, s[8:11], s31 offen lds
    s_add_u32 m0, s27, 5120
    s_nop 0
    buffer_load_dwordx4 v17, s[8:11], s31 offen lds
    s_add_u32 m0, s27, 6144
    s_nop 0
    buffer_load_dwordx4 v18, s[8:11], s31 offen lds
    s_add_u32 m0, s27, 7168
    s_nop 0
    buffer_load_dwordx4 v19, s[8:11], s31 offen lds
    s_add_u32 m0, s28, 0
    s_nop 0
    buffer_load_dwordx4 v20, s[12:15], s32 offen lds
    s_add_u32 m0, s28, 1024
    s_nop 0
    buffer_load_dwordx4 v21, s[12:15], s32 offen lds
    s_add_u32 m0, s28, 2048
    s_nop 0
    buffer_load_dwordx4 v22, s[12:15], s32 offen lds
    s_add_u32 m0, s28, 3072
    s_nop 0
    buffer_load_dwordx4 v23, s[12:15], s32 offen lds
    s_add_u32 s31, s31, 128
    s_add_u32 s32, s32, 393216
l1_kernel_nd_28:
    s_sub_u32 s33, s33, 1
    s_cmp_eq_u32 s33, 0
    s_cbranch_scc1 l1_kernel_ldone_22
    s_cmp_lt_u32 s33, 2
    s_cbranch_scc1 l1_kernel_w0_29
    s_waitcnt vmcnt(12)
    s_branch l1_kernel_w1_30
l1_kernel_w0_29:
    s_waitcnt vmcnt(0)
l1_kernel_w1_30:
    s_barrier
    s_cmp_le_u32 s33, 2
    s_cbranch_scc1 l1_kernel_nd_31
    s_add_u32 m0, s27, 49152
    s_nop 0
    buffer_load_dwordx4 v12, s[8:11], s31 offen lds
    s_add_u32 m0, s27, 50176
    s_nop 0
    buffer_load_dwordx4 v13, s[8:11], s31 offen lds
    s_add_u32 m0, s27, 51200
    s_nop 0
    buffer_load_dwordx4 v14, s[8:11], s31 offen lds
    s_add_u32 m0, s27, 52224
    s_nop 0
    buffer_load_dwordx4 v15, s[8:11], s31 offen lds
    s_add_u32 m0, s27, 53248
    s_nop 0
    buffer_load_dwordx4 v16, s[8:11], s31 offen lds
    s_add_u32 m0, s27, 54272
    s_nop 0
    buffer_load_dwordx4 v17, s[8:11], s31 offen lds
    s_add_u32 m0, s27, 55296
    s_nop 0
    buffer_load_dwordx4 v18, s[8:11], s31 offen lds
    s_add_u32 m0, s27, 56320
    s_nop 0
    buffer_load_dwordx4 v19, s[8:11], s31 offen lds
    s_add_u32 m0, s28, 49152
    s_nop 0
    buffer_load_dwordx4 v20, s[12:15], s32 offen lds
    s_add_u32 m0, s28, 50176
    s_nop 0
    buffer_load_dwordx4 v21, s[12:15], s32 offen lds
    s_add_u32 m0, s28, 51200
    s_nop 0
    buffer_load_dwordx4 v22, s[12:15], s32 offen lds
    s_add_u32 m0, s28, 52224
    s_nop 0
    buffer_load_dwordx4 v23, s[12:15], s32 offen lds
    s_add_u32 s31, s31, 128
    s_add_u32 s32, s32, 393216
l1_kernel_nd_31:
    s_sub_u32 s33, s33, 1
    s_cmp_eq_u32 s33, 0
    s_cbranch_scc0 l1_kernel_lloop_21
l1_kernel_ldone_22:
    s_endpgm
l1_kernel_comp_19:
    v_and_b32 v148, 63, v146
    s_lshr_b32 s25, s24, 1
    s_and_b32 s26, s24, 1
    v_and_b32 v150, 31, v148
    v_lshrrev_b32 v151, 5, v148
    v_lshrrev_b32 v152, 1, v148
    v_and_b32 v152, 7, v152
    s_mul_i32 s29, s25, 64
    v_add_u32 v153, s29, v150
    v_lshlrev_b32 v153, 7, v153
    v_add_u32 v154, 0, v151
    v_xor_b32 v154, v154, v152
    v_lshlrev_b32 v154, 4, v154
    v_add_u32 v128, v153, v154
    v_add_u32 v132, 49152, v128
    v_add_u32 v136, 98304, v128
    v_add_u32 v154, 2, v151
    v_xor_b32 v154, v154, v152
    v_lshlrev_b32 v154, 4, v154
    v_add_u32 v129, v153, v154
    v_add_u32 v133, 49152, v129
    v_add_u32 v137, 98304, v129
    v_add_u32 v154, 4, v151
    v_xor_b32 v154, v154, v152
    v_lshlrev_b32 v154, 4, v154
    v_add_u32 v130, v153, v154
    v_add_u32 v134, 49152, v130
    v_add_u32 v138, 98304, v130
    v_add_u32 v154, 6, v151
    v_xor_b32 v154, v154, v152
    v_lshlrev_b32 v154, 4, v154
    v_add_u32 v131, v153, v154
    v_add_u32 v135, 49152, v131
    v_add_u32 v139, 98304, v131
    v_lshrrev_b32 v150, 4, v148
    v_and_b32 v151, 15, v148
    v_lshrrev_b32 v151, 2, v151
    v_and_b32 v152, 3, v148
    v_lshrrev_b32 v153, 1, v150
    v_lshlrev_b32 v153, 3, v153
    v_add_u32 v153, v153, v151
    v_mul_u32_u24 v153, 256, v153
    v_and_b32 v154, 1, v150
    v_lshlrev_b32 v154, 1, v154
    v_lshrrev_b32 v155, 1, v152
    v_add_u32 v154, v154, v155
    s_mul_i32 s29, s26, 8
    v_add_u32 v154, s29, v154
    v_lshlrev_b32 v155, 2, v151
    v_and_b32 v152, 1, v152
    v_lshlrev_b32 v152, 3, v152
    v_add_u32 v153, v153, v152
    v_add_u32 v153, 32768, v153
    v_add_u32 v140, 0, v154
    v_xor_b32 v140, v140, v155
    v_lshlrev_b32 v140, 4, v140
    v_add_u32 v140, v140, v153
    v_add_u32 v142, 49152, v140
    v_add_u32 v144, 98304, v140
    v_add_u32 v141, 4, v154
    v_xor_b32 v141, v141, v155
    v_lshlrev_b32 v141, 4, v141
    v_add_u32 v141, v141, v153
    v_add_u32 v143, 49152, v141
    v_add_u32 v145, 98304, v141
    v_mov_b32 v0, 0
    v_mov_b32 v1, 0
    v_mov_b32 v2, 0
    v_mov_b32 v3, 0
    v_mov_b32 v4, 0
    v_mov_b32 v5, 0
    v_mov_b32 v6, 0
    v_mov_b32 v7, 0
    v_mov_b32 v8, 0
    v_mov_b32 v9, 0
    v_mov_b32 v10, 0
    v_mov_b32 v11, 0
    v_mov_b32 v12, 0
    v_mov_b32 v13, 0
    v_mov_b32 v14, 0
    v_mov_b32 v15, 0
    v_mov_b32 v16, 0
    v_mov_b32 v17, 0
    v_mov_b32 v18, 0
    v_mov_b32 v19, 0
    v_mov_b32 v20, 0
    v_mov_b32 v21, 0
    v_mov_b32 v22, 0
    v_mov_b32 v23, 0
    v_mov_b32 v24, 0
    v_mov_b32 v25, 0
    v_mov_b32 v26, 0
    v_mov_b32 v27, 0
    v_mov_b32 v28, 0
    v_mov_b32 v29, 0
    v_mov_b32 v30, 0
    v_mov_b32 v31, 0
    v_mov_b32 v32, 0
    v_mov_b32 v33, 0
    v_mov_b32 v34, 0
    v_mov_b32 v35, 0
    v_mov_b32 v36, 0
    v_mov_b32 v37, 0
    v_mov_b32 v38, 0
    v_mov_b32 v39, 0
    v_mov_b32 v40, 0
    v_mov_b32 v41, 0
    v_mov_b32 v42, 0
    v_mov_b32 v43, 0
    v_mov_b32 v44, 0
    v_mov_b32 v45, 0
    v_mov_b32 v46, 0
    v_mov_b32 v47, 0
    v_mov_b32 v48, 0
    v_mov_b32 v49, 0
    v_mov_b32 v50, 0
    v_mov_b32 v51, 0
    v_mov_b32 v52, 0
    v_mov_b32 v53, 0
    v_mov_b32 v54, 0
    v_mov_b32 v55, 0
    v_mov_b32 v56, 0
    v_mov_b32 v57, 0
    v_mov_b32 v58, 0
    v_mov_b32 v59, 0
    v_mov_b32 v60, 0
    v_mov_b32 v61, 0
    v_mov_b32 v62, 0
    v_mov_b32 v63, 0
    v_mov_b32 v80, 0
    v_mov_b32 v81, 0
    v_mov_b32 v82, 0
    v_mov_b32 v83, 0
    v_mov_b32 v84, 0
    v_mov_b32 v85, 0
    v_mov_b32 v86, 0
    v_mov_b32 v87, 0
    v_mov_b32 v112, 0
    v_mov_b32 v113, 0
    v_mov_b32 v114, 0
    v_mov_b32 v115, 0
    v_mov_b32 v116, 0
    v_mov_b32 v117, 0
    v_mov_b32 v118, 0
    v_mov_b32 v119, 0
    v_mov_b32 v88, 0
    v_mov_b32 v89, 0
    v_mov_b32 v90, 0
    v_mov_b32 v91, 0
    v_mov_b32 v92, 0
    v_mov_b32 v93, 0
    v_mov_b32 v94, 0
    v_mov_b32 v95, 0
    v_mov_b32 v120, 0
    v_mov_b32 v121, 0
    v_mov_b32 v122, 0
    v_mov_b32 v123, 0
    v_mov_b32 v124, 0
    v_mov_b32 v125, 0
    v_mov_b32 v126, 0
    v_mov_b32 v127, 0
    s_mov_b32 s20, s60
    s_mov_b32 s21, s61
    s_and_b32 s21, s21, 0xffff
    s_mov_b32 s22, 65536
    s_mov_b32 s23, 0x00020000
    v_and_b32 v148, 31, v146
    v_bfe_u32 v149, v146, 5, 1
    v_lshlrev_b32 v148, 1, v148
    v_lshl_add_u32 v148, v149, 8, v148
    s_lshl_b32 s29, s35, 1
    s_add_u32 s29, s29, s26
    s_lshl_b32 s29, s29, 11
    buffer_load_ushort v64, v148, s[20:23], s29 offen offset:0
    buffer_load_ushort v65, v148, s[20:23], s29 offen offset:64
    buffer_load_ushort v66, v148, s[20:23], s29 offen offset:128
    buffer_load_ushort v67, v148, s[20:23], s29 offen offset:192
    buffer_load_ushort v68, v148, s[20:23], s29 offen offset:512
    buffer_load_ushort v69, v148, s[20:23], s29 offen offset:576
    buffer_load_ushort v70, v148, s[20:23], s29 offen offset:640
    buffer_load_ushort v71, v148, s[20:23], s29 offen offset:704
    buffer_load_ushort v72, v148, s[20:23], s29 offen offset:1024
    buffer_load_ushort v73, v148, s[20:23], s29 offen offset:1088
    buffer_load_ushort v74, v148, s[20:23], s29 offen offset:1152
    buffer_load_ushort v75, v148, s[20:23], s29 offen offset:1216
    buffer_load_ushort v76, v148, s[20:23], s29 offen offset:1536
    buffer_load_ushort v77, v148, s[20:23], s29 offen offset:1600
    buffer_load_ushort v78, v148, s[20:23], s29 offen offset:1664
    buffer_load_ushort v79, v148, s[20:23], s29 offen offset:1728
    s_waitcnt vmcnt(0)
    v_lshl_or_b32 v160, v65, 16, v64
    v_lshl_or_b32 v161, v67, 16, v66
    v_lshl_or_b32 v162, v69, 16, v68
    v_lshl_or_b32 v163, v71, 16, v70
    v_lshl_or_b32 v164, v73, 16, v72
    v_lshl_or_b32 v165, v75, 16, v74
    v_lshl_or_b32 v166, v77, 16, v76
    v_lshl_or_b32 v167, v79, 16, v78
l1_kernel_loop_32:
    s_waitcnt lgkmcnt(0)
    s_barrier
    ds_read_b128 v[64:67], v128 offset:0
    ds_read_b128 v[68:71], v128 offset:4096
    ds_read_b64_tr_b16 v[96:97], v140 offset:0
    ds_read_b64_tr_b16 v[98:99], v140 offset:1024
    ds_read_b64_tr_b16 v[100:101], v141 offset:0
    ds_read_b64_tr_b16 v[102:103], v141 offset:1024
    v_mfma_f32_32x32x16_bf16 v[0:15], v[112:115], v[80:83], v[0:15]
    v_mfma_f32_32x32x16_bf16 v[16:31], v[112:115], v[84:87], v[16:31]
    v_mfma_f32_32x32x16_bf16 v[32:47], v[116:119], v[80:83], v[32:47]
    v_mfma_f32_32x32x16_bf16 v[48:63], v[116:119], v[84:87], v[48:63]
    ds_read_b128 v[72:75], v129 offset:0
    ds_read_b128 v[76:79], v129 offset:4096
    ds_read_b64_tr_b16 v[104:105], v140 offset:4096
    ds_read_b64_tr_b16 v[106:107], v140 offset:5120
    ds_read_b64_tr_b16 v[108:109], v141 offset:4096
    ds_read_b64_tr_b16 v[110:111], v141 offset:5120
    v_mfma_f32_32x32x16_bf16 v[0:15], v[120:123], v[88:91], v[0:15]
    v_mfma_f32_32x32x16_bf16 v[16:31], v[120:123], v[92:95], v[16:31]
    v_mfma_f32_32x32x16_bf16 v[32:47], v[124:127], v[88:91], v[32:47]
    v_mfma_f32_32x32x16_bf16 v[48:63], v[124:127], v[92:95], v[48:63]
    ds_read_b128 v[80:83], v130 offset:0
    ds_read_b128 v[84:87], v130 offset:4096
    ds_read_b64_tr_b16 v[112:113], v140 offset:8192
    ds_read_b64_tr_b16 v[114:115], v140 offset:9216
    ds_read_b64_tr_b16 v[116:117], v141 offset:8192
    ds_read_b64_tr_b16 v[118:119], v141 offset:9216
    s_waitcnt lgkmcnt(12)
    v_mfma_f32_32x32x16_bf16 v[0:15], v[96:99], v[64:67], v[0:15]
    v_mfma_f32_32x32x16_bf16 v[16:31], v[96:99], v[68:71], v[16:31]
    v_mfma_f32_32x32x16_bf16 v[32:47], v[100:103], v[64:67], v[32:47]
    v_mfma_f32_32x32x16_bf16 v[48:63], v[100:103], v[68:71], v[48:63]
    ds_read_b128 v[88:91], v131 offset:0
    ds_read_b128 v[92:95], v131 offset:4096
    ds_read_b64_tr_b16 v[120:121], v140 offset:12288
    ds_read_b64_tr_b16 v[122:123], v140 offset:13312
    ds_read_b64_tr_b16 v[124:125], v141 offset:12288
    ds_read_b64_tr_b16 v[126:127], v141 offset:13312
    s_waitcnt lgkmcnt(12)
    v_mfma_f32_32x32x16_bf16 v[0:15], v[104:107], v[72:75], v[0:15]
    v_mfma_f32_32x32x16_bf16 v[16:31], v[104:107], v[76:79], v[16:31]
    v_mfma_f32_32x32x16_bf16 v[32:47], v[108:111], v[72:75], v[32:47]
    v_mfma_f32_32x32x16_bf16 v[48:63], v[108:111], v[76:79], v[48:63]
    s_sub_u32 s33, s33, 1
    s_cmp_eq_u32 s33, 0
    s_cbranch_scc1 l1_kernel_exit_33
    s_waitcnt lgkmcnt(0)
    s_barrier
    ds_read_b128 v[64:67], v132 offset:0
    ds_read_b128 v[68:71], v132 offset:4096
    ds_read_b64_tr_b16 v[96:97], v142 offset:0
    ds_read_b64_tr_b16 v[98:99], v142 offset:1024
    ds_read_b64_tr_b16 v[100:101], v143 offset:0
    ds_read_b64_tr_b16 v[102:103], v143 offset:1024
    v_mfma_f32_32x32x16_bf16 v[0:15], v[112:115], v[80:83], v[0:15]
    v_mfma_f32_32x32x16_bf16 v[16:31], v[112:115], v[84:87], v[16:31]
    v_mfma_f32_32x32x16_bf16 v[32:47], v[116:119], v[80:83], v[32:47]
    v_mfma_f32_32x32x16_bf16 v[48:63], v[116:119], v[84:87], v[48:63]
    ds_read_b128 v[72:75], v133 offset:0
    ds_read_b128 v[76:79], v133 offset:4096
    ds_read_b64_tr_b16 v[104:105], v142 offset:4096
    ds_read_b64_tr_b16 v[106:107], v142 offset:5120
    ds_read_b64_tr_b16 v[108:109], v143 offset:4096
    ds_read_b64_tr_b16 v[110:111], v143 offset:5120
    v_mfma_f32_32x32x16_bf16 v[0:15], v[120:123], v[88:91], v[0:15]
    v_mfma_f32_32x32x16_bf16 v[16:31], v[120:123], v[92:95], v[16:31]
    v_mfma_f32_32x32x16_bf16 v[32:47], v[124:127], v[88:91], v[32:47]
    v_mfma_f32_32x32x16_bf16 v[48:63], v[124:127], v[92:95], v[48:63]
    ds_read_b128 v[80:83], v134 offset:0
    ds_read_b128 v[84:87], v134 offset:4096
    ds_read_b64_tr_b16 v[112:113], v142 offset:8192
    ds_read_b64_tr_b16 v[114:115], v142 offset:9216
    ds_read_b64_tr_b16 v[116:117], v143 offset:8192
    ds_read_b64_tr_b16 v[118:119], v143 offset:9216
    s_waitcnt lgkmcnt(12)
    v_mfma_f32_32x32x16_bf16 v[0:15], v[96:99], v[64:67], v[0:15]
    v_mfma_f32_32x32x16_bf16 v[16:31], v[96:99], v[68:71], v[16:31]
    v_mfma_f32_32x32x16_bf16 v[32:47], v[100:103], v[64:67], v[32:47]
    v_mfma_f32_32x32x16_bf16 v[48:63], v[100:103], v[68:71], v[48:63]
    ds_read_b128 v[88:91], v135 offset:0
    ds_read_b128 v[92:95], v135 offset:4096
    ds_read_b64_tr_b16 v[120:121], v142 offset:12288
    ds_read_b64_tr_b16 v[122:123], v142 offset:13312
    ds_read_b64_tr_b16 v[124:125], v143 offset:12288
    ds_read_b64_tr_b16 v[126:127], v143 offset:13312
    s_waitcnt lgkmcnt(12)
    v_mfma_f32_32x32x16_bf16 v[0:15], v[104:107], v[72:75], v[0:15]
    v_mfma_f32_32x32x16_bf16 v[16:31], v[104:107], v[76:79], v[16:31]
    v_mfma_f32_32x32x16_bf16 v[32:47], v[108:111], v[72:75], v[32:47]
    v_mfma_f32_32x32x16_bf16 v[48:63], v[108:111], v[76:79], v[48:63]
    s_sub_u32 s33, s33, 1
    s_cmp_eq_u32 s33, 0
    s_cbranch_scc1 l1_kernel_exit_33
    s_waitcnt lgkmcnt(0)
    s_barrier
    ds_read_b128 v[64:67], v136 offset:0
    ds_read_b128 v[68:71], v136 offset:4096
    ds_read_b64_tr_b16 v[96:97], v144 offset:0
    ds_read_b64_tr_b16 v[98:99], v144 offset:1024
    ds_read_b64_tr_b16 v[100:101], v145 offset:0
    ds_read_b64_tr_b16 v[102:103], v145 offset:1024
    v_mfma_f32_32x32x16_bf16 v[0:15], v[112:115], v[80:83], v[0:15]
    v_mfma_f32_32x32x16_bf16 v[16:31], v[112:115], v[84:87], v[16:31]
    v_mfma_f32_32x32x16_bf16 v[32:47], v[116:119], v[80:83], v[32:47]
    v_mfma_f32_32x32x16_bf16 v[48:63], v[116:119], v[84:87], v[48:63]
    ds_read_b128 v[72:75], v137 offset:0
    ds_read_b128 v[76:79], v137 offset:4096
    ds_read_b64_tr_b16 v[104:105], v144 offset:4096
    ds_read_b64_tr_b16 v[106:107], v144 offset:5120
    ds_read_b64_tr_b16 v[108:109], v145 offset:4096
    ds_read_b64_tr_b16 v[110:111], v145 offset:5120
    v_mfma_f32_32x32x16_bf16 v[0:15], v[120:123], v[88:91], v[0:15]
    v_mfma_f32_32x32x16_bf16 v[16:31], v[120:123], v[92:95], v[16:31]
    v_mfma_f32_32x32x16_bf16 v[32:47], v[124:127], v[88:91], v[32:47]
    v_mfma_f32_32x32x16_bf16 v[48:63], v[124:127], v[92:95], v[48:63]
    ds_read_b128 v[80:83], v138 offset:0
    ds_read_b128 v[84:87], v138 offset:4096
    ds_read_b64_tr_b16 v[112:113], v144 offset:8192
    ds_read_b64_tr_b16 v[114:115], v144 offset:9216
    ds_read_b64_tr_b16 v[116:117], v145 offset:8192
    ds_read_b64_tr_b16 v[118:119], v145 offset:9216
    s_waitcnt lgkmcnt(12)
    v_mfma_f32_32x32x16_bf16 v[0:15], v[96:99], v[64:67], v[0:15]
    v_mfma_f32_32x32x16_bf16 v[16:31], v[96:99], v[68:71], v[16:31]
    v_mfma_f32_32x32x16_bf16 v[32:47], v[100:103], v[64:67], v[32:47]
    v_mfma_f32_32x32x16_bf16 v[48:63], v[100:103], v[68:71], v[48:63]
    ds_read_b128 v[88:91], v139 offset:0
    ds_read_b128 v[92:95], v139 offset:4096
    ds_read_b64_tr_b16 v[120:121], v144 offset:12288
    ds_read_b64_tr_b16 v[122:123], v144 offset:13312
    ds_read_b64_tr_b16 v[124:125], v145 offset:12288
    ds_read_b64_tr_b16 v[126:127], v145 offset:13312
    s_waitcnt lgkmcnt(12)
    v_mfma_f32_32x32x16_bf16 v[0:15], v[104:107], v[72:75], v[0:15]
    v_mfma_f32_32x32x16_bf16 v[16:31], v[104:107], v[76:79], v[16:31]
    v_mfma_f32_32x32x16_bf16 v[32:47], v[108:111], v[72:75], v[32:47]
    v_mfma_f32_32x32x16_bf16 v[48:63], v[108:111], v[76:79], v[48:63]
    s_sub_u32 s33, s33, 1
    s_cmp_eq_u32 s33, 0
    s_cbranch_scc0 l1_kernel_loop_32
l1_kernel_exit_33:
    s_waitcnt lgkmcnt(6)
    v_mfma_f32_32x32x16_bf16 v[0:15], v[112:115], v[80:83], v[0:15]
    v_mfma_f32_32x32x16_bf16 v[16:31], v[112:115], v[84:87], v[16:31]
    v_mfma_f32_32x32x16_bf16 v[32:47], v[116:119], v[80:83], v[32:47]
    v_mfma_f32_32x32x16_bf16 v[48:63], v[116:119], v[84:87], v[48:63]
    s_waitcnt lgkmcnt(0)
    v_mfma_f32_32x32x16_bf16 v[0:15], v[120:123], v[88:91], v[0:15]
    v_mfma_f32_32x32x16_bf16 v[16:31], v[120:123], v[92:95], v[16:31]
    v_mfma_f32_32x32x16_bf16 v[32:47], v[124:127], v[88:91], v[32:47]
    v_mfma_f32_32x32x16_bf16 v[48:63], v[124:127], v[92:95], v[48:63]
    s_barrier
    v_and_b32 v120, 63, v146
    v_mov_b32 v127, v146
    v_and_b32 v121, 31, v120
    v_lshrrev_b32 v122, 5, v120
    s_mul_i32 s36, s24, 8192
    s_mov_b32 s58, 0x3fb8aa3b
    s_mov_b32 s59, 0x3fb8aa3b
    v_lshrrev_b32 v112, 4, v120
    v_and_b32 v113, 15, v120
    v_lshrrev_b32 v113, 2, v113
    v_and_b32 v114, 3, v120
    v_lshrrev_b32 v125, 1, v112
    v_lshlrev_b32 v125, 3, v125
    v_add_u32 v125, v125, v113
    v_mul_u32_u24 v125, 128, v125
    v_and_b32 v112, 1, v112
    v_lshl_add_u32 v125, v112, 5, v125
    v_lshl_add_u32 v125, v114, 3, v125
    v_lshrrev_b32 v112, 4, v120
    v_and_b32 v113, 15, v120
    v_lshrrev_b32 v113, 2, v113
    v_and_b32 v114, 3, v120
    v_lshrrev_b32 v126, 1, v112
    v_lshlrev_b32 v126, 3, v126
    v_add_u32 v126, v126, v113
    v_mul_u32_u24 v126, 64, v126
    v_and_b32 v112, 1, v112
    v_lshl_add_u32 v126, v112, 5, v126
    v_lshl_add_u32 v126, v114, 3, v126
    v_add_u32 v125, s36, v125
    v_add_u32 v126, s36, v126
    v_lshlrev_b32 v123, 7, v121
    v_lshl_add_u32 v123, v122, 3, v123
    v_add_u32 v123, s36, v123
    v_lshlrev_b32 v124, 6, v121
    v_lshl_add_u32 v124, v122, 3, v124
    v_add_u32 v124, s36, v124
    v_cvt_pk_bf16_f32 v64, v0, v1
    v_cvt_pk_bf16_f32 v65, v2, v3
    v_cvt_pk_bf16_f32 v66, v4, v5
    v_cvt_pk_bf16_f32 v67, v6, v7
    v_cvt_pk_bf16_f32 v68, v8, v9
    v_cvt_pk_bf16_f32 v69, v10, v11
    v_cvt_pk_bf16_f32 v70, v12, v13
    v_cvt_pk_bf16_f32 v71, v14, v15
    v_cvt_pk_bf16_f32 v72, v16, v17
    v_cvt_pk_bf16_f32 v73, v18, v19
    v_cvt_pk_bf16_f32 v74, v20, v21
    v_cvt_pk_bf16_f32 v75, v22, v23
    v_cvt_pk_bf16_f32 v76, v24, v25
    v_cvt_pk_bf16_f32 v77, v26, v27
    v_cvt_pk_bf16_f32 v78, v28, v29
    v_cvt_pk_bf16_f32 v79, v30, v31
    v_cvt_pk_bf16_f32 v80, v32, v33
    v_cvt_pk_bf16_f32 v81, v34, v35
    v_cvt_pk_bf16_f32 v82, v36, v37
    v_cvt_pk_bf16_f32 v83, v38, v39
    v_cvt_pk_bf16_f32 v84, v40, v41
    v_cvt_pk_bf16_f32 v85, v42, v43
    v_cvt_pk_bf16_f32 v86, v44, v45
    v_cvt_pk_bf16_f32 v87, v46, v47
    ds_write_b64 v124, v[80:81] offset:4096
    ds_write_b64 v124, v[82:83] offset:4112
    ds_write_b64 v124, v[84:85] offset:4128
    ds_write_b64 v124, v[86:87] offset:4144
    v_cvt_pk_bf16_f32 v80, v48, v49
    v_cvt_pk_bf16_f32 v81, v50, v51
    v_cvt_pk_bf16_f32 v82, v52, v53
    v_cvt_pk_bf16_f32 v83, v54, v55
    v_cvt_pk_bf16_f32 v84, v56, v57
    v_cvt_pk_bf16_f32 v85, v58, v59
    v_cvt_pk_bf16_f32 v86, v60, v61
    v_cvt_pk_bf16_f32 v87, v62, v63
    ds_write_b64 v124, v[80:81] offset:6144
    ds_write_b64 v124, v[82:83] offset:6160
    ds_write_b64 v124, v[84:85] offset:6176
    ds_write_b64 v124, v[86:87] offset:6192
    s_waitcnt vmcnt(0)
    v_mfma_f32_32x32x16_bf16 v[32:47], v[160:163], v[64:67], 0
    v_mfma_f32_32x32x16_bf16 v[32:47], v[164:167], v[68:71], v[32:47]
    s_nop 11
    v_cvt_pk_bf16_f32 v112, v32, v33
    v_lshlrev_b32 v32, 16, v112
    v_and_b32 v33, 0xffff0000, v112
    v_cvt_pk_bf16_f32 v112, v34, v35
    v_lshlrev_b32 v34, 16, v112
    v_and_b32 v35, 0xffff0000, v112
    v_cvt_pk_bf16_f32 v112, v36, v37
    v_lshlrev_b32 v36, 16, v112
    v_and_b32 v37, 0xffff0000, v112
    v_cvt_pk_bf16_f32 v112, v38, v39
    v_lshlrev_b32 v38, 16, v112
    v_and_b32 v39, 0xffff0000, v112
    v_cvt_pk_bf16_f32 v112, v40, v41
    v_lshlrev_b32 v40, 16, v112
    v_and_b32 v41, 0xffff0000, v112
    v_cvt_pk_bf16_f32 v112, v42, v43
    v_lshlrev_b32 v42, 16, v112
    v_and_b32 v43, 0xffff0000, v112
    v_cvt_pk_bf16_f32 v112, v44, v45
    v_lshlrev_b32 v44, 16, v112
    v_and_b32 v45, 0xffff0000, v112
    v_cvt_pk_bf16_f32 v112, v46, v47
    v_lshlrev_b32 v46, 16, v112
    v_and_b32 v47, 0xffff0000, v112
    v_max3_f32 v112, v32, v33, v34
    v_min3_f32 v113, v32, v33, v34
    v_max3_f32 v112, v112, v35, v36
    v_min3_f32 v113, v113, v35, v36
    v_max3_f32 v112, v112, v37, v38
    v_min3_f32 v113, v113, v37, v38
    v_max3_f32 v112, v112, v39, v40
    v_min3_f32 v113, v113, v39, v40
    v_max3_f32 v112, v112, v41, v42
    v_min3_f32 v113, v113, v41, v42
    v_max3_f32 v112, v112, v43, v44
    v_min3_f32 v113, v113, v43, v44
    v_max3_f32 v112, v112, v45, v46
    v_min3_f32 v113, v113, v45, v46
    v_max_f32 v112, v112, v47
    v_min_f32 v113, v113, v47
    v_mov_b32 v114, v112
    s_nop 1
    v_permlane32_swap_b32 v112, v114
    v_max_f32 v112, v112, v114
    v_mov_b32 v114, v113
    s_nop 1
    v_permlane32_swap_b32 v113, v114
    v_min_f32 v113, v113, v114
    v_mul_f32 v116, 0xbfb8aa3b, v112
    v_mul_f32 v118, 0x3fb8aa3b, v113
    v_mov_b32 v117, v116
    v_mov_b32 v119, v118
    v_pk_fma_f32 v[80:81], v[32:33], s[58:59], v[116:117]
    v_pk_fma_f32 v[96:97], v[32:33], s[58:59], v[118:119] neg_lo:[1,0,0] neg_hi:[1,0,0]
    v_pk_fma_f32 v[82:83], v[34:35], s[58:59], v[116:117]
    v_pk_fma_f32 v[98:99], v[34:35], s[58:59], v[118:119] neg_lo:[1,0,0] neg_hi:[1,0,0]
    v_pk_fma_f32 v[84:85], v[36:37], s[58:59], v[116:117]
    v_pk_fma_f32 v[100:101], v[36:37], s[58:59], v[118:119] neg_lo:[1,0,0] neg_hi:[1,0,0]
    v_pk_fma_f32 v[86:87], v[38:39], s[58:59], v[116:117]
    v_pk_fma_f32 v[102:103], v[38:39], s[58:59], v[118:119] neg_lo:[1,0,0] neg_hi:[1,0,0]
    v_pk_fma_f32 v[88:89], v[40:41], s[58:59], v[116:117]
    v_pk_fma_f32 v[104:105], v[40:41], s[58:59], v[118:119] neg_lo:[1,0,0] neg_hi:[1,0,0]
    v_pk_fma_f32 v[90:91], v[42:43], s[58:59], v[116:117]
    v_pk_fma_f32 v[106:107], v[42:43], s[58:59], v[118:119] neg_lo:[1,0,0] neg_hi:[1,0,0]
    v_pk_fma_f32 v[92:93], v[44:45], s[58:59], v[116:117]
    v_pk_fma_f32 v[108:109], v[44:45], s[58:59], v[118:119] neg_lo:[1,0,0] neg_hi:[1,0,0]
    v_pk_fma_f32 v[94:95], v[46:47], s[58:59], v[116:117]
    v_pk_fma_f32 v[110:111], v[46:47], s[58:59], v[118:119] neg_lo:[1,0,0] neg_hi:[1,0,0]
    v_exp_f32 v80, v80
    v_exp_f32 v96, v96
    v_exp_f32 v81, v81
    v_exp_f32 v97, v97
    v_exp_f32 v82, v82
    v_exp_f32 v98, v98
    v_exp_f32 v83, v83
    v_exp_f32 v99, v99
    v_exp_f32 v84, v84
    v_exp_f32 v100, v100
    v_exp_f32 v85, v85
    v_exp_f32 v101, v101
    v_exp_f32 v86, v86
    v_exp_f32 v102, v102
    v_exp_f32 v87, v87
    v_exp_f32 v103, v103
    v_exp_f32 v88, v88
    v_exp_f32 v104, v104
    v_exp_f32 v89, v89
    v_exp_f32 v105, v105
    v_exp_f32 v90, v90
    v_exp_f32 v106, v106
    v_exp_f32 v91, v91
    v_exp_f32 v107, v107
    v_exp_f32 v92, v92
    v_exp_f32 v108, v108
    v_exp_f32 v93, v93
    v_exp_f32 v109, v109
    v_exp_f32 v94, v94
    v_exp_f32 v110, v110
    v_exp_f32 v95, v95
    v_exp_f32 v111, v111
    v_pk_add_f32 v[116:117], v[80:81], v[82:83]
    v_pk_add_f32 v[118:119], v[96:97], v[98:99]
    v_pk_add_f32 v[116:117], v[116:117], v[84:85]
    v_pk_add_f32 v[118:119], v[118:119], v[100:101]
    v_pk_add_f32 v[116:117], v[116:117], v[86:87]
    v_pk_add_f32 v[118:119], v[118:119], v[102:103]
    v_pk_add_f32 v[116:117], v[116:117], v[88:89]
    v_pk_add_f32 v[118:119], v[118:119], v[104:105]
    v_pk_add_f32 v[116:117], v[116:117], v[90:91]
    v_pk_add_f32 v[118:119], v[118:119], v[106:107]
    v_pk_add_f32 v[116:117], v[116:117], v[92:93]
    v_pk_add_f32 v[118:119], v[118:119], v[108:109]
    v_pk_add_f32 v[116:117], v[116:117], v[94:95]
    v_pk_add_f32 v[118:119], v[118:119], v[110:111]
    v_add_f32 v112, v116, v117
    v_add_f32 v113, v118, v119
    v_mov_b32 v114, v112
    s_nop 1
    v_permlane32_swap_b32 v112, v114
    v_add_f32 v112, v112, v114
    v_mov_b32 v114, v113
    s_nop 1
    v_permlane32_swap_b32 v113, v114
    v_add_f32 v113, v113, v114
    v_rcp_f32 v116, v112
    v_rcp_f32 v118, v113
    v_mov_b32 v117, v116
    v_mov_b32 v119, v118
    v_pk_mul_f32 v[80:81], v[80:81], v[116:117]
    v_pk_mul_f32 v[96:97], v[96:97], v[118:119]
    v_pk_mul_f32 v[82:83], v[82:83], v[116:117]
    v_pk_mul_f32 v[98:99], v[98:99], v[118:119]
    v_pk_mul_f32 v[84:85], v[84:85], v[116:117]
    v_pk_mul_f32 v[100:101], v[100:101], v[118:119]
    v_pk_mul_f32 v[86:87], v[86:87], v[116:117]
    v_pk_mul_f32 v[102:103], v[102:103], v[118:119]
    v_pk_mul_f32 v[88:89], v[88:89], v[116:117]
    v_pk_mul_f32 v[104:105], v[104:105], v[118:119]
    v_pk_mul_f32 v[90:91], v[90:91], v[116:117]
    v_pk_mul_f32 v[106:107], v[106:107], v[118:119]
    v_pk_mul_f32 v[92:93], v[92:93], v[116:117]
    v_pk_mul_f32 v[108:109], v[108:109], v[118:119]
    v_pk_mul_f32 v[94:95], v[94:95], v[116:117]
    v_pk_mul_f32 v[110:111], v[110:111], v[118:119]
    v_cvt_pk_bf16_f32 v48, v80, v81
    v_cvt_pk_bf16_f32 v56, v96, v97
    v_cvt_pk_bf16_f32 v49, v82, v83
    v_cvt_pk_bf16_f32 v57, v98, v99
    v_cvt_pk_bf16_f32 v50, v84, v85
    v_cvt_pk_bf16_f32 v58, v100, v101
    v_cvt_pk_bf16_f32 v51, v86, v87
    v_cvt_pk_bf16_f32 v59, v102, v103
    v_cvt_pk_bf16_f32 v52, v88, v89
    v_cvt_pk_bf16_f32 v60, v104, v105
    v_cvt_pk_bf16_f32 v53, v90, v91
    v_cvt_pk_bf16_f32 v61, v106, v107
    v_cvt_pk_bf16_f32 v54, v92, v93
    v_cvt_pk_bf16_f32 v62, v108, v109
    v_cvt_pk_bf16_f32 v55, v94, v95
    v_cvt_pk_bf16_f32 v63, v110, v111
    v_mov_b32 v80, 0x3f803f80
    v_mov_b32 v81, 0x3f803f80
    v_mov_b32 v82, 0x3f803f80
    v_mov_b32 v83, 0x3f803f80
    ds_write_b64 v123, v[48:49] offset:0
    ds_write_b64 v123, v[56:57] offset:64
    ds_write_b64 v123, v[50:51] offset:16
    ds_write_b64 v123, v[58:59] offset:80
    ds_write_b64 v123, v[52:53] offset:32
    ds_write_b64 v123, v[60:61] offset:96
    ds_write_b64 v123, v[54:55] offset:48
    ds_write_b64 v123, v[62:63] offset:112
    s_waitcnt lgkmcnt(0)
    ds_read_b64_tr_b16 v[32:33], v125 offset:0
    ds_read_b64_tr_b16 v[34:35], v125 offset:512
    ds_read_b64_tr_b16 v[36:37], v125 offset:64
    ds_read_b64_tr_b16 v[38:39], v125 offset:576
    ds_read_b64_tr_b16 v[40:41], v126 offset:4096
    ds_read_b64_tr_b16 v[42:43], v126 offset:4352
    s_waitcnt lgkmcnt(0)
    v_mfma_f32_32x32x16_bf16 v[128:143], v[32:35], v[40:43], 0
    v_mfma_f32_32x32x16_bf16 v[0:15], v[32:35], v[80:83], 0
    v_mfma_f32_32x32x16_bf16 v[144:159], v[36:39], v[40:43], 0
    v_mfma_f32_32x32x16_bf16 v[16:31], v[36:39], v[80:83], 0
    ds_read_b64_tr_b16 v[32:33], v125 offset:2048
    ds_read_b64_tr_b16 v[34:35], v125 offset:2560
    ds_read_b64_tr_b16 v[36:37], v125 offset:2112
    ds_read_b64_tr_b16 v[38:39], v125 offset:2624
    ds_read_b64_tr_b16 v[40:41], v126 offset:5120
    ds_read_b64_tr_b16 v[42:43], v126 offset:5376
    s_waitcnt lgkmcnt(0)
    v_mfma_f32_32x32x16_bf16 v[128:143], v[32:35], v[40:43], v[128:143]
    v_mfma_f32_32x32x16_bf16 v[0:15], v[32:35], v[80:83], v[0:15]
    v_mfma_f32_32x32x16_bf16 v[144:159], v[36:39], v[40:43], v[144:159]
    v_mfma_f32_32x32x16_bf16 v[16:31], v[36:39], v[80:83], v[16:31]
    v_mfma_f32_32x32x16_bf16 v[32:47], v[160:163], v[72:75], 0
    v_mfma_f32_32x32x16_bf16 v[32:47], v[164:167], v[76:79], v[32:47]
    s_nop 11
    v_cvt_pk_bf16_f32 v112, v32, v33
    v_lshlrev_b32 v32, 16, v112
    v_and_b32 v33, 0xffff0000, v112
    v_cvt_pk_bf16_f32 v112, v34, v35
    v_lshlrev_b32 v34, 16, v112
    v_and_b32 v35, 0xffff0000, v112
    v_cvt_pk_bf16_f32 v112, v36, v37
    v_lshlrev_b32 v36, 16, v112
    v_and_b32 v37, 0xffff0000, v112
    v_cvt_pk_bf16_f32 v112, v38, v39
    v_lshlrev_b32 v38, 16, v112
    v_and_b32 v39, 0xffff0000, v112
    v_cvt_pk_bf16_f32 v112, v40, v41
    v_lshlrev_b32 v40, 16, v112
    v_and_b32 v41, 0xffff0000, v112
    v_cvt_pk_bf16_f32 v112, v42, v43
    v_lshlrev_b32 v42, 16, v112
    v_and_b32 v43, 0xffff0000, v112
    v_cvt_pk_bf16_f32 v112, v44, v45
    v_lshlrev_b32 v44, 16, v112
    v_and_b32 v45, 0xffff0000, v112
    v_cvt_pk_bf16_f32 v112, v46, v47
    v_lshlrev_b32 v46, 16, v112
    v_and_b32 v47, 0xffff0000, v112
    v_max3_f32 v112, v32, v33, v34
    v_min3_f32 v113, v32, v33, v34
    v_max3_f32 v112, v112, v35, v36
    v_min3_f32 v113, v113, v35, v36
    v_max3_f32 v112, v112, v37, v38
    v_min3_f32 v113, v113, v37, v38
    v_max3_f32 v112, v112, v39, v40
    v_min3_f32 v113, v113, v39, v40
    v_max3_f32 v112, v112, v41, v42
    v_min3_f32 v113, v113, v41, v42
    v_max3_f32 v112, v112, v43, v44
    v_min3_f32 v113, v113, v43, v44
    v_max3_f32 v112, v112, v45, v46
    v_min3_f32 v113, v113, v45, v46
    v_max_f32 v112, v112, v47
    v_min_f32 v113, v113, v47
    v_mov_b32 v114, v112
    s_nop 1
    v_permlane32_swap_b32 v112, v114
    v_max_f32 v112, v112, v114
    v_mov_b32 v114, v113
    s_nop 1
    v_permlane32_swap_b32 v113, v114
    v_min_f32 v113, v113, v114
    v_mul_f32 v116, 0xbfb8aa3b, v112
    v_mul_f32 v118, 0x3fb8aa3b, v113
    v_mov_b32 v117, v116
    v_mov_b32 v119, v118
    v_pk_fma_f32 v[80:81], v[32:33], s[58:59], v[116:117]
    v_pk_fma_f32 v[96:97], v[32:33], s[58:59], v[118:119] neg_lo:[1,0,0] neg_hi:[1,0,0]
    v_pk_fma_f32 v[82:83], v[34:35], s[58:59], v[116:117]
    v_pk_fma_f32 v[98:99], v[34:35], s[58:59], v[118:119] neg_lo:[1,0,0] neg_hi:[1,0,0]
    v_pk_fma_f32 v[84:85], v[36:37], s[58:59], v[116:117]
    v_pk_fma_f32 v[100:101], v[36:37], s[58:59], v[118:119] neg_lo:[1,0,0] neg_hi:[1,0,0]
    v_pk_fma_f32 v[86:87], v[38:39], s[58:59], v[116:117]
    v_pk_fma_f32 v[102:103], v[38:39], s[58:59], v[118:119] neg_lo:[1,0,0] neg_hi:[1,0,0]
    v_pk_fma_f32 v[88:89], v[40:41], s[58:59], v[116:117]
    v_pk_fma_f32 v[104:105], v[40:41], s[58:59], v[118:119] neg_lo:[1,0,0] neg_hi:[1,0,0]
    v_pk_fma_f32 v[90:91], v[42:43], s[58:59], v[116:117]
    v_pk_fma_f32 v[106:107], v[42:43], s[58:59], v[118:119] neg_lo:[1,0,0] neg_hi:[1,0,0]
    v_pk_fma_f32 v[92:93], v[44:45], s[58:59], v[116:117]
    v_pk_fma_f32 v[108:109], v[44:45], s[58:59], v[118:119] neg_lo:[1,0,0] neg_hi:[1,0,0]
    v_pk_fma_f32 v[94:95], v[46:47], s[58:59], v[116:117]
    v_pk_fma_f32 v[110:111], v[46:47], s[58:59], v[118:119] neg_lo:[1,0,0] neg_hi:[1,0,0]
    v_exp_f32 v80, v80
    v_exp_f32 v96, v96
    v_exp_f32 v81, v81
    v_exp_f32 v97, v97
    v_exp_f32 v82, v82
    v_exp_f32 v98, v98
    v_exp_f32 v83, v83
    v_exp_f32 v99, v99
    v_exp_f32 v84, v84
    v_exp_f32 v100, v100
    v_exp_f32 v85, v85
    v_exp_f32 v101, v101
    v_exp_f32 v86, v86
    v_exp_f32 v102, v102
    v_exp_f32 v87, v87
    v_exp_f32 v103, v103
    v_exp_f32 v88, v88
    v_exp_f32 v104, v104
    v_exp_f32 v89, v89
    v_exp_f32 v105, v105
    v_exp_f32 v90, v90
    v_exp_f32 v106, v106
    v_exp_f32 v91, v91
    v_exp_f32 v107, v107
    v_exp_f32 v92, v92
    v_exp_f32 v108, v108
    v_exp_f32 v93, v93
    v_exp_f32 v109, v109
    v_exp_f32 v94, v94
    v_exp_f32 v110, v110
    v_exp_f32 v95, v95
    v_exp_f32 v111, v111
    v_pk_add_f32 v[116:117], v[80:81], v[82:83]
    v_pk_add_f32 v[118:119], v[96:97], v[98:99]
    v_pk_add_f32 v[116:117], v[116:117], v[84:85]
    v_pk_add_f32 v[118:119], v[118:119], v[100:101]
    v_pk_add_f32 v[116:117], v[116:117], v[86:87]
    v_pk_add_f32 v[118:119], v[118:119], v[102:103]
    v_pk_add_f32 v[116:117], v[116:117], v[88:89]
    v_pk_add_f32 v[118:119], v[118:119], v[104:105]
    v_pk_add_f32 v[116:117], v[116:117], v[90:91]
    v_pk_add_f32 v[118:119], v[118:119], v[106:107]
    v_pk_add_f32 v[116:117], v[116:117], v[92:93]
    v_pk_add_f32 v[118:119], v[118:119], v[108:109]
    v_pk_add_f32 v[116:117], v[116:117], v[94:95]
    v_pk_add_f32 v[118:119], v[118:119], v[110:111]
    v_add_f32 v112, v116, v117
    v_add_f32 v113, v118, v119
    v_mov_b32 v114, v112
    s_nop 1
    v_permlane32_swap_b32 v112, v114
    v_add_f32 v112, v112, v114
    v_mov_b32 v114, v113
    s_nop 1
    v_permlane32_swap_b32 v113, v114
    v_add_f32 v113, v113, v114
    v_rcp_f32 v116, v112
    v_rcp_f32 v118, v113
    v_mov_b32 v117, v116
    v_mov_b32 v119, v118
    v_pk_mul_f32 v[80:81], v[80:81], v[116:117]
    v_pk_mul_f32 v[96:97], v[96:97], v[118:119]
    v_pk_mul_f32 v[82:83], v[82:83], v[116:117]
    v_pk_mul_f32 v[98:99], v[98:99], v[118:119]
    v_pk_mul_f32 v[84:85], v[84:85], v[116:117]
    v_pk_mul_f32 v[100:101], v[100:101], v[118:119]
    v_pk_mul_f32 v[86:87], v[86:87], v[116:117]
    v_pk_mul_f32 v[102:103], v[102:103], v[118:119]
    v_pk_mul_f32 v[88:89], v[88:89], v[116:117]
    v_pk_mul_f32 v[104:105], v[104:105], v[118:119]
    v_pk_mul_f32 v[90:91], v[90:91], v[116:117]
    v_pk_mul_f32 v[106:107], v[106:107], v[118:119]
    v_pk_mul_f32 v[92:93], v[92:93], v[116:117]
    v_pk_mul_f32 v[108:109], v[108:109], v[118:119]
    v_pk_mul_f32 v[94:95], v[94:95], v[116:117]
    v_pk_mul_f32 v[110:111], v[110:111], v[118:119]
    v_cvt_pk_bf16_f32 v48, v80, v81
    v_cvt_pk_bf16_f32 v56, v96, v97
    v_cvt_pk_bf16_f32 v49, v82, v83
    v_cvt_pk_bf16_f32 v57, v98, v99
    v_cvt_pk_bf16_f32 v50, v84, v85
    v_cvt_pk_bf16_f32 v58, v100, v101
    v_cvt_pk_bf16_f32 v51, v86, v87
    v_cvt_pk_bf16_f32 v59, v102, v103
    v_cvt_pk_bf16_f32 v52, v88, v89
    v_cvt_pk_bf16_f32 v60, v104, v105
    v_cvt_pk_bf16_f32 v53, v90, v91
    v_cvt_pk_bf16_f32 v61, v106, v107
    v_cvt_pk_bf16_f32 v54, v92, v93
    v_cvt_pk_bf16_f32 v62, v108, v109
    v_cvt_pk_bf16_f32 v55, v94, v95
    v_cvt_pk_bf16_f32 v63, v110, v111
    v_mov_b32 v80, 0x3f803f80
    v_mov_b32 v81, 0x3f803f80
    v_mov_b32 v82, 0x3f803f80
    v_mov_b32 v83, 0x3f803f80
    ds_write_b64 v123, v[48:49] offset:0
    ds_write_b64 v123, v[56:57] offset:64
    ds_write_b64 v123, v[50:51] offset:16
    ds_write_b64 v123, v[58:59] offset:80
    ds_write_b64 v123, v[52:53] offset:32
    ds_write_b64 v123, v[60:61] offset:96
    ds_write_b64 v123, v[54:55] offset:48
    ds_write_b64 v123, v[62:63] offset:112
    s_waitcnt lgkmcnt(0)
    ds_read_b64_tr_b16 v[32:33], v125 offset:0
    ds_read_b64_tr_b16 v[34:35], v125 offset:512
    ds_read_b64_tr_b16 v[36:37], v125 offset:64
    ds_read_b64_tr_b16 v[38:39], v125 offset:576
    ds_read_b64_tr_b16 v[40:41], v126 offset:6144
    ds_read_b64_tr_b16 v[42:43], v126 offset:6400
    s_waitcnt lgkmcnt(0)
    v_mfma_f32_32x32x16_bf16 v[128:143], v[32:35], v[40:43], v[128:143]
    v_mfma_f32_32x32x16_bf16 v[0:15], v[32:35], v[80:83], v[0:15]
    v_mfma_f32_32x32x16_bf16 v[144:159], v[36:39], v[40:43], v[144:159]
    v_mfma_f32_32x32x16_bf16 v[16:31], v[36:39], v[80:83], v[16:31]
    ds_read_b64_tr_b16 v[32:33], v125 offset:2048
    ds_read_b64_tr_b16 v[34:35], v125 offset:2560
    ds_read_b64_tr_b16 v[36:37], v125 offset:2112
    ds_read_b64_tr_b16 v[38:39], v125 offset:2624
    ds_read_b64_tr_b16 v[40:41], v126 offset:7168
    ds_read_b64_tr_b16 v[42:43], v126 offset:7424
    s_waitcnt lgkmcnt(0)
    v_mfma_f32_32x32x16_bf16 v[128:143], v[32:35], v[40:43], v[128:143]
    v_mfma_f32_32x32x16_bf16 v[0:15], v[32:35], v[80:83], v[0:15]
    v_mfma_f32_32x32x16_bf16 v[144:159], v[36:39], v[40:43], v[144:159]
    v_mfma_f32_32x32x16_bf16 v[16:31], v[36:39], v[80:83], v[16:31]
    s_barrier
    v_lshlrev_b32 v32, 2, v121
    v_lshl_add_u32 v32, v122, 9, v32
    s_lshl_b32 s29, s24, 13
    v_add_u32 v32, s29, v32
    s_nop 3
    ds_write_b32 v32, v128 offset:0
    ds_write_b32 v32, v129 offset:128
    ds_write_b32 v32, v130 offset:256
    ds_write_b32 v32, v131 offset:384
    ds_write_b32 v32, v132 offset:1024
    ds_write_b32 v32, v133 offset:1152
    ds_write_b32 v32, v134 offset:1280
    ds_write_b32 v32, v135 offset:1408
    ds_write_b32 v32, v136 offset:2048
    ds_write_b32 v32, v137 offset:2176
    ds_write_b32 v32, v138 offset:2304
    ds_write_b32 v32, v139 offset:2432
    ds_write_b32 v32, v140 offset:3072
    ds_write_b32 v32, v141 offset:3200
    ds_write_b32 v32, v142 offset:3328
    ds_write_b32 v32, v143 offset:3456
    ds_write_b32 v32, v144 offset:4096
    ds_write_b32 v32, v145 offset:4224
    ds_write_b32 v32, v146 offset:4352
    ds_write_b32 v32, v147 offset:4480
    ds_write_b32 v32, v148 offset:5120
    ds_write_b32 v32, v149 offset:5248
    ds_write_b32 v32, v150 offset:5376
    ds_write_b32 v32, v151 offset:5504
    ds_write_b32 v32, v152 offset:6144
    ds_write_b32 v32, v153 offset:6272
    ds_write_b32 v32, v154 offset:6400
    ds_write_b32 v32, v155 offset:6528
    ds_write_b32 v32, v156 offset:7168
    ds_write_b32 v32, v157 offset:7296
    ds_write_b32 v32, v158 offset:7424
    ds_write_b32 v32, v159 offset:7552
    v_lshlrev_b32 v33, 4, v122
    s_lshl_b32 s29, s24, 8
    v_add_u32 v33, s29, v33
    v_add_u32 v33, 65536, v33
    v_cmp_eq_u32 vcc, 0, v121
    s_nop 0
    s_and_saveexec_b64 s[56:57], vcc
    ds_write_b32 v33, v0 offset:0
    ds_write_b32 v33, v1 offset:4
    ds_write_b32 v33, v2 offset:8
    ds_write_b32 v33, v3 offset:12
    ds_write_b32 v33, v4 offset:32
    ds_write_b32 v33, v5 offset:36
    ds_write_b32 v33, v6 offset:40
    ds_write_b32 v33, v7 offset:44
    ds_write_b32 v33, v8 offset:64
    ds_write_b32 v33, v9 offset:68
    ds_write_b32 v33, v10 offset:72
    ds_write_b32 v33, v11 offset:76
    ds_write_b32 v33, v12 offset:96
    ds_write_b32 v33, v13 offset:100
    ds_write_b32 v33, v14 offset:104
    ds_write_b32 v33, v15 offset:108
    ds_write_b32 v33, v16 offset:128
    ds_write_b32 v33, v17 offset:132
    ds_write_b32 v33, v18 offset:136
    ds_write_b32 v33, v19 offset:140
    ds_write_b32 v33, v20 offset:160
    ds_write_b32 v33, v21 offset:164
    ds_write_b32 v33, v22 offset:168
    ds_write_b32 v33, v23 offset:172
    ds_write_b32 v33, v24 offset:192
    ds_write_b32 v33, v25 offset:196
    ds_write_b32 v33, v26 offset:200
    ds_write_b32 v33, v27 offset:204
    ds_write_b32 v33, v28 offset:224
    ds_write_b32 v33, v29 offset:228
    ds_write_b32 v33, v30 offset:232
    ds_write_b32 v33, v31 offset:236
    s_mov_b64 exec, s[56:57]
    s_waitcnt lgkmcnt(0)
    s_barrier
    v_lshrrev_b32 v34, 8, v127
    v_and_b32 v35, 255, v127
    s_lshl_b32 s29, s35, 4
    s_add_u32 s29, s29, s34
    s_mul_i32 s29, s29, 8448
    v_mul_u32_u24 v36, 67584, v34
    v_mov_b32 v37, v36
    v_lshl_add_u32 v36, v35, 4, v36
    v_lshrrev_b32 v40, 7, v35
    v_lshlrev_b32 v40, 4, v40
    v_and_b32 v41, 1, v35
    v_lshl_add_u32 v40, v41, 3, v40
    v_bfe_u32 v41, v35, 6, 1
    v_lshl_add_u32 v40, v41, 2, v40
    v_lshlrev_b32 v42, 7, v40
    v_bfe_u32 v41, v35, 1, 5
    v_lshl_add_u32 v42, v41, 2, v42
    v_lshl_add_u32 v42, v34, 13, v42
    ds_read_b32 v48, v42 offset:0
    ds_read_b32 v49, v42 offset:128
    ds_read_b32 v50, v42 offset:256
    ds_read_b32 v51, v42 offset:384
    ds_read_b32 v52, v42 offset:16384
    ds_read_b32 v53, v42 offset:16512
    ds_read_b32 v54, v42 offset:16640
    ds_read_b32 v55, v42 offset:16768
    ds_read_b32 v56, v42 offset:32768
    ds_read_b32 v57, v42 offset:32896
    ds_read_b32 v58, v42 offset:33024
    ds_read_b32 v59, v42 offset:33152
    ds_read_b32 v60, v42 offset:49152
    ds_read_b32 v61, v42 offset:49280
    ds_read_b32 v62, v42 offset:49408
    ds_read_b32 v63, v42 offset:49536
    s_waitcnt lgkmcnt(0)
    v_add_f32 v48, v48, v52
    v_add_f32 v56, v56, v60
    v_add_f32 v44, v48, v56
    v_add_f32 v49, v49, v53
    v_add_f32 v57, v57, v61
    v_add_f32 v45, v49, v57
    v_add_f32 v50, v50, v54
    v_add_f32 v58, v58, v62
    v_add_f32 v46, v50, v58
    v_add_f32 v51, v51, v55
    v_add_f32 v59, v59, v63
    v_add_f32 v47, v51, v59
    buffer_store_dwordx4 v[44:47], v36, s[16:19], s29 offen
    v_lshrrev_b32 v40, 7, v35
    v_lshlrev_b32 v40, 4, v40
    v_add_u32 v40, 32, v40
    v_and_b32 v41, 1, v35
    v_lshl_add_u32 v40, v41, 3, v40
    v_bfe_u32 v41, v35, 6, 1
    v_lshl_add_u32 v40, v41, 2, v40
    v_lshlrev_b32 v42, 7, v40
    v_bfe_u32 v41, v35, 1, 5
    v_lshl_add_u32 v42, v41, 2, v42
    v_lshl_add_u32 v42, v34, 13, v42
    ds_read_b32 v48, v42 offset:0
    ds_read_b32 v49, v42 offset:128
    ds_read_b32 v50, v42 offset:256
    ds_read_b32 v51, v42 offset:384
    ds_read_b32 v52, v42 offset:16384
    ds_read_b32 v53, v42 offset:16512
    ds_read_b32 v54, v42 offset:16640
    ds_read_b32 v55, v42 offset:16768
    ds_read_b32 v56, v42 offset:32768
    ds_read_b32 v57, v42 offset:32896
    ds_read_b32 v58, v42 offset:33024
    ds_read_b32 v59, v42 offset:33152
    ds_read_b32 v60, v42 offset:49152
    ds_read_b32 v61, v42 offset:49280
    ds_read_b32 v62, v42 offset:49408
    ds_read_b32 v63, v42 offset:49536
    s_waitcnt lgkmcnt(0)
    v_add_f32 v48, v48, v52
    v_add_f32 v56, v56, v60
    v_add_f32 v44, v48, v56
    v_add_f32 v49, v49, v53
    v_add_f32 v57, v57, v61
    v_add_f32 v45, v49, v57
    v_add_f32 v50, v50, v54
    v_add_f32 v58, v58, v62
    v_add_f32 v46, v50, v58
    v_add_f32 v51, v51, v55
    v_add_f32 v59, v59, v63
    v_add_f32 v47, v51, v59
    v_add_u32 v36, 4096, v36
    buffer_store_dwordx4 v[44:47], v36, s[16:19], s29 offen
    v_cmp_gt_u32 vcc, 128, v127
    s_nop 0
    s_and_saveexec_b64 s[56:57], vcc
    s_cbranch_execz l1_kernel_kvz_34
    v_lshrrev_b32 v34, 6, v127
    v_and_b32 v35, 63, v127
    v_lshlrev_b32 v40, 2, v35
    v_lshl_add_u32 v40, v34, 8, v40
    v_add_u32 v40, 65536, v40
    ds_read_b32 v48, v40 offset:0
    ds_read_b32 v49, v40 offset:512
    ds_read_b32 v50, v40 offset:1024
    ds_read_b32 v51, v40 offset:1536
    s_waitcnt lgkmcnt(0)
    v_add_f32 v48, v48, v49
    v_add_f32 v50, v50, v51
    v_add_f32 v48, v48, v50
    v_lshrrev_b32 v41, 4, v35
    v_bfe_u32 v42, v35, 2, 1
    v_lshl_add_u32 v41, v41, 1, v42
    v_lshlrev_b32 v41, 3, v41
    v_bfe_u32 v42, v35, 3, 1
    v_lshl_add_u32 v41, v42, 2, v41
    v_and_b32 v42, 3, v35
    v_add_u32 v41, v41, v42
    v_lshlrev_b32 v41, 2, v41
    v_mul_u32_u24 v42, 67584, v34
    v_add_u32 v41, v41, v42
    v_add_u32 v41, 8192, v41
    buffer_store_dword v48, v41, s[16:19], s29 offen
l1_kernel_kvz_34:
    s_endpgm
l1_kernel_w1_2:
    s_sub_u32 s35, s35, 24
    s_load_dwordx2 s[40:41], s[0:1], 96
    s_load_dwordx2 s[6:7], s[0:1], 40
    s_waitcnt lgkmcnt(0)
    s_mov_b32 s8, s40
    s_mov_b32 s9, s41
    s_and_b32 s9, s9, 0xffff
    s_mov_b32 s10, 4194304
    s_mov_b32 s11, 0x00020000
    s_mov_b32 s12, s6
    s_mov_b32 s13, s7
    s_and_b32 s13, s13, 0xffff
    s_mov_b32 s14, 2097152
    s_mov_b32 s15, 0x00020000
    s_add_u32 s16, s40, 16781312
    s_addc_u32 s17, s41, 0
    s_and_b32 s17, s17, 0xffff
    s_mov_b32 s18, 4194304
    s_mov_b32 s19, 0x00020000
    s_mov_b32 s31, 0
    s_mov_b32 s32, 0
    s_mov_b32 s33, 16
    v_mov_b32 v146, v0
    v_lshrrev_b32 v148, 6, v0
    s_nop 0
    v_readfirstlane_b32 s24, v148
    s_nop 0
    s_cmp_lt_u32 s24, 8
    s_cbranch_scc1 l1_kernel_comp_35
    s_cmp_lt_u32 s24, 12
    s_cbranch_scc1 l1_kernel_lok_36
    s_endpgm
l1_kernel_lok_36:
    s_sub_u32 s24, s24, 8
    v_and_b32 v4, 63, v0
    s_mul_i32 s27, s24, 8192
    s_mul_i32 s28, s24, 4096
    s_add_u32 s28, s28, 32768
    v_lshrrev_b32 v6, 3, v4
    v_lshrrev_b32 v7, 4, v4
    v_and_b32 v8, 7, v4
    s_mul_i32 s29, s34, 256
    s_mul_i32 s30, s24, 64
    s_add_u32 s29, s29, s30
    s_mov_b32 s30, 2048
    v_add_u32 v9, s29, v6
    v_mul_lo_u32 v9, v9, s30
    v_xor_b32 v10, v7, v8
    v_lshlrev_b32 v10, 4, v10
    v_add_u32 v12, v9, v10
    v_add_u32 v9, s29, v6
    v_add_u32 v9, 8, v9
    v_mul_lo_u32 v9, v9, s30
    v_or_b32 v10, 4, v7
    v_xor_b32 v10, v10, v8
    v_lshlrev_b32 v10, 4, v10
    v_add_u32 v13, v9, v10
    v_add_u32 v9, s29, v6
    v_add_u32 v9, 16, v9
    v_mul_lo_u32 v9, v9, s30
    v_xor_b32 v10, v7, v8
    v_lshlrev_b32 v10, 4, v10
    v_add_u32 v14, v9, v10
    v_add_u32 v9, s29, v6
    v_add_u32 v9, 24, v9
    v_mul_lo_u32 v9, v9, s30
    v_or_b32 v10, 4, v7
    v_xor_b32 v10, v10, v8
    v_lshlrev_b32 v10, 4, v10
    v_add_u32 v15, v9, v10
    v_add_u32 v9, s29, v6
    v_add_u32 v9, 32, v9
    v_mul_lo_u32 v9, v9, s30
    v_xor_b32 v10, v7, v8
    v_lshlrev_b32 v10, 4, v10
    v_add_u32 v16, v9, v10
    v_add_u32 v9, s29, v6
    v_add_u32 v9, 40, v9
    v_mul_lo_u32 v9, v9, s30
    v_or_b32 v10, 4, v7
    v_xor_b32 v10, v10, v8
    v_lshlrev_b32 v10, 4, v10
    v_add_u32 v17, v9, v10
    v_add_u32 v9, s29, v6
    v_add_u32 v9, 48, v9
    v_mul_lo_u32 v9, v9, s30
    v_xor_b32 v10, v7, v8
    v_lshlrev_b32 v10, 4, v10
    v_add_u32 v18, v9, v10
    v_add_u32 v9, s29, v6
    v_add_u32 v9, 56, v9
    v_mul_lo_u32 v9, v9, s30
    v_or_b32 v10, 4, v7
    v_xor_b32 v10, v10, v8
    v_lshlrev_b32 v10, 4, v10
    v_add_u32 v19, v9, v10
    v_lshrrev_b32 v6, 4, v4
    v_and_b32 v8, 15, v4
    v_lshlrev_b32 v7, 2, v6
    v_xor_b32 v8, v8, v7
    v_lshlrev_b32 v8, 4, v8
    s_mul_i32 s30, s35, 256
    s_mul_i32 s29, s24, 16
    v_add_u32 v8, s30, v8
    s_mov_b32 s30, 2048
    v_add_u32 v9, s29, v6
    v_mul_lo_u32 v9, v9, s30
    v_add_u32 v20, v9, v8
    v_add_u32 v9, s29, v6
    v_add_u32 v9, 4, v9
    v_mul_lo_u32 v9, v9, s30
    v_add_u32 v21, v9, v8
    v_add_u32 v9, s29, v6
    v_add_u32 v9, 8, v9
    v_mul_lo_u32 v9, v9, s30
    v_add_u32 v22, v9, v8
    v_add_u32 v9, s29, v6
    v_add_u32 v9, 12, v9
    v_mul_lo_u32 v9, v9, s30
    v_add_u32 v23, v9, v8
    s_add_u32 m0, s27, 0
    s_nop 0
    buffer_load_dwordx4 v12, s[8:11], s31 offen lds
    s_add_u32 m0, s27, 1024
    s_nop 0
    buffer_load_dwordx4 v13, s[8:11], s31 offen lds
    s_add_u32 m0, s27, 2048
    s_nop 0
    buffer_load_dwordx4 v14, s[8:11], s31 offen lds
    s_add_u32 m0, s27, 3072
    s_nop 0
    buffer_load_dwordx4 v15, s[8:11], s31 offen lds
    s_add_u32 m0, s27, 4096
    s_nop 0
    buffer_load_dwordx4 v16, s[8:11], s31 offen lds
    s_add_u32 m0, s27, 5120
    s_nop 0
    buffer_load_dwordx4 v17, s[8:11], s31 offen lds
    s_add_u32 m0, s27, 6144
    s_nop 0
    buffer_load_dwordx4 v18, s[8:11], s31 offen lds
    s_add_u32 m0, s27, 7168
    s_nop 0
    buffer_load_dwordx4 v19, s[8:11], s31 offen lds
    s_add_u32 m0, s28, 0
    s_nop 0
    buffer_load_dwordx4 v20, s[12:15], s32 offen lds
    s_add_u32 m0, s28, 1024
    s_nop 0
    buffer_load_dwordx4 v21, s[12:15], s32 offen lds
    s_add_u32 m0, s28, 2048
    s_nop 0
    buffer_load_dwordx4 v22, s[12:15], s32 offen lds
    s_add_u32 m0, s28, 3072
    s_nop 0
    buffer_load_dwordx4 v23, s[12:15], s32 offen lds
    s_add_u32 s31, s31, 128
    s_add_u32 s32, s32, 131072
    s_add_u32 m0, s27, 49152
    s_nop 0
    buffer_load_dwordx4 v12, s[8:11], s31 offen lds
    s_add_u32 m0, s27, 50176
    s_nop 0
    buffer_load_dwordx4 v13, s[8:11], s31 offen lds
    s_add_u32 m0, s27, 51200
    s_nop 0
    buffer_load_dwordx4 v14, s[8:11], s31 offen lds
    s_add_u32 m0, s27, 52224
    s_nop 0
    buffer_load_dwordx4 v15, s[8:11], s31 offen lds
    s_add_u32 m0, s27, 53248
    s_nop 0
    buffer_load_dwordx4 v16, s[8:11], s31 offen lds
    s_add_u32 m0, s27, 54272
    s_nop 0
    buffer_load_dwordx4 v17, s[8:11], s31 offen lds
    s_add_u32 m0, s27, 55296
    s_nop 0
    buffer_load_dwordx4 v18, s[8:11], s31 offen lds
    s_add_u32 m0, s27, 56320
    s_nop 0
    buffer_load_dwordx4 v19, s[8:11], s31 offen lds
    s_add_u32 m0, s28, 49152
    s_nop 0
    buffer_load_dwordx4 v20, s[12:15], s32 offen lds
    s_add_u32 m0, s28, 50176
    s_nop 0
    buffer_load_dwordx4 v21, s[12:15], s32 offen lds
    s_add_u32 m0, s28, 51200
    s_nop 0
    buffer_load_dwordx4 v22, s[12:15], s32 offen lds
    s_add_u32 m0, s28, 52224
    s_nop 0
    buffer_load_dwordx4 v23, s[12:15], s32 offen lds
    s_add_u32 s31, s31, 128
    s_add_u32 s32, s32, 131072
l1_kernel_lloop_37:
    s_cmp_lt_u32 s33, 2
    s_cbranch_scc1 l1_kernel_w0_39
    s_waitcnt vmcnt(12)
    s_branch l1_kernel_w1_40
l1_kernel_w0_39:
    s_waitcnt vmcnt(0)
l1_kernel_w1_40:
    s_barrier
    s_cmp_le_u32 s33, 2
    s_cbranch_scc1 l1_kernel_nd_41
    s_add_u32 m0, s27, 98304
    s_nop 0
    buffer_load_dwordx4 v12, s[8:11], s31 offen lds
    s_add_u32 m0, s27, 99328
    s_nop 0
    buffer_load_dwordx4 v13, s[8:11], s31 offen lds
    s_add_u32 m0, s27, 100352
    s_nop 0
    buffer_load_dwordx4 v14, s[8:11], s31 offen lds
    s_add_u32 m0, s27, 101376
    s_nop 0
    buffer_load_dwordx4 v15, s[8:11], s31 offen lds
    s_add_u32 m0, s27, 102400
    s_nop 0
    buffer_load_dwordx4 v16, s[8:11], s31 offen lds
    s_add_u32 m0, s27, 103424
    s_nop 0
    buffer_load_dwordx4 v17, s[8:11], s31 offen lds
    s_add_u32 m0, s27, 104448
    s_nop 0
    buffer_load_dwordx4 v18, s[8:11], s31 offen lds
    s_add_u32 m0, s27, 105472
    s_nop 0
    buffer_load_dwordx4 v19, s[8:11], s31 offen lds
    s_add_u32 m0, s28, 98304
    s_nop 0
    buffer_load_dwordx4 v20, s[12:15], s32 offen lds
    s_add_u32 m0, s28, 99328
    s_nop 0
    buffer_load_dwordx4 v21, s[12:15], s32 offen lds
    s_add_u32 m0, s28, 100352
    s_nop 0
    buffer_load_dwordx4 v22, s[12:15], s32 offen lds
    s_add_u32 m0, s28, 101376
    s_nop 0
    buffer_load_dwordx4 v23, s[12:15], s32 offen lds
    s_add_u32 s31, s31, 128
    s_add_u32 s32, s32, 131072
l1_kernel_nd_41:
    s_sub_u32 s33, s33, 1
    s_cmp_eq_u32 s33, 0
    s_cbranch_scc1 l1_kernel_ldone_38
    s_cmp_lt_u32 s33, 2
    s_cbranch_scc1 l1_kernel_w0_42
    s_waitcnt vmcnt(12)
    s_branch l1_kernel_w1_43
l1_kernel_w0_42:
    s_waitcnt vmcnt(0)
l1_kernel_w1_43:
    s_barrier
    s_cmp_le_u32 s33, 2
    s_cbranch_scc1 l1_kernel_nd_44
    s_add_u32 m0, s27, 0
    s_nop 0
    buffer_load_dwordx4 v12, s[8:11], s31 offen lds
    s_add_u32 m0, s27, 1024
    s_nop 0
    buffer_load_dwordx4 v13, s[8:11], s31 offen lds
    s_add_u32 m0, s27, 2048
    s_nop 0
    buffer_load_dwordx4 v14, s[8:11], s31 offen lds
    s_add_u32 m0, s27, 3072
    s_nop 0
    buffer_load_dwordx4 v15, s[8:11], s31 offen lds
    s_add_u32 m0, s27, 4096
    s_nop 0
    buffer_load_dwordx4 v16, s[8:11], s31 offen lds
    s_add_u32 m0, s27, 5120
    s_nop 0
    buffer_load_dwordx4 v17, s[8:11], s31 offen lds
    s_add_u32 m0, s27, 6144
    s_nop 0
    buffer_load_dwordx4 v18, s[8:11], s31 offen lds
    s_add_u32 m0, s27, 7168
    s_nop 0
    buffer_load_dwordx4 v19, s[8:11], s31 offen lds
    s_add_u32 m0, s28, 0
    s_nop 0
    buffer_load_dwordx4 v20, s[12:15], s32 offen lds
    s_add_u32 m0, s28, 1024
    s_nop 0
    buffer_load_dwordx4 v21, s[12:15], s32 offen lds
    s_add_u32 m0, s28, 2048
    s_nop 0
    buffer_load_dwordx4 v22, s[12:15], s32 offen lds
    s_add_u32 m0, s28, 3072
    s_nop 0
    buffer_load_dwordx4 v23, s[12:15], s32 offen lds
    s_add_u32 s31, s31, 128
    s_add_u32 s32, s32, 131072
l1_kernel_nd_44:
    s_sub_u32 s33, s33, 1
    s_cmp_eq_u32 s33, 0
    s_cbranch_scc1 l1_kernel_ldone_38
    s_cmp_lt_u32 s33, 2
    s_cbranch_scc1 l1_kernel_w0_45
    s_waitcnt vmcnt(12)
    s_branch l1_kernel_w1_46
l1_kernel_w0_45:
    s_waitcnt vmcnt(0)
l1_kernel_w1_46:
    s_barrier
    s_cmp_le_u32 s33, 2
    s_cbranch_scc1 l1_kernel_nd_47
    s_add_u32 m0, s27, 49152
    s_nop 0
    buffer_load_dwordx4 v12, s[8:11], s31 offen lds
    s_add_u32 m0, s27, 50176
    s_nop 0
    buffer_load_dwordx4 v13, s[8:11], s31 offen lds
    s_add_u32 m0, s27, 51200
    s_nop 0
    buffer_load_dwordx4 v14, s[8:11], s31 offen lds
    s_add_u32 m0, s27, 52224
    s_nop 0
    buffer_load_dwordx4 v15, s[8:11], s31 offen lds
    s_add_u32 m0, s27, 53248
    s_nop 0
    buffer_load_dwordx4 v16, s[8:11], s31 offen lds
    s_add_u32 m0, s27, 54272
    s_nop 0
    buffer_load_dwordx4 v17, s[8:11], s31 offen lds
    s_add_u32 m0, s27, 55296
    s_nop 0
    buffer_load_dwordx4 v18, s[8:11], s31 offen lds
    s_add_u32 m0, s27, 56320
    s_nop 0
    buffer_load_dwordx4 v19, s[8:11], s31 offen lds
    s_add_u32 m0, s28, 49152
    s_nop 0
    buffer_load_dwordx4 v20, s[12:15], s32 offen lds
    s_add_u32 m0, s28, 50176
    s_nop 0
    buffer_load_dwordx4 v21, s[12:15], s32 offen lds
    s_add_u32 m0, s28, 51200
    s_nop 0
    buffer_load_dwordx4 v22, s[12:15], s32 offen lds
    s_add_u32 m0, s28, 52224
    s_nop 0
    buffer_load_dwordx4 v23, s[12:15], s32 offen lds
    s_add_u32 s31, s31, 128
    s_add_u32 s32, s32, 131072
l1_kernel_nd_47:
    s_sub_u32 s33, s33, 1
    s_cmp_eq_u32 s33, 0
    s_cbranch_scc0 l1_kernel_lloop_37
l1_kernel_ldone_38:
    s_endpgm
l1_kernel_comp_35:
    v_and_b32 v148, 63, v146
    s_lshr_b32 s25, s24, 1
    s_and_b32 s26, s24, 1
    v_and_b32 v150, 31, v148
    v_lshrrev_b32 v151, 5, v148
    v_lshrrev_b32 v152, 1, v148
    v_and_b32 v152, 7, v152
    s_mul_i32 s29, s25, 64
    v_add_u32 v153, s29, v150
    v_lshlrev_b32 v153, 7, v153
    v_add_u32 v154, 0, v151
    v_xor_b32 v154, v154, v152
    v_lshlrev_b32 v154, 4, v154
    v_add_u32 v128, v153, v154
    v_add_u32 v132, 49152, v128
    v_add_u32 v136, 98304, v128
    v_add_u32 v154, 2, v151
    v_xor_b32 v154, v154, v152
    v_lshlrev_b32 v154, 4, v154
    v_add_u32 v129, v153, v154
    v_add_u32 v133, 49152, v129
    v_add_u32 v137, 98304, v129
    v_add_u32 v154, 4, v151
    v_xor_b32 v154, v154, v152
    v_lshlrev_b32 v154, 4, v154
    v_add_u32 v130, v153, v154
    v_add_u32 v134, 49152, v130
    v_add_u32 v138, 98304, v130
    v_add_u32 v154, 6, v151
    v_xor_b32 v154, v154, v152
    v_lshlrev_b32 v154, 4, v154
    v_add_u32 v131, v153, v154
    v_add_u32 v135, 49152, v131
    v_add_u32 v139, 98304, v131
    v_lshrrev_b32 v150, 4, v148
    v_and_b32 v151, 15, v148
    v_lshrrev_b32 v151, 2, v151
    v_and_b32 v152, 3, v148
    v_lshrrev_b32 v153, 1, v150
    v_lshlrev_b32 v153, 3, v153
    v_add_u32 v153, v153, v151
    v_mul_u32_u24 v153, 256, v153
    v_and_b32 v154, 1, v150
    v_lshlrev_b32 v154, 1, v154
    v_lshrrev_b32 v155, 1, v152
    v_add_u32 v154, v154, v155
    s_mul_i32 s29, s26, 8
    v_add_u32 v154, s29, v154
    v_lshlrev_b32 v155, 2, v151
    v_and_b32 v152, 1, v152
    v_lshlrev_b32 v152, 3, v152
    v_add_u32 v153, v153, v152
    v_add_u32 v153, 32768, v153
    v_add_u32 v140, 0, v154
    v_xor_b32 v140, v140, v155
    v_lshlrev_b32 v140, 4, v140
    v_add_u32 v140, v140, v153
    v_add_u32 v142, 49152, v140
    v_add_u32 v144, 98304, v140
    v_add_u32 v141, 4, v154
    v_xor_b32 v141, v141, v155
    v_lshlrev_b32 v141, 4, v141
    v_add_u32 v141, v141, v153
    v_add_u32 v143, 49152, v141
    v_add_u32 v145, 98304, v141
    v_mov_b32 v0, 0
    v_mov_b32 v1, 0
    v_mov_b32 v2, 0
    v_mov_b32 v3, 0
    v_mov_b32 v4, 0
    v_mov_b32 v5, 0
    v_mov_b32 v6, 0
    v_mov_b32 v7, 0
    v_mov_b32 v8, 0
    v_mov_b32 v9, 0
    v_mov_b32 v10, 0
    v_mov_b32 v11, 0
    v_mov_b32 v12, 0
    v_mov_b32 v13, 0
    v_mov_b32 v14, 0
    v_mov_b32 v15, 0
    v_mov_b32 v16, 0
    v_mov_b32 v17, 0
    v_mov_b32 v18, 0
    v_mov_b32 v19, 0
    v_mov_b32 v20, 0
    v_mov_b32 v21, 0
    v_mov_b32 v22, 0
    v_mov_b32 v23, 0
    v_mov_b32 v24, 0
    v_mov_b32 v25, 0
    v_mov_b32 v26, 0
    v_mov_b32 v27, 0
    v_mov_b32 v28, 0
    v_mov_b32 v29, 0
    v_mov_b32 v30, 0
    v_mov_b32 v31, 0
    v_mov_b32 v32, 0
    v_mov_b32 v33, 0
    v_mov_b32 v34, 0
    v_mov_b32 v35, 0
    v_mov_b32 v36, 0
    v_mov_b32 v37, 0
    v_mov_b32 v38, 0
    v_mov_b32 v39, 0
    v_mov_b32 v40, 0
    v_mov_b32 v41, 0
    v_mov_b32 v42, 0
    v_mov_b32 v43, 0
    v_mov_b32 v44, 0
    v_mov_b32 v45, 0
    v_mov_b32 v46, 0
    v_mov_b32 v47, 0
    v_mov_b32 v48, 0
    v_mov_b32 v49, 0
    v_mov_b32 v50, 0
    v_mov_b32 v51, 0
    v_mov_b32 v52, 0
    v_mov_b32 v53, 0
    v_mov_b32 v54, 0
    v_mov_b32 v55, 0
    v_mov_b32 v56, 0
    v_mov_b32 v57, 0
    v_mov_b32 v58, 0
    v_mov_b32 v59, 0
    v_mov_b32 v60, 0
    v_mov_b32 v61, 0
    v_mov_b32 v62, 0
    v_mov_b32 v63, 0
    v_mov_b32 v80, 0
    v_mov_b32 v81, 0
    v_mov_b32 v82, 0
    v_mov_b32 v83, 0
    v_mov_b32 v84, 0
    v_mov_b32 v85, 0
    v_mov_b32 v86, 0
    v_mov_b32 v87, 0
    v_mov_b32 v112, 0
    v_mov_b32 v113, 0
    v_mov_b32 v114, 0
    v_mov_b32 v115, 0
    v_mov_b32 v116, 0
    v_mov_b32 v117, 0
    v_mov_b32 v118, 0
    v_mov_b32 v119, 0
    v_mov_b32 v88, 0
    v_mov_b32 v89, 0
    v_mov_b32 v90, 0
    v_mov_b32 v91, 0
    v_mov_b32 v92, 0
    v_mov_b32 v93, 0
    v_mov_b32 v94, 0
    v_mov_b32 v95, 0
    v_mov_b32 v120, 0
    v_mov_b32 v121, 0
    v_mov_b32 v122, 0
    v_mov_b32 v123, 0
    v_mov_b32 v124, 0
    v_mov_b32 v125, 0
    v_mov_b32 v126, 0
    v_mov_b32 v127, 0
    s_mov_b32 s38, 0xbdd2d3e8
    s_mov_b32 s39, 0xbdd2d3e8
    s_mov_b32 s62, 1.0
    s_mov_b32 s63, 1.0
l1_kernel_loop_48:
    s_waitcnt lgkmcnt(0)
    s_barrier
    ds_read_b128 v[64:67], v128 offset:0
    ds_read_b128 v[68:71], v128 offset:4096
    ds_read_b64_tr_b16 v[96:97], v140 offset:0
    ds_read_b64_tr_b16 v[98:99], v140 offset:1024
    ds_read_b64_tr_b16 v[100:101], v141 offset:0
    ds_read_b64_tr_b16 v[102:103], v141 offset:1024
    v_mfma_f32_32x32x16_bf16 v[0:15], v[112:115], v[80:83], v[0:15]
    v_mfma_f32_32x32x16_bf16 v[16:31], v[112:115], v[84:87], v[16:31]
    v_mfma_f32_32x32x16_bf16 v[32:47], v[116:119], v[80:83], v[32:47]
    v_mfma_f32_32x32x16_bf16 v[48:63], v[116:119], v[84:87], v[48:63]
    ds_read_b128 v[72:75], v129 offset:0
    ds_read_b128 v[76:79], v129 offset:4096
    ds_read_b64_tr_b16 v[104:105], v140 offset:4096
    ds_read_b64_tr_b16 v[106:107], v140 offset:5120
    ds_read_b64_tr_b16 v[108:109], v141 offset:4096
    ds_read_b64_tr_b16 v[110:111], v141 offset:5120
    v_mfma_f32_32x32x16_bf16 v[0:15], v[120:123], v[88:91], v[0:15]
    v_mfma_f32_32x32x16_bf16 v[16:31], v[120:123], v[92:95], v[16:31]
    v_mfma_f32_32x32x16_bf16 v[32:47], v[124:127], v[88:91], v[32:47]
    v_mfma_f32_32x32x16_bf16 v[48:63], v[124:127], v[92:95], v[48:63]
    ds_read_b128 v[80:83], v130 offset:0
    ds_read_b128 v[84:87], v130 offset:4096
    ds_read_b64_tr_b16 v[112:113], v140 offset:8192
    ds_read_b64_tr_b16 v[114:115], v140 offset:9216
    ds_read_b64_tr_b16 v[116:117], v141 offset:8192
    ds_read_b64_tr_b16 v[118:119], v141 offset:9216
    s_waitcnt lgkmcnt(12)
    v_mfma_f32_32x32x16_bf16 v[0:15], v[96:99], v[64:67], v[0:15]
    v_mfma_f32_32x32x16_bf16 v[16:31], v[96:99], v[68:71], v[16:31]
    v_mfma_f32_32x32x16_bf16 v[32:47], v[100:103], v[64:67], v[32:47]
    v_mfma_f32_32x32x16_bf16 v[48:63], v[100:103], v[68:71], v[48:63]
    ds_read_b128 v[88:91], v131 offset:0
    ds_read_b128 v[92:95], v131 offset:4096
    ds_read_b64_tr_b16 v[120:121], v140 offset:12288
    ds_read_b64_tr_b16 v[122:123], v140 offset:13312
    ds_read_b64_tr_b16 v[124:125], v141 offset:12288
    ds_read_b64_tr_b16 v[126:127], v141 offset:13312
    s_waitcnt lgkmcnt(12)
    v_mfma_f32_32x32x16_bf16 v[0:15], v[104:107], v[72:75], v[0:15]
    v_mfma_f32_32x32x16_bf16 v[16:31], v[104:107], v[76:79], v[16:31]
    v_mfma_f32_32x32x16_bf16 v[32:47], v[108:111], v[72:75], v[32:47]
    v_mfma_f32_32x32x16_bf16 v[48:63], v[108:111], v[76:79], v[48:63]
    s_sub_u32 s33, s33, 1
    s_cmp_eq_u32 s33, 0
    s_cbranch_scc1 l1_kernel_exit_49
    s_waitcnt lgkmcnt(0)
    s_barrier
    ds_read_b128 v[64:67], v132 offset:0
    ds_read_b128 v[68:71], v132 offset:4096
    ds_read_b64_tr_b16 v[96:97], v142 offset:0
    ds_read_b64_tr_b16 v[98:99], v142 offset:1024
    ds_read_b64_tr_b16 v[100:101], v143 offset:0
    ds_read_b64_tr_b16 v[102:103], v143 offset:1024
    v_mfma_f32_32x32x16_bf16 v[0:15], v[112:115], v[80:83], v[0:15]
    v_mfma_f32_32x32x16_bf16 v[16:31], v[112:115], v[84:87], v[16:31]
    v_mfma_f32_32x32x16_bf16 v[32:47], v[116:119], v[80:83], v[32:47]
    v_mfma_f32_32x32x16_bf16 v[48:63], v[116:119], v[84:87], v[48:63]
    ds_read_b128 v[72:75], v133 offset:0
    ds_read_b128 v[76:79], v133 offset:4096
    ds_read_b64_tr_b16 v[104:105], v142 offset:4096
    ds_read_b64_tr_b16 v[106:107], v142 offset:5120
    ds_read_b64_tr_b16 v[108:109], v143 offset:4096
    ds_read_b64_tr_b16 v[110:111], v143 offset:5120
    v_mfma_f32_32x32x16_bf16 v[0:15], v[120:123], v[88:91], v[0:15]
    v_mfma_f32_32x32x16_bf16 v[16:31], v[120:123], v[92:95], v[16:31]
    v_mfma_f32_32x32x16_bf16 v[32:47], v[124:127], v[88:91], v[32:47]
    v_mfma_f32_32x32x16_bf16 v[48:63], v[124:127], v[92:95], v[48:63]
    ds_read_b128 v[80:83], v134 offset:0
    ds_read_b128 v[84:87], v134 offset:4096
    ds_read_b64_tr_b16 v[112:113], v142 offset:8192
    ds_read_b64_tr_b16 v[114:115], v142 offset:9216
    ds_read_b64_tr_b16 v[116:117], v143 offset:8192
    ds_read_b64_tr_b16 v[118:119], v143 offset:9216
    s_waitcnt lgkmcnt(12)
    v_mfma_f32_32x32x16_bf16 v[0:15], v[96:99], v[64:67], v[0:15]
    v_mfma_f32_32x32x16_bf16 v[16:31], v[96:99], v[68:71], v[16:31]
    v_mfma_f32_32x32x16_bf16 v[32:47], v[100:103], v[64:67], v[32:47]
    v_mfma_f32_32x32x16_bf16 v[48:63], v[100:103], v[68:71], v[48:63]
    ds_read_b128 v[88:91], v135 offset:0
    ds_read_b128 v[92:95], v135 offset:4096
    ds_read_b64_tr_b16 v[120:121], v142 offset:12288
    ds_read_b64_tr_b16 v[122:123], v142 offset:13312
    ds_read_b64_tr_b16 v[124:125], v143 offset:12288
    ds_read_b64_tr_b16 v[126:127], v143 offset:13312
    s_waitcnt lgkmcnt(12)
    v_mfma_f32_32x32x16_bf16 v[0:15], v[104:107], v[72:75], v[0:15]
    v_mfma_f32_32x32x16_bf16 v[16:31], v[104:107], v[76:79], v[16:31]
    v_mfma_f32_32x32x16_bf16 v[32:47], v[108:111], v[72:75], v[32:47]
    v_mfma_f32_32x32x16_bf16 v[48:63], v[108:111], v[76:79], v[48:63]
    s_sub_u32 s33, s33, 1
    s_cmp_eq_u32 s33, 0
    s_cbranch_scc1 l1_kernel_exit_49
    s_waitcnt lgkmcnt(0)
    s_barrier
    ds_read_b128 v[64:67], v136 offset:0
    ds_read_b128 v[68:71], v136 offset:4096
    ds_read_b64_tr_b16 v[96:97], v144 offset:0
    ds_read_b64_tr_b16 v[98:99], v144 offset:1024
    ds_read_b64_tr_b16 v[100:101], v145 offset:0
    ds_read_b64_tr_b16 v[102:103], v145 offset:1024
    v_mfma_f32_32x32x16_bf16 v[0:15], v[112:115], v[80:83], v[0:15]
    v_mfma_f32_32x32x16_bf16 v[16:31], v[112:115], v[84:87], v[16:31]
    v_mfma_f32_32x32x16_bf16 v[32:47], v[116:119], v[80:83], v[32:47]
    v_mfma_f32_32x32x16_bf16 v[48:63], v[116:119], v[84:87], v[48:63]
    ds_read_b128 v[72:75], v137 offset:0
    ds_read_b128 v[76:79], v137 offset:4096
    ds_read_b64_tr_b16 v[104:105], v144 offset:4096
    ds_read_b64_tr_b16 v[106:107], v144 offset:5120
    ds_read_b64_tr_b16 v[108:109], v145 offset:4096
    ds_read_b64_tr_b16 v[110:111], v145 offset:5120
    v_mfma_f32_32x32x16_bf16 v[0:15], v[120:123], v[88:91], v[0:15]
    v_mfma_f32_32x32x16_bf16 v[16:31], v[120:123], v[92:95], v[16:31]
    v_mfma_f32_32x32x16_bf16 v[32:47], v[124:127], v[88:91], v[32:47]
    v_mfma_f32_32x32x16_bf16 v[48:63], v[124:127], v[92:95], v[48:63]
    ds_read_b128 v[80:83], v138 offset:0
    ds_read_b128 v[84:87], v138 offset:4096
    ds_read_b64_tr_b16 v[112:113], v144 offset:8192
    ds_read_b64_tr_b16 v[114:115], v144 offset:9216
    ds_read_b64_tr_b16 v[116:117], v145 offset:8192
    ds_read_b64_tr_b16 v[118:119], v145 offset:9216
    s_waitcnt lgkmcnt(12)
    v_mfma_f32_32x32x16_bf16 v[0:15], v[96:99], v[64:67], v[0:15]
    v_mfma_f32_32x32x16_bf16 v[16:31], v[96:99], v[68:71], v[16:31]
    v_mfma_f32_32x32x16_bf16 v[32:47], v[100:103], v[64:67], v[32:47]
    v_mfma_f32_32x32x16_bf16 v[48:63], v[100:103], v[68:71], v[48:63]
    ds_read_b128 v[88:91], v139 offset:0
    ds_read_b128 v[92:95], v139 offset:4096
    ds_read_b64_tr_b16 v[120:121], v144 offset:12288
    ds_read_b64_tr_b16 v[122:123], v144 offset:13312
    ds_read_b64_tr_b16 v[124:125], v145 offset:12288
    ds_read_b64_tr_b16 v[126:127], v145 offset:13312
    s_waitcnt lgkmcnt(12)
    v_mfma_f32_32x32x16_bf16 v[0:15], v[104:107], v[72:75], v[0:15]
    v_mfma_f32_32x32x16_bf16 v[16:31], v[104:107], v[76:79], v[16:31]
    v_mfma_f32_32x32x16_bf16 v[32:47], v[108:111], v[72:75], v[32:47]
    v_mfma_f32_32x32x16_bf16 v[48:63], v[108:111], v[76:79], v[48:63]
    s_sub_u32 s33, s33, 1
    s_cmp_eq_u32 s33, 0
    s_cbranch_scc0 l1_kernel_loop_48
l1_kernel_exit_49:
    s_waitcnt lgkmcnt(6)
    v_mfma_f32_32x32x16_bf16 v[0:15], v[112:115], v[80:83], v[0:15]
    v_mfma_f32_32x32x16_bf16 v[16:31], v[112:115], v[84:87], v[16:31]
    v_mfma_f32_32x32x16_bf16 v[32:47], v[116:119], v[80:83], v[32:47]
    v_mfma_f32_32x32x16_bf16 v[48:63], v[116:119], v[84:87], v[48:63]
    s_waitcnt lgkmcnt(0)
    v_mfma_f32_32x32x16_bf16 v[0:15], v[120:123], v[88:91], v[0:15]
    v_mfma_f32_32x32x16_bf16 v[16:31], v[120:123], v[92:95], v[16:31]
    v_mfma_f32_32x32x16_bf16 v[32:47], v[124:127], v[88:91], v[32:47]
    v_mfma_f32_32x32x16_bf16 v[48:63], v[124:127], v[92:95], v[48:63]
    s_barrier
    v_and_b32 v64, 63, v146
    v_and_b32 v65, 31, v64
    v_lshrrev_b32 v66, 5, v64
    s_mul_i32 s36, s24, 8192
    v_lshlrev_b32 v68, 7, v65
    v_add_u32 v68, s36, v68
    v_and_b32 v69, 7, v65
    v_lshrrev_b32 v70, 3, v64
    v_and_b32 v71, 7, v64
    v_lshlrev_b32 v80, 7, v70
    v_lshl_add_u32 v80, v71, 4, v80
    v_add_u32 v80, s36, v80
    s_mul_i32 s29, s34, 256
    s_mul_i32 s30, s25, 64
    s_add_u32 s29, s29, s30
    s_mov_b32 s53, s29
    v_add_u32 v67, s29, v70
    s_mov_b32 s30, 2048
    v_mul_lo_u32 v67, v67, s30
    v_xor_b32 v71, v71, v70
    v_lshlrev_b32 v71, 4, v71
    s_mul_i32 s54, s35, 128
    s_mul_i32 s30, s26, 64
    s_add_u32 s54, s54, s30
    s_lshl_b32 s29, s54, 1
    v_add3_u32 v67, v67, v71, s29
    v_add_u32 v81, 0, v66
    v_xor_b32 v81, v81, v69
    v_lshl_add_u32 v81, v81, 4, v68
    v_add_u32 v82, 2, v66
    v_xor_b32 v82, v82, v69
    v_lshl_add_u32 v82, v82, 4, v68
    v_add_u32 v83, 4, v66
    v_xor_b32 v83, v83, v69
    v_lshl_add_u32 v83, v83, 4, v68
    v_add_u32 v84, 6, v66
    v_xor_b32 v84, v84, v69
    v_lshl_add_u32 v84, v84, 4, v68
    v_mov_b32 v96, 0xc0135761
    v_mov_b32 v97, 0xc0135761
    v_pk_mul_f32 v[88:89], v[0:1], v[0:1]
    v_pk_mul_f32 v[90:91], v[2:3], v[2:3]
    v_pk_mul_f32 v[92:93], v[4:5], v[4:5]
    v_pk_mul_f32 v[94:95], v[6:7], v[6:7]
    v_pk_fma_f32 v[88:89], v[88:89], s[38:39], v[96:97]
    v_pk_fma_f32 v[90:91], v[90:91], s[38:39], v[96:97]
    v_pk_fma_f32 v[92:93], v[92:93], s[38:39], v[96:97]
    v_pk_fma_f32 v[94:95], v[94:95], s[38:39], v[96:97]
    v_pk_mul_f32 v[88:89], v[88:89], v[0:1]
    v_pk_mul_f32 v[90:91], v[90:91], v[2:3]
    v_pk_mul_f32 v[92:93], v[92:93], v[4:5]
    v_pk_mul_f32 v[94:95], v[94:95], v[6:7]
    v_exp_f32 v88, v88
    v_exp_f32 v89, v89
    v_exp_f32 v90, v90
    v_exp_f32 v91, v91
    v_exp_f32 v92, v92
    v_exp_f32 v93, v93
    v_exp_f32 v94, v94
    v_exp_f32 v95, v95
    v_pk_add_f32 v[88:89], v[88:89], s[62:63]
    v_pk_add_f32 v[90:91], v[90:91], s[62:63]
    v_pk_add_f32 v[92:93], v[92:93], s[62:63]
    v_pk_add_f32 v[94:95], v[94:95], s[62:63]
    v_rcp_f32 v88, v88
    v_rcp_f32 v89, v89
    v_rcp_f32 v90, v90
    v_rcp_f32 v91, v91
    v_rcp_f32 v92, v92
    v_rcp_f32 v93, v93
    v_rcp_f32 v94, v94
    v_rcp_f32 v95, v95
    v_pk_mul_f32 v[0:1], v[0:1], v[88:89]
    v_pk_mul_f32 v[2:3], v[2:3], v[90:91]
    v_pk_mul_f32 v[4:5], v[4:5], v[92:93]
    v_pk_mul_f32 v[6:7], v[6:7], v[94:95]
    v_pk_mul_f32 v[88:89], v[8:9], v[8:9]
    v_pk_mul_f32 v[90:91], v[10:11], v[10:11]
    v_pk_mul_f32 v[92:93], v[12:13], v[12:13]
    v_pk_mul_f32 v[94:95], v[14:15], v[14:15]
    v_pk_fma_f32 v[88:89], v[88:89], s[38:39], v[96:97]
    v_pk_fma_f32 v[90:91], v[90:91], s[38:39], v[96:97]
    v_pk_fma_f32 v[92:93], v[92:93], s[38:39], v[96:97]
    v_pk_fma_f32 v[94:95], v[94:95], s[38:39], v[96:97]
    v_pk_mul_f32 v[88:89], v[88:89], v[8:9]
    v_pk_mul_f32 v[90:91], v[90:91], v[10:11]
    v_pk_mul_f32 v[92:93], v[92:93], v[12:13]
    v_pk_mul_f32 v[94:95], v[94:95], v[14:15]
    v_exp_f32 v88, v88
    v_exp_f32 v89, v89
    v_exp_f32 v90, v90
    v_exp_f32 v91, v91
    v_exp_f32 v92, v92
    v_exp_f32 v93, v93
    v_exp_f32 v94, v94
    v_exp_f32 v95, v95
    v_pk_add_f32 v[88:89], v[88:89], s[62:63]
    v_pk_add_f32 v[90:91], v[90:91], s[62:63]
    v_pk_add_f32 v[92:93], v[92:93], s[62:63]
    v_pk_add_f32 v[94:95], v[94:95], s[62:63]
    v_rcp_f32 v88, v88
    v_rcp_f32 v89, v89
    v_rcp_f32 v90, v90
    v_rcp_f32 v91, v91
    v_rcp_f32 v92, v92
    v_rcp_f32 v93, v93
    v_rcp_f32 v94, v94
    v_rcp_f32 v95, v95
    v_pk_mul_f32 v[8:9], v[8:9], v[88:89]
    v_pk_mul_f32 v[10:11], v[10:11], v[90:91]
    v_pk_mul_f32 v[12:13], v[12:13], v[92:93]
    v_pk_mul_f32 v[14:15], v[14:15], v[94:95]
    v_cvt_pk_bf16_f32 v72, v0, v1
    v_cvt_pk_bf16_f32 v73, v2, v3
    v_cvt_pk_bf16_f32 v74, v4, v5
    v_cvt_pk_bf16_f32 v75, v6, v7
    v_cvt_pk_bf16_f32 v76, v8, v9
    v_cvt_pk_bf16_f32 v77, v10, v11
    v_cvt_pk_bf16_f32 v78, v12, v13
    v_cvt_pk_bf16_f32 v79, v14, v15
    v_permlane32_swap_b32 v72, v74
    v_permlane32_swap_b32 v73, v75
    v_permlane32_swap_b32 v76, v78
    v_permlane32_swap_b32 v77, v79
    ds_write_b128 v81, v[72:75] offset:0
    ds_write_b128 v82, v[76:79] offset:0
    v_mov_b32 v96, 0xc0135761
    v_mov_b32 v97, 0xc0135761
    v_pk_mul_f32 v[88:89], v[32:33], v[32:33]
    v_pk_mul_f32 v[90:91], v[34:35], v[34:35]
    v_pk_mul_f32 v[92:93], v[36:37], v[36:37]
    v_pk_mul_f32 v[94:95], v[38:39], v[38:39]
    v_pk_fma_f32 v[88:89], v[88:89], s[38:39], v[96:97]
    v_pk_fma_f32 v[90:91], v[90:91], s[38:39], v[96:97]
    v_pk_fma_f32 v[92:93], v[92:93], s[38:39], v[96:97]
    v_pk_fma_f32 v[94:95], v[94:95], s[38:39], v[96:97]
    v_pk_mul_f32 v[88:89], v[88:89], v[32:33]
    v_pk_mul_f32 v[90:91], v[90:91], v[34:35]
    v_pk_mul_f32 v[92:93], v[92:93], v[36:37]
    v_pk_mul_f32 v[94:95], v[94:95], v[38:39]
    v_exp_f32 v88, v88
    v_exp_f32 v89, v89
    v_exp_f32 v90, v90
    v_exp_f32 v91, v91
    v_exp_f32 v92, v92
    v_exp_f32 v93, v93
    v_exp_f32 v94, v94
    v_exp_f32 v95, v95
    v_pk_add_f32 v[88:89], v[88:89], s[62:63]
    v_pk_add_f32 v[90:91], v[90:91], s[62:63]
    v_pk_add_f32 v[92:93], v[92:93], s[62:63]
    v_pk_add_f32 v[94:95], v[94:95], s[62:63]
    v_rcp_f32 v88, v88
    v_rcp_f32 v89, v89
    v_rcp_f32 v90, v90
    v_rcp_f32 v91, v91
    v_rcp_f32 v92, v92
    v_rcp_f32 v93, v93
    v_rcp_f32 v94, v94
    v_rcp_f32 v95, v95
    v_pk_mul_f32 v[32:33], v[32:33], v[88:89]
    v_pk_mul_f32 v[34:35], v[34:35], v[90:91]
    v_pk_mul_f32 v[36:37], v[36:37], v[92:93]
    v_pk_mul_f32 v[38:39], v[38:39], v[94:95]
    v_pk_mul_f32 v[88:89], v[40:41], v[40:41]
    v_pk_mul_f32 v[90:91], v[42:43], v[42:43]
    v_pk_mul_f32 v[92:93], v[44:45], v[44:45]
    v_pk_mul_f32 v[94:95], v[46:47], v[46:47]
    v_pk_fma_f32 v[88:89], v[88:89], s[38:39], v[96:97]
    v_pk_fma_f32 v[90:91], v[90:91], s[38:39], v[96:97]
    v_pk_fma_f32 v[92:93], v[92:93], s[38:39], v[96:97]
    v_pk_fma_f32 v[94:95], v[94:95], s[38:39], v[96:97]
    v_pk_mul_f32 v[88:89], v[88:89], v[40:41]
    v_pk_mul_f32 v[90:91], v[90:91], v[42:43]
    v_pk_mul_f32 v[92:93], v[92:93], v[44:45]
    v_pk_mul_f32 v[94:95], v[94:95], v[46:47]
    v_exp_f32 v88, v88
    v_exp_f32 v89, v89
    v_exp_f32 v90, v90
    v_exp_f32 v91, v91
    v_exp_f32 v92, v92
    v_exp_f32 v93, v93
    v_exp_f32 v94, v94
    v_exp_f32 v95, v95
    v_pk_add_f32 v[88:89], v[88:89], s[62:63]
    v_pk_add_f32 v[90:91], v[90:91], s[62:63]
    v_pk_add_f32 v[92:93], v[92:93], s[62:63]
    v_pk_add_f32 v[94:95], v[94:95], s[62:63]
    v_rcp_f32 v88, v88
    v_rcp_f32 v89, v89
    v_rcp_f32 v90, v90
    v_rcp_f32 v91, v91
    v_rcp_f32 v92, v92
    v_rcp_f32 v93, v93
    v_rcp_f32 v94, v94
    v_rcp_f32 v95, v95
    v_pk_mul_f32 v[40:41], v[40:41], v[88:89]
    v_pk_mul_f32 v[42:43], v[42:43], v[90:91]
    v_pk_mul_f32 v[44:45], v[44:45], v[92:93]
    v_pk_mul_f32 v[46:47], v[46:47], v[94:95]
    v_cvt_pk_bf16_f32 v72, v32, v33
    v_cvt_pk_bf16_f32 v73, v34, v35
    v_cvt_pk_bf16_f32 v74, v36, v37
    v_cvt_pk_bf16_f32 v75, v38, v39
    v_cvt_pk_bf16_f32 v76, v40, v41
    v_cvt_pk_bf16_f32 v77, v42, v43
    v_cvt_pk_bf16_f32 v78, v44, v45
    v_cvt_pk_bf16_f32 v79, v46, v47
    v_permlane32_swap_b32 v72, v74
    v_permlane32_swap_b32 v73, v75
    v_permlane32_swap_b32 v76, v78
    v_permlane32_swap_b32 v77, v79
    ds_write_b128 v83, v[72:75] offset:0
    ds_write_b128 v84, v[76:79] offset:0
    v_mov_b32 v96, 0xc0135761
    v_mov_b32 v97, 0xc0135761
    v_pk_mul_f32 v[88:89], v[16:17], v[16:17]
    v_pk_mul_f32 v[90:91], v[18:19], v[18:19]
    v_pk_mul_f32 v[92:93], v[20:21], v[20:21]
    v_pk_mul_f32 v[94:95], v[22:23], v[22:23]
    v_pk_fma_f32 v[88:89], v[88:89], s[38:39], v[96:97]
    v_pk_fma_f32 v[90:91], v[90:91], s[38:39], v[96:97]
    v_pk_fma_f32 v[92:93], v[92:93], s[38:39], v[96:97]
    v_pk_fma_f32 v[94:95], v[94:95], s[38:39], v[96:97]
    v_pk_mul_f32 v[88:89], v[88:89], v[16:17]
    v_pk_mul_f32 v[90:91], v[90:91], v[18:19]
    v_pk_mul_f32 v[92:93], v[92:93], v[20:21]
    v_pk_mul_f32 v[94:95], v[94:95], v[22:23]
    v_exp_f32 v88, v88
    v_exp_f32 v89, v89
    v_exp_f32 v90, v90
    v_exp_f32 v91, v91
    v_exp_f32 v92, v92
    v_exp_f32 v93, v93
    v_exp_f32 v94, v94
    v_exp_f32 v95, v95
    v_pk_add_f32 v[88:89], v[88:89], s[62:63]
    v_pk_add_f32 v[90:91], v[90:91], s[62:63]
    v_pk_add_f32 v[92:93], v[92:93], s[62:63]
    v_pk_add_f32 v[94:95], v[94:95], s[62:63]
    v_rcp_f32 v88, v88
    v_rcp_f32 v89, v89
    v_rcp_f32 v90, v90
    v_rcp_f32 v91, v91
    v_rcp_f32 v92, v92
    v_rcp_f32 v93, v93
    v_rcp_f32 v94, v94
    v_rcp_f32 v95, v95
    v_pk_mul_f32 v[16:17], v[16:17], v[88:89]
    v_pk_mul_f32 v[18:19], v[18:19], v[90:91]
    v_pk_mul_f32 v[20:21], v[20:21], v[92:93]
    v_pk_mul_f32 v[22:23], v[22:23], v[94:95]
    v_pk_mul_f32 v[88:89], v[24:25], v[24:25]
    v_pk_mul_f32 v[90:91], v[26:27], v[26:27]
    v_pk_mul_f32 v[92:93], v[28:29], v[28:29]
    v_pk_mul_f32 v[94:95], v[30:31], v[30:31]
    v_pk_fma_f32 v[88:89], v[88:89], s[38:39], v[96:97]
    v_pk_fma_f32 v[90:91], v[90:91], s[38:39], v[96:97]
    v_pk_fma_f32 v[92:93], v[92:93], s[38:39], v[96:97]
    v_pk_fma_f32 v[94:95], v[94:95], s[38:39], v[96:97]
    v_pk_mul_f32 v[88:89], v[88:89], v[24:25]
    v_pk_mul_f32 v[90:91], v[90:91], v[26:27]
    v_pk_mul_f32 v[92:93], v[92:93], v[28:29]
    v_pk_mul_f32 v[94:95], v[94:95], v[30:31]
    v_exp_f32 v88, v88
    v_exp_f32 v89, v89
    v_exp_f32 v90, v90
    v_exp_f32 v91, v91
    v_exp_f32 v92, v92
    v_exp_f32 v93, v93
    v_exp_f32 v94, v94
    v_exp_f32 v95, v95
    v_pk_add_f32 v[88:89], v[88:89], s[62:63]
    v_pk_add_f32 v[90:91], v[90:91], s[62:63]
    v_pk_add_f32 v[92:93], v[92:93], s[62:63]
    v_pk_add_f32 v[94:95], v[94:95], s[62:63]
    v_rcp_f32 v88, v88
    v_rcp_f32 v89, v89
    v_rcp_f32 v90, v90
    v_rcp_f32 v91, v91
    v_rcp_f32 v92, v92
    v_rcp_f32 v93, v93
    v_rcp_f32 v94, v94
    v_rcp_f32 v95, v95
    v_pk_mul_f32 v[24:25], v[24:25], v[88:89]
    v_pk_mul_f32 v[26:27], v[26:27], v[90:91]
    v_pk_mul_f32 v[28:29], v[28:29], v[92:93]
    v_pk_mul_f32 v[30:31], v[30:31], v[94:95]
    v_cvt_pk_bf16_f32 v72, v16, v17
    v_cvt_pk_bf16_f32 v73, v18, v19
    v_cvt_pk_bf16_f32 v74, v20, v21
    v_cvt_pk_bf16_f32 v75, v22, v23
    v_cvt_pk_bf16_f32 v76, v24, v25
    v_cvt_pk_bf16_f32 v77, v26, v27
    v_cvt_pk_bf16_f32 v78, v28, v29
    v_cvt_pk_bf16_f32 v79, v30, v31
    v_permlane32_swap_b32 v72, v74
    v_permlane32_swap_b32 v73, v75
    v_permlane32_swap_b32 v76, v78
    v_permlane32_swap_b32 v77, v79
    ds_write_b128 v81, v[72:75] offset:4096
    ds_write_b128 v82, v[76:79] offset:4096
    v_mov_b32 v96, 0xc0135761
    v_mov_b32 v97, 0xc0135761
    v_pk_mul_f32 v[88:89], v[48:49], v[48:49]
    v_pk_mul_f32 v[90:91], v[50:51], v[50:51]
    v_pk_mul_f32 v[92:93], v[52:53], v[52:53]
    v_pk_mul_f32 v[94:95], v[54:55], v[54:55]
    v_pk_fma_f32 v[88:89], v[88:89], s[38:39], v[96:97]
    v_pk_fma_f32 v[90:91], v[90:91], s[38:39], v[96:97]
    v_pk_fma_f32 v[92:93], v[92:93], s[38:39], v[96:97]
    v_pk_fma_f32 v[94:95], v[94:95], s[38:39], v[96:97]
    v_pk_mul_f32 v[88:89], v[88:89], v[48:49]
    v_pk_mul_f32 v[90:91], v[90:91], v[50:51]
    v_pk_mul_f32 v[92:93], v[92:93], v[52:53]
    v_pk_mul_f32 v[94:95], v[94:95], v[54:55]
    v_exp_f32 v88, v88
    v_exp_f32 v89, v89
    v_exp_f32 v90, v90
    v_exp_f32 v91, v91
    v_exp_f32 v92, v92
    v_exp_f32 v93, v93
    v_exp_f32 v94, v94
    v_exp_f32 v95, v95
    v_pk_add_f32 v[88:89], v[88:89], s[62:63]
    v_pk_add_f32 v[90:91], v[90:91], s[62:63]
    v_pk_add_f32 v[92:93], v[92:93], s[62:63]
    v_pk_add_f32 v[94:95], v[94:95], s[62:63]
    v_rcp_f32 v88, v88
    v_rcp_f32 v89, v89
    v_rcp_f32 v90, v90
    v_rcp_f32 v91, v91
    v_rcp_f32 v92, v92
    v_rcp_f32 v93, v93
    v_rcp_f32 v94, v94
    v_rcp_f32 v95, v95
    v_pk_mul_f32 v[48:49], v[48:49], v[88:89]
    v_pk_mul_f32 v[50:51], v[50:51], v[90:91]
    v_pk_mul_f32 v[52:53], v[52:53], v[92:93]
    v_pk_mul_f32 v[54:55], v[54:55], v[94:95]
    v_pk_mul_f32 v[88:89], v[56:57], v[56:57]
    v_pk_mul_f32 v[90:91], v[58:59], v[58:59]
    v_pk_mul_f32 v[92:93], v[60:61], v[60:61]
    v_pk_mul_f32 v[94:95], v[62:63], v[62:63]
    v_pk_fma_f32 v[88:89], v[88:89], s[38:39], v[96:97]
    v_pk_fma_f32 v[90:91], v[90:91], s[38:39], v[96:97]
    v_pk_fma_f32 v[92:93], v[92:93], s[38:39], v[96:97]
    v_pk_fma_f32 v[94:95], v[94:95], s[38:39], v[96:97]
    v_pk_mul_f32 v[88:89], v[88:89], v[56:57]
    v_pk_mul_f32 v[90:91], v[90:91], v[58:59]
    v_pk_mul_f32 v[92:93], v[92:93], v[60:61]
    v_pk_mul_f32 v[94:95], v[94:95], v[62:63]
    v_exp_f32 v88, v88
    v_exp_f32 v89, v89
    v_exp_f32 v90, v90
    v_exp_f32 v91, v91
    v_exp_f32 v92, v92
    v_exp_f32 v93, v93
    v_exp_f32 v94, v94
    v_exp_f32 v95, v95
    v_pk_add_f32 v[88:89], v[88:89], s[62:63]
    v_pk_add_f32 v[90:91], v[90:91], s[62:63]
    v_pk_add_f32 v[92:93], v[92:93], s[62:63]
    v_pk_add_f32 v[94:95], v[94:95], s[62:63]
    v_rcp_f32 v88, v88
    v_rcp_f32 v89, v89
    v_rcp_f32 v90, v90
    v_rcp_f32 v91, v91
    v_rcp_f32 v92, v92
    v_rcp_f32 v93, v93
    v_rcp_f32 v94, v94
    v_rcp_f32 v95, v95
    v_pk_mul_f32 v[56:57], v[56:57], v[88:89]
    v_pk_mul_f32 v[58:59], v[58:59], v[90:91]
    v_pk_mul_f32 v[60:61], v[60:61], v[92:93]
    v_pk_mul_f32 v[62:63], v[62:63], v[94:95]
    v_cvt_pk_bf16_f32 v72, v48, v49
    v_cvt_pk_bf16_f32 v73, v50, v51
    v_cvt_pk_bf16_f32 v74, v52, v53
    v_cvt_pk_bf16_f32 v75, v54, v55
    v_cvt_pk_bf16_f32 v76, v56, v57
    v_cvt_pk_bf16_f32 v77, v58, v59
    v_cvt_pk_bf16_f32 v78, v60, v61
    v_cvt_pk_bf16_f32 v79, v62, v63
    v_permlane32_swap_b32 v72, v74
    v_permlane32_swap_b32 v73, v75
    v_permlane32_swap_b32 v76, v78
    v_permlane32_swap_b32 v77, v79
    ds_write_b128 v83, v[72:75] offset:4096
    ds_write_b128 v84, v[76:79] offset:4096
    s_waitcnt lgkmcnt(0)
    ds_read_b128 v[0:3], v80 offset:0
    ds_read_b128 v[4:7], v80 offset:1024
    ds_read_b128 v[8:11], v80 offset:2048
    ds_read_b128 v[12:15], v80 offset:3072
    ds_read_b128 v[16:19], v80 offset:4096
    ds_read_b128 v[20:23], v80 offset:5120
    ds_read_b128 v[24:27], v80 offset:6144
    ds_read_b128 v[28:31], v80 offset:7168
    s_waitcnt lgkmcnt(7)
    buffer_store_dwordx4 v[0:3], v67, s[16:19], 0 offen
    v_add_u32 v67, 16384, v67
    s_waitcnt lgkmcnt(6)
    buffer_store_dwordx4 v[4:7], v67, s[16:19], 0 offen
    v_add_u32 v67, 16384, v67
    s_waitcnt lgkmcnt(5)
    buffer_store_dwordx4 v[8:11], v67, s[16:19], 0 offen
    v_add_u32 v67, 16384, v67
    s_waitcnt lgkmcnt(4)
    buffer_store_dwordx4 v[12:15], v67, s[16:19], 0 offen
    v_add_u32 v67, 16384, v67
    s_waitcnt lgkmcnt(3)
    buffer_store_dwordx4 v[16:19], v67, s[16:19], 0 offen
    v_add_u32 v67, 16384, v67
    s_waitcnt lgkmcnt(2)
    buffer_store_dwordx4 v[20:23], v67, s[16:19], 0 offen
    v_add_u32 v67, 16384, v67
    s_waitcnt lgkmcnt(1)
    buffer_store_dwordx4 v[24:27], v67, s[16:19], 0 offen
    v_add_u32 v67, 16384, v67
    s_waitcnt lgkmcnt(0)
    buffer_store_dwordx4 v[28:31], v67, s[16:19], 0 offen
l1_kernel_end_1:
    s_endpgm
.text
.globl l2_kernel
.p2align 8
.type l2_kernel,@function
l2_kernel:
    s_cmp_ge_u32 s2, 252
    s_cbranch_scc1 l2_kernel_end_1
    s_and_b32 s70, s2, 7
    s_lshr_b32 s71, s2, 3
    s_cmp_ge_u32 s71, 28
    s_cbranch_scc1 l2_kernel_cs_2
    s_cmp_ge_u32 s71, 16
    s_cbranch_scc1 l2_kernel_qs_3
    s_sub_u32 s52, s2, 0
    s_mul_hi_u32 s34, s52, 536870912
    s_mul_i32 s29, s34, 8
    s_sub_u32 s35, s52, s29
    s_mov_b32 s55, 0
    s_load_dwordx2 s[40:41], s[0:1], 96
    s_load_dwordx2 s[6:7], s[0:1], 48
    s_waitcnt lgkmcnt(0)
    s_add_u32 s8, s40, 16777216
    s_addc_u32 s9, s41, 0
    s_and_b32 s9, s9, 0xffff
    s_mov_b32 s10, 4202496
    s_mov_b32 s11, 0x00020000
    s_mov_b32 s12, s6
    s_mov_b32 s13, s7
    s_and_b32 s13, s13, 0xffff
    s_mov_b32 s14, 2097152
    s_mov_b32 s15, 0x00020000
    s_add_u32 s16, s40, 22020096
    s_addc_u32 s17, s41, 0
    s_and_b32 s17, s17, 0xffff
    s_mov_b32 s18, 4194304
    s_mov_b32 s19, 0x00020000
    s_mov_b32 s31, 2048
    s_mov_b32 s32, 0
    s_mov_b32 s33, 16
    v_mov_b32 v114, v0
    v_lshrrev_b32 v116, 6, v0
    s_nop 0
    v_readfirstlane_b32 s24, v116
    s_nop 0
    s_cmp_lt_u32 s24, 4
    s_cbranch_scc1 l2_kernel_comp_4
    s_cmp_lt_u32 s24, 8
    s_cbranch_scc1 l2_kernel_lok_5
    s_endpgm
l2_kernel_lok_5:
    s_sub_u32 s24, s24, 4
    v_and_b32 v4, 63, v0
    s_mul_i32 s27, s24, 4096
    s_mul_i32 s28, s24, 4096
    s_add_u32 s28, s28, 16384
    v_lshrrev_b32 v6, 3, v4
    v_lshrrev_b32 v7, 4, v4
    v_and_b32 v8, 7, v4
    s_mul_i32 s29, s34, 128
    s_mul_i32 s30, s24, 32
    s_add_u32 s29, s29, s30
    s_mov_b32 s30, 2048
    v_add_u32 v9, s29, v6
    v_mul_lo_u32 v9, v9, s30
    v_xor_b32 v10, v7, v8
    v_lshlrev_b32 v10, 4, v10
    v_add_u32 v12, v9, v10
    v_add_u32 v9, s29, v6
    v_add_u32 v9, 8, v9
    v_mul_lo_u32 v9, v9, s30
    v_or_b32 v10, 4, v7
    v_xor_b32 v10, v10, v8
    v_lshlrev_b32 v10, 4, v10
    v_add_u32 v13, v9, v10
    v_add_u32 v9, s29, v6
    v_add_u32 v9, 16, v9
    v_mul_lo_u32 v9, v9, s30
    v_xor_b32 v10, v7, v8
    v_lshlrev_b32 v10, 4, v10
    v_add_u32 v14, v9, v10
    v_add_u32 v9, s29, v6
    v_add_u32 v9, 24, v9
    v_mul_lo_u32 v9, v9, s30
    v_or_b32 v10, 4, v7
    v_xor_b32 v10, v10, v8
    v_lshlrev_b32 v10, 4, v10
    v_add_u32 v15, v9, v10
    v_lshrrev_b32 v6, 4, v4
    v_and_b32 v8, 15, v4
    v_lshlrev_b32 v7, 2, v6
    v_xor_b32 v8, v8, v7
    v_lshlrev_b32 v8, 4, v8
    s_mul_i32 s30, s35, 256
    s_mul_i32 s29, s24, 16
    v_add_u32 v8, s30, v8
    s_mov_b32 s30, 2048
    v_add_u32 v9, s29, v6
    v_mul_lo_u32 v9, v9, s30
    v_add_u32 v16, v9, v8
    v_add_u32 v9, s29, v6
    v_add_u32 v9, 4, v9
    v_mul_lo_u32 v9, v9, s30
    v_add_u32 v17, v9, v8
    v_add_u32 v9, s29, v6
    v_add_u32 v9, 8, v9
    v_mul_lo_u32 v9, v9, s30
    v_add_u32 v18, v9, v8
    v_add_u32 v9, s29, v6
    v_add_u32 v9, 12, v9
    v_mul_lo_u32 v9, v9, s30
    v_add_u32 v19, v9, v8
    s_add_u32 m0, s27, 0
    s_nop 0
    buffer_load_dwordx4 v12, s[8:11], s31 offen lds
    s_add_u32 m0, s27, 1024
    s_nop 0
    buffer_load_dwordx4 v13, s[8:11], s31 offen lds
    s_add_u32 m0, s27, 2048
    s_nop 0
    buffer_load_dwordx4 v14, s[8:11], s31 offen lds
    s_add_u32 m0, s27, 3072
    s_nop 0
    buffer_load_dwordx4 v15, s[8:11], s31 offen lds
    s_add_u32 m0, s28, 0
    s_nop 0
    buffer_load_dwordx4 v16, s[12:15], s32 offen lds
    s_add_u32 m0, s28, 1024
    s_nop 0
    buffer_load_dwordx4 v17, s[12:15], s32 offen lds
    s_add_u32 m0, s28, 2048
    s_nop 0
    buffer_load_dwordx4 v18, s[12:15], s32 offen lds
    s_add_u32 m0, s28, 3072
    s_nop 0
    buffer_load_dwordx4 v19, s[12:15], s32 offen lds
    s_add_u32 s31, s31, 128
    s_add_u32 s32, s32, 131072
    s_add_u32 s55, s55, 1
    s_cmp_eq_u32 s55, 4
    s_cselect_b32 s37, 4096, 0
    s_add_u32 s31, s31, s37
    s_cmp_eq_u32 s55, 8
    s_cselect_b32 s37, 4294961152, 0
    s_add_u32 s31, s31, s37
    s_cmp_eq_u32 s55, 12
    s_cselect_b32 s37, 8192, 0
    s_add_u32 s31, s31, s37
    s_add_u32 m0, s27, 32768
    s_nop 0
    buffer_load_dwordx4 v12, s[8:11], s31 offen lds
    s_add_u32 m0, s27, 33792
    s_nop 0
    buffer_load_dwordx4 v13, s[8:11], s31 offen lds
    s_add_u32 m0, s27, 34816
    s_nop 0
    buffer_load_dwordx4 v14, s[8:11], s31 offen lds
    s_add_u32 m0, s27, 35840
    s_nop 0
    buffer_load_dwordx4 v15, s[8:11], s31 offen lds
    s_add_u32 m0, s28, 32768
    s_nop 0
    buffer_load_dwordx4 v16, s[12:15], s32 offen lds
    s_add_u32 m0, s28, 33792
    s_nop 0
    buffer_load_dwordx4 v17, s[12:15], s32 offen lds
    s_add_u32 m0, s28, 34816
    s_nop 0
    buffer_load_dwordx4 v18, s[12:15], s32 offen lds
    s_add_u32 m0, s28, 35840
    s_nop 0
    buffer_load_dwordx4 v19, s[12:15], s32 offen lds
    s_add_u32 s31, s31, 128
    s_add_u32 s32, s32, 131072
    s_add_u32 s55, s55, 1
    s_cmp_eq_u32 s55, 4
    s_cselect_b32 s37, 4096, 0
    s_add_u32 s31, s31, s37
    s_cmp_eq_u32 s55, 8
    s_cselect_b32 s37, 4294961152, 0
    s_add_u32 s31, s31, s37
    s_cmp_eq_u32 s55, 12
    s_cselect_b32 s37, 8192, 0
    s_add_u32 s31, s31, s37
l2_kernel_lloop_6:
    s_cmp_lt_u32 s33, 2
    s_cbranch_scc1 l2_kernel_w0_8
    s_waitcnt vmcnt(8)
    s_branch l2_kernel_w1_9
l2_kernel_w0_8:
    s_waitcnt vmcnt(0)
l2_kernel_w1_9:
    s_barrier
    s_cmp_le_u32 s33, 2
    s_cbranch_scc1 l2_kernel_nd_10
    s_add_u32 m0, s27, 65536
    s_nop 0
    buffer_load_dwordx4 v12, s[8:11], s31 offen lds
    s_add_u32 m0, s27, 66560
    s_nop 0
    buffer_load_dwordx4 v13, s[8:11], s31 offen lds
    s_add_u32 m0, s27, 67584
    s_nop 0
    buffer_load_dwordx4 v14, s[8:11], s31 offen lds
    s_add_u32 m0, s27, 68608
    s_nop 0
    buffer_load_dwordx4 v15, s[8:11], s31 offen lds
    s_add_u32 m0, s28, 65536
    s_nop 0
    buffer_load_dwordx4 v16, s[12:15], s32 offen lds
    s_add_u32 m0, s28, 66560
    s_nop 0
    buffer_load_dwordx4 v17, s[12:15], s32 offen lds
    s_add_u32 m0, s28, 67584
    s_nop 0
    buffer_load_dwordx4 v18, s[12:15], s32 offen lds
    s_add_u32 m0, s28, 68608
    s_nop 0
    buffer_load_dwordx4 v19, s[12:15], s32 offen lds
    s_add_u32 s31, s31, 128
    s_add_u32 s32, s32, 131072
    s_add_u32 s55, s55, 1
    s_cmp_eq_u32 s55, 4
    s_cselect_b32 s37, 4096, 0
    s_add_u32 s31, s31, s37
    s_cmp_eq_u32 s55, 8
    s_cselect_b32 s37, 4294961152, 0
    s_add_u32 s31, s31, s37
    s_cmp_eq_u32 s55, 12
    s_cselect_b32 s37, 8192, 0
    s_add_u32 s31, s31, s37
l2_kernel_nd_10:
    s_sub_u32 s33, s33, 1
    s_cmp_eq_u32 s33, 0
    s_cbranch_scc1 l2_kernel_ldone_7
    s_cmp_lt_u32 s33, 2
    s_cbranch_scc1 l2_kernel_w0_11
    s_waitcnt vmcnt(8)
    s_branch l2_kernel_w1_12
l2_kernel_w0_11:
    s_waitcnt vmcnt(0)
l2_kernel_w1_12:
    s_barrier
    s_cmp_le_u32 s33, 2
    s_cbranch_scc1 l2_kernel_nd_13
    s_add_u32 m0, s27, 0
    s_nop 0
    buffer_load_dwordx4 v12, s[8:11], s31 offen lds
    s_add_u32 m0, s27, 1024
    s_nop 0
    buffer_load_dwordx4 v13, s[8:11], s31 offen lds
    s_add_u32 m0, s27, 2048
    s_nop 0
    buffer_load_dwordx4 v14, s[8:11], s31 offen lds
    s_add_u32 m0, s27, 3072
    s_nop 0
    buffer_load_dwordx4 v15, s[8:11], s31 offen lds
    s_add_u32 m0, s28, 0
    s_nop 0
    buffer_load_dwordx4 v16, s[12:15], s32 offen lds
    s_add_u32 m0, s28, 1024
    s_nop 0
    buffer_load_dwordx4 v17, s[12:15], s32 offen lds
    s_add_u32 m0, s28, 2048
    s_nop 0
    buffer_load_dwordx4 v18, s[12:15], s32 offen lds
    s_add_u32 m0, s28, 3072
    s_nop 0
    buffer_load_dwordx4 v19, s[12:15], s32 offen lds
    s_add_u32 s31, s31, 128
    s_add_u32 s32, s32, 131072
    s_add_u32 s55, s55, 1
    s_cmp_eq_u32 s55, 4
    s_cselect_b32 s37, 4096, 0
    s_add_u32 s31, s31, s37
    s_cmp_eq_u32 s55, 8
    s_cselect_b32 s37, 4294961152, 0
    s_add_u32 s31, s31, s37
    s_cmp_eq_u32 s55, 12
    s_cselect_b32 s37, 8192, 0
    s_add_u32 s31, s31, s37
l2_kernel_nd_13:
    s_sub_u32 s33, s33, 1
    s_cmp_eq_u32 s33, 0
    s_cbranch_scc1 l2_kernel_ldone_7
    s_cmp_lt_u32 s33, 2
    s_cbranch_scc1 l2_kernel_w0_14
    s_waitcnt vmcnt(8)
    s_branch l2_kernel_w1_15
l2_kernel_w0_14:
    s_waitcnt vmcnt(0)
l2_kernel_w1_15:
    s_barrier
    s_cmp_le_u32 s33, 2
    s_cbranch_scc1 l2_kernel_nd_16
    s_add_u32 m0, s27, 32768
    s_nop 0
    buffer_load_dwordx4 v12, s[8:11], s31 offen lds
    s_add_u32 m0, s27, 33792
    s_nop 0
    buffer_load_dwordx4 v13, s[8:11], s31 offen lds
    s_add_u32 m0, s27, 34816
    s_nop 0
    buffer_load_dwordx4 v14, s[8:11], s31 offen lds
    s_add_u32 m0, s27, 35840
    s_nop 0
    buffer_load_dwordx4 v15, s[8:11], s31 offen lds
    s_add_u32 m0, s28, 32768
    s_nop 0
    buffer_load_dwordx4 v16, s[12:15], s32 offen lds
    s_add_u32 m0, s28, 33792
    s_nop 0
    buffer_load_dwordx4 v17, s[12:15], s32 offen lds
    s_add_u32 m0, s28, 34816
    s_nop 0
    buffer_load_dwordx4 v18, s[12:15], s32 offen lds
    s_add_u32 m0, s28, 35840
    s_nop 0
    buffer_load_dwordx4 v19, s[12:15], s32 offen lds
    s_add_u32 s31, s31, 128
    s_add_u32 s32, s32, 131072
    s_add_u32 s55, s55, 1
    s_cmp_eq_u32 s55, 4
    s_cselect_b32 s37, 4096, 0
    s_add_u32 s31, s31, s37
    s_cmp_eq_u32 s55, 8
    s_cselect_b32 s37, 4294961152, 0
    s_add_u32 s31, s31, s37
    s_cmp_eq_u32 s55, 12
    s_cselect_b32 s37, 8192, 0
    s_add_u32 s31, s31, s37
l2_kernel_nd_16:
    s_sub_u32 s33, s33, 1
    s_cmp_eq_u32 s33, 0
    s_cbranch_scc0 l2_kernel_lloop_6
l2_kernel_ldone_7:
    s_endpgm
l2_kernel_comp_4:
    v_and_b32 v116, 63, v114
    s_lshr_b32 s25, s24, 1
    s_and_b32 s26, s24, 1
    v_and_b32 v118, 31, v116
    v_lshrrev_b32 v119, 5, v116
    v_lshrrev_b32 v120, 1, v116
    v_and_b32 v120, 7, v120
    s_mul_i32 s29, s25, 64
    v_add_u32 v121, s29, v118
    v_lshlrev_b32 v121, 7, v121
    v_add_u32 v122, 0, v119
    v_xor_b32 v122, v122, v120
    v_lshlrev_b32 v122, 4, v122
    v_add_u32 v96, v121, v122
    v_add_u32 v100, 32768, v96
    v_add_u32 v104, 65536, v96
    v_add_u32 v122, 2, v119
    v_xor_b32 v122, v122, v120
    v_lshlrev_b32 v122, 4, v122
    v_add_u32 v97, v121, v122
    v_add_u32 v101, 32768, v97
    v_add_u32 v105, 65536, v97
    v_add_u32 v122, 4, v119
    v_xor_b32 v122, v122, v120
    v_lshlrev_b32 v122, 4, v122
    v_add_u32 v98, v121, v122
    v_add_u32 v102, 32768, v98
    v_add_u32 v106, 65536, v98
    v_add_u32 v122, 6, v119
    v_xor_b32 v122, v122, v120
    v_lshlrev_b32 v122, 4, v122
    v_add_u32 v99, v121, v122
    v_add_u32 v103, 32768, v99
    v_add_u32 v107, 65536, v99
    v_lshrrev_b32 v118, 4, v116
    v_and_b32 v119, 15, v116
    v_lshrrev_b32 v119, 2, v119
    v_and_b32 v120, 3, v116
    v_lshrrev_b32 v121, 1, v118
    v_lshlrev_b32 v121, 3, v121
    v_add_u32 v121, v121, v119
    v_mul_u32_u24 v121, 256, v121
    v_and_b32 v122, 1, v118
    v_lshlrev_b32 v122, 1, v122
    v_lshrrev_b32 v123, 1, v120
    v_add_u32 v122, v122, v123
    s_mul_i32 s29, s26, 8
    v_add_u32 v122, s29, v122
    v_lshlrev_b32 v123, 2, v119
    v_and_b32 v120, 1, v120
    v_lshlrev_b32 v120, 3, v120
    v_add_u32 v121, v121, v120
    v_add_u32 v121, 16384, v121
    v_add_u32 v108, 0, v122
    v_xor_b32 v108, v108, v123
    v_lshlrev_b32 v108, 4, v108
    v_add_u32 v108, v108, v121
    v_add_u32 v110, 32768, v108
    v_add_u32 v112, 65536, v108
    v_add_u32 v109, 4, v122
    v_xor_b32 v109, v109, v123
    v_lshlrev_b32 v109, 4, v109
    v_add_u32 v109, v109, v121
    v_add_u32 v111, 32768, v109
    v_add_u32 v113, 65536, v109
    v_mov_b32 v0, 0
    v_mov_b32 v1, 0
    v_mov_b32 v2, 0
    v_mov_b32 v3, 0
    v_mov_b32 v4, 0
    v_mov_b32 v5, 0
    v_mov_b32 v6, 0
    v_mov_b32 v7, 0
    v_mov_b32 v8, 0
    v_mov_b32 v9, 0
    v_mov_b32 v10, 0
    v_mov_b32 v11, 0
    v_mov_b32 v12, 0
    v_mov_b32 v13, 0
    v_mov_b32 v14, 0
    v_mov_b32 v15, 0
    v_mov_b32 v16, 0
    v_mov_b32 v17, 0
    v_mov_b32 v18, 0
    v_mov_b32 v19, 0
    v_mov_b32 v20, 0
    v_mov_b32 v21, 0
    v_mov_b32 v22, 0
    v_mov_b32 v23, 0
    v_mov_b32 v24, 0
    v_mov_b32 v25, 0
    v_mov_b32 v26, 0
    v_mov_b32 v27, 0
    v_mov_b32 v28, 0
    v_mov_b32 v29, 0
    v_mov_b32 v30, 0
    v_mov_b32 v31, 0
    v_mov_b32 v32, 0
    v_mov_b32 v33, 0
    v_mov_b32 v34, 0
    v_mov_b32 v35, 0
    v_mov_b32 v36, 0
    v_mov_b32 v37, 0
    v_mov_b32 v38, 0
    v_mov_b32 v39, 0
    v_mov_b32 v40, 0
    v_mov_b32 v41, 0
    v_mov_b32 v42, 0
    v_mov_b32 v43, 0
    v_mov_b32 v44, 0
    v_mov_b32 v45, 0
    v_mov_b32 v46, 0
    v_mov_b32 v47, 0
    v_mov_b32 v48, 0
    v_mov_b32 v49, 0
    v_mov_b32 v50, 0
    v_mov_b32 v51, 0
    v_mov_b32 v52, 0
    v_mov_b32 v53, 0
    v_mov_b32 v54, 0
    v_mov_b32 v55, 0
    v_mov_b32 v56, 0
    v_mov_b32 v57, 0
    v_mov_b32 v58, 0
    v_mov_b32 v59, 0
    v_mov_b32 v60, 0
    v_mov_b32 v61, 0
    v_mov_b32 v62, 0
    v_mov_b32 v63, 0
    v_mov_b32 v72, 0
    v_mov_b32 v73, 0
    v_mov_b32 v74, 0
    v_mov_b32 v75, 0
    v_mov_b32 v76, 0
    v_mov_b32 v77, 0
    v_mov_b32 v78, 0
    v_mov_b32 v79, 0
    v_mov_b32 v88, 0
    v_mov_b32 v89, 0
    v_mov_b32 v90, 0
    v_mov_b32 v91, 0
    v_mov_b32 v92, 0
    v_mov_b32 v93, 0
    v_mov_b32 v94, 0
    v_mov_b32 v95, 0
    s_load_dwordx2 s[4:5], s[0:1], 0
    s_waitcnt lgkmcnt(0)
    s_mov_b32 s20, s4
    s_mov_b32 s21, s5
    s_and_b32 s21, s21, 0xffff
    s_mov_b32 s22, 4194304
    s_mov_b32 s23, 0x00020000
    s_add_u32 s44, s40, 48300032
    s_addc_u32 s45, s41, 0
    s_and_b32 s45, s45, 0xffff
    s_mov_b32 s46, 262144
    s_mov_b32 s47, 0x00020000
l2_kernel_loop_17:
    s_waitcnt lgkmcnt(0)
    s_barrier
    ds_read_b128 v[64:67], v96 offset:0
    ds_read_b128 v[68:71], v96 offset:4096
    ds_read_b64_tr_b16 v[80:81], v108 offset:0
    ds_read_b64_tr_b16 v[82:83], v108 offset:1024
    ds_read_b64_tr_b16 v[84:85], v109 offset:0
    ds_read_b64_tr_b16 v[86:87], v109 offset:1024
    v_mfma_f32_32x32x16_bf16 v[0:15], v[88:91], v[72:75], v[0:15]
    v_mfma_f32_32x32x16_bf16 v[16:31], v[88:91], v[76:79], v[16:31]
    v_mfma_f32_32x32x16_bf16 v[32:47], v[92:95], v[72:75], v[32:47]
    v_mfma_f32_32x32x16_bf16 v[48:63], v[92:95], v[76:79], v[48:63]
    ds_read_b128 v[72:75], v97 offset:0
    ds_read_b128 v[76:79], v97 offset:4096
    ds_read_b64_tr_b16 v[88:89], v108 offset:4096
    ds_read_b64_tr_b16 v[90:91], v108 offset:5120
    ds_read_b64_tr_b16 v[92:93], v109 offset:4096
    ds_read_b64_tr_b16 v[94:95], v109 offset:5120
    s_waitcnt lgkmcnt(6)
    v_mfma_f32_32x32x16_bf16 v[0:15], v[80:83], v[64:67], v[0:15]
    v_mfma_f32_32x32x16_bf16 v[16:31], v[80:83], v[68:71], v[16:31]
    v_mfma_f32_32x32x16_bf16 v[32:47], v[84:87], v[64:67], v[32:47]
    v_mfma_f32_32x32x16_bf16 v[48:63], v[84:87], v[68:71], v[48:63]
    ds_read_b128 v[64:67], v98 offset:0
    ds_read_b128 v[68:71], v98 offset:4096
    ds_read_b64_tr_b16 v[80:81], v108 offset:8192
    ds_read_b64_tr_b16 v[82:83], v108 offset:9216
    ds_read_b64_tr_b16 v[84:85], v109 offset:8192
    ds_read_b64_tr_b16 v[86:87], v109 offset:9216
    s_waitcnt lgkmcnt(6)
    v_mfma_f32_32x32x16_bf16 v[0:15], v[88:91], v[72:75], v[0:15]
    v_mfma_f32_32x32x16_bf16 v[16:31], v[88:91], v[76:79], v[16:31]
    v_mfma_f32_32x32x16_bf16 v[32:47], v[92:95], v[72:75], v[32:47]
    v_mfma_f32_32x32x16_bf16 v[48:63], v[92:95], v[76:79], v[48:63]
    ds_read_b128 v[72:75], v99 offset:0
    ds_read_b128 v[76:79], v99 offset:4096
    ds_read_b64_tr_b16 v[88:89], v108 offset:12288
    ds_read_b64_tr_b16 v[90:91], v108 offset:13312
    ds_read_b64_tr_b16 v[92:93], v109 offset:12288
    ds_read_b64_tr_b16 v[94:95], v109 offset:13312
    s_waitcnt lgkmcnt(6)
    v_mfma_f32_32x32x16_bf16 v[0:15], v[80:83], v[64:67], v[0:15]
    v_mfma_f32_32x32x16_bf16 v[16:31], v[80:83], v[68:71], v[16:31]
    v_mfma_f32_32x32x16_bf16 v[32:47], v[84:87], v[64:67], v[32:47]
    v_mfma_f32_32x32x16_bf16 v[48:63], v[84:87], v[68:71], v[48:63]
    s_sub_u32 s33, s33, 1
    s_cmp_eq_u32 s33, 0
    s_cbranch_scc1 l2_kernel_exit_18
    s_waitcnt lgkmcnt(0)
    s_barrier
    ds_read_b128 v[64:67], v100 offset:0
    ds_read_b128 v[68:71], v100 offset:4096
    ds_read_b64_tr_b16 v[80:81], v110 offset:0
    ds_read_b64_tr_b16 v[82:83], v110 offset:1024
    ds_read_b64_tr_b16 v[84:85], v111 offset:0
    ds_read_b64_tr_b16 v[86:87], v111 offset:1024
    v_mfma_f32_32x32x16_bf16 v[0:15], v[88:91], v[72:75], v[0:15]
    v_mfma_f32_32x32x16_bf16 v[16:31], v[88:91], v[76:79], v[16:31]
    v_mfma_f32_32x32x16_bf16 v[32:47], v[92:95], v[72:75], v[32:47]
    v_mfma_f32_32x32x16_bf16 v[48:63], v[92:95], v[76:79], v[48:63]
    ds_read_b128 v[72:75], v101 offset:0
    ds_read_b128 v[76:79], v101 offset:4096
    ds_read_b64_tr_b16 v[88:89], v110 offset:4096
    ds_read_b64_tr_b16 v[90:91], v110 offset:5120
    ds_read_b64_tr_b16 v[92:93], v111 offset:4096
    ds_read_b64_tr_b16 v[94:95], v111 offset:5120
    s_waitcnt lgkmcnt(6)
    v_mfma_f32_32x32x16_bf16 v[0:15], v[80:83], v[64:67], v[0:15]
    v_mfma_f32_32x32x16_bf16 v[16:31], v[80:83], v[68:71], v[16:31]
    v_mfma_f32_32x32x16_bf16 v[32:47], v[84:87], v[64:67], v[32:47]
    v_mfma_f32_32x32x16_bf16 v[48:63], v[84:87], v[68:71], v[48:63]
    ds_read_b128 v[64:67], v102 offset:0
    ds_read_b128 v[68:71], v102 offset:4096
    ds_read_b64_tr_b16 v[80:81], v110 offset:8192
    ds_read_b64_tr_b16 v[82:83], v110 offset:9216
    ds_read_b64_tr_b16 v[84:85], v111 offset:8192
    ds_read_b64_tr_b16 v[86:87], v111 offset:9216
    s_waitcnt lgkmcnt(6)
    v_mfma_f32_32x32x16_bf16 v[0:15], v[88:91], v[72:75], v[0:15]
    v_mfma_f32_32x32x16_bf16 v[16:31], v[88:91], v[76:79], v[16:31]
    v_mfma_f32_32x32x16_bf16 v[32:47], v[92:95], v[72:75], v[32:47]
    v_mfma_f32_32x32x16_bf16 v[48:63], v[92:95], v[76:79], v[48:63]
    ds_read_b128 v[72:75], v103 offset:0
    ds_read_b128 v[76:79], v103 offset:4096
    ds_read_b64_tr_b16 v[88:89], v110 offset:12288
    ds_read_b64_tr_b16 v[90:91], v110 offset:13312
    ds_read_b64_tr_b16 v[92:93], v111 offset:12288
    ds_read_b64_tr_b16 v[94:95], v111 offset:13312
    s_waitcnt lgkmcnt(6)
    v_mfma_f32_32x32x16_bf16 v[0:15], v[80:83], v[64:67], v[0:15]
    v_mfma_f32_32x32x16_bf16 v[16:31], v[80:83], v[68:71], v[16:31]
    v_mfma_f32_32x32x16_bf16 v[32:47], v[84:87], v[64:67], v[32:47]
    v_mfma_f32_32x32x16_bf16 v[48:63], v[84:87], v[68:71], v[48:63]
    s_sub_u32 s33, s33, 1
    s_cmp_eq_u32 s33, 0
    s_cbranch_scc1 l2_kernel_exit_18
    s_waitcnt lgkmcnt(0)
    s_barrier
    ds_read_b128 v[64:67], v104 offset:0
    ds_read_b128 v[68:71], v104 offset:4096
    ds_read_b64_tr_b16 v[80:81], v112 offset:0
    ds_read_b64_tr_b16 v[82:83], v112 offset:1024
    ds_read_b64_tr_b16 v[84:85], v113 offset:0
    ds_read_b64_tr_b16 v[86:87], v113 offset:1024
    v_mfma_f32_32x32x16_bf16 v[0:15], v[88:91], v[72:75], v[0:15]
    v_mfma_f32_32x32x16_bf16 v[16:31], v[88:91], v[76:79], v[16:31]
    v_mfma_f32_32x32x16_bf16 v[32:47], v[92:95], v[72:75], v[32:47]
    v_mfma_f32_32x32x16_bf16 v[48:63], v[92:95], v[76:79], v[48:63]
    ds_read_b128 v[72:75], v105 offset:0
    ds_read_b128 v[76:79], v105 offset:4096
    ds_read_b64_tr_b16 v[88:89], v112 offset:4096
    ds_read_b64_tr_b16 v[90:91], v112 offset:5120
    ds_read_b64_tr_b16 v[92:93], v113 offset:4096
    ds_read_b64_tr_b16 v[94:95], v113 offset:5120
    s_waitcnt lgkmcnt(6)
    v_mfma_f32_32x32x16_bf16 v[0:15], v[80:83], v[64:67], v[0:15]
    v_mfma_f32_32x32x16_bf16 v[16:31], v[80:83], v[68:71], v[16:31]
    v_mfma_f32_32x32x16_bf16 v[32:47], v[84:87], v[64:67], v[32:47]
    v_mfma_f32_32x32x16_bf16 v[48:63], v[84:87], v[68:71], v[48:63]
    ds_read_b128 v[64:67], v106 offset:0
    ds_read_b128 v[68:71], v106 offset:4096
    ds_read_b64_tr_b16 v[80:81], v112 offset:8192
    ds_read_b64_tr_b16 v[82:83], v112 offset:9216
    ds_read_b64_tr_b16 v[84:85], v113 offset:8192
    ds_read_b64_tr_b16 v[86:87], v113 offset:9216
    s_waitcnt lgkmcnt(6)
    v_mfma_f32_32x32x16_bf16 v[0:15], v[88:91], v[72:75], v[0:15]
    v_mfma_f32_32x32x16_bf16 v[16:31], v[88:91], v[76:79], v[16:31]
    v_mfma_f32_32x32x16_bf16 v[32:47], v[92:95], v[72:75], v[32:47]
    v_mfma_f32_32x32x16_bf16 v[48:63], v[92:95], v[76:79], v[48:63]
    ds_read_b128 v[72:75], v107 offset:0
    ds_read_b128 v[76:79], v107 offset:4096
    ds_read_b64_tr_b16 v[88:89], v112 offset:12288
    ds_read_b64_tr_b16 v[90:91], v112 offset:13312
    ds_read_b64_tr_b16 v[92:93], v113 offset:12288
    ds_read_b64_tr_b16 v[94:95], v113 offset:13312
    s_waitcnt lgkmcnt(6)
    v_mfma_f32_32x32x16_bf16 v[0:15], v[80:83], v[64:67], v[0:15]
    v_mfma_f32_32x32x16_bf16 v[16:31], v[80:83], v[68:71], v[16:31]
    v_mfma_f32_32x32x16_bf16 v[32:47], v[84:87], v[64:67], v[32:47]
    v_mfma_f32_32x32x16_bf16 v[48:63], v[84:87], v[68:71], v[48:63]
    s_sub_u32 s33, s33, 1
    s_cmp_eq_u32 s33, 0
    s_cbranch_scc0 l2_kernel_loop_17
l2_kernel_exit_18:
    s_waitcnt lgkmcnt(0)
    v_mfma_f32_32x32x16_bf16 v[0:15], v[88:91], v[72:75], v[0:15]
    v_mfma_f32_32x32x16_bf16 v[16:31], v[88:91], v[76:79], v[16:31]
    v_mfma_f32_32x32x16_bf16 v[32:47], v[92:95], v[72:75], v[32:47]
    v_mfma_f32_32x32x16_bf16 v[48:63], v[92:95], v[76:79], v[48:63]
    s_barrier
    v_and_b32 v64, 63, v114
    v_and_b32 v65, 31, v64
    v_lshrrev_b32 v66, 5, v64
    s_mul_i32 s36, s24, 8192
    v_lshlrev_b32 v68, 7, v65
    v_add_u32 v68, s36, v68
    v_and_b32 v69, 7, v65
    v_lshrrev_b32 v70, 3, v64
    v_and_b32 v71, 7, v64
    v_lshlrev_b32 v80, 7, v70
    v_lshl_add_u32 v80, v71, 4, v80
    v_add_u32 v80, s36, v80
    s_mul_i32 s29, s34, 128
    s_mul_i32 s30, s25, 64
    s_add_u32 s29, s29, s30
    s_mov_b32 s53, s29
    v_add_u32 v67, s29, v70
    s_mov_b32 s30, 2048
    v_mul_lo_u32 v67, v67, s30
    v_xor_b32 v71, v71, v70
    v_lshlrev_b32 v71, 4, v71
    s_mul_i32 s54, s35, 128
    s_mul_i32 s30, s26, 64
    s_add_u32 s54, s54, s30
    s_lshl_b32 s29, s54, 1
    v_add3_u32 v67, v67, v71, s29
    v_add_u32 v81, 0, v66
    v_xor_b32 v81, v81, v69
    v_lshl_add_u32 v81, v81, 4, v68
    v_add_u32 v82, 2, v66
    v_xor_b32 v82, v82, v69
    v_lshl_add_u32 v82, v82, 4, v68
    v_add_u32 v83, 4, v66
    v_xor_b32 v83, v83, v69
    v_lshl_add_u32 v83, v83, 4, v68
    v_add_u32 v84, 6, v66
    v_xor_b32 v84, v84, v69
    v_lshl_add_u32 v84, v84, 4, v68
    v_add_u32 v88, s53, v65
    v_lshlrev_b32 v88, 11, v88
    v_lshl_add_u32 v88, v66, 3, v88
    s_lshl_b32 s29, s54, 1
    v_add_u32 v88, s29, v88
    buffer_load_dwordx2 v[128:129], v88, s[20:23], 0 offen offset:0
    buffer_load_dwordx2 v[130:131], v88, s[20:23], 0 offen offset:16
    buffer_load_dwordx2 v[132:133], v88, s[20:23], 0 offen offset:32
    buffer_load_dwordx2 v[134:135], v88, s[20:23], 0 offen offset:48
    buffer_load_dwordx2 v[144:145], v88, s[20:23], 0 offen offset:64
    buffer_load_dwordx2 v[146:147], v88, s[20:23], 0 offen offset:80
    buffer_load_dwordx2 v[148:149], v88, s[20:23], 0 offen offset:96
    buffer_load_dwordx2 v[150:151], v88, s[20:23], 0 offen offset:112
    v_add_u32 v88, 65536, v88
    buffer_load_dwordx2 v[136:137], v88, s[20:23], 0 offen offset:0
    buffer_load_dwordx2 v[138:139], v88, s[20:23], 0 offen offset:16
    buffer_load_dwordx2 v[140:141], v88, s[20:23], 0 offen offset:32
    buffer_load_dwordx2 v[142:143], v88, s[20:23], 0 offen offset:48
    buffer_load_dwordx2 v[152:153], v88, s[20:23], 0 offen offset:64
    buffer_load_dwordx2 v[154:155], v88, s[20:23], 0 offen offset:80
    buffer_load_dwordx2 v[156:157], v88, s[20:23], 0 offen offset:96
    buffer_load_dwordx2 v[158:159], v88, s[20:23], 0 offen offset:112
    v_add_u32 v103, s53, v65
    v_lshlrev_b32 v103, 7, v103
    s_lshr_b32 s29, s54, 3
    v_add_u32 v103, s29, v103
    v_mov_b32 v100, 0
    v_mov_b32 v101, 0
    v_cvt_pk_bf16_f32 v102, v0, v1
    v_lshlrev_b32 v0, 16, v102
    v_and_b32 v1, 0xffff0000, v102
    v_cvt_pk_bf16_f32 v102, v2, v3
    v_lshlrev_b32 v2, 16, v102
    v_and_b32 v3, 0xffff0000, v102
    v_cvt_pk_bf16_f32 v102, v4, v5
    v_lshlrev_b32 v4, 16, v102
    v_and_b32 v5, 0xffff0000, v102
    v_cvt_pk_bf16_f32 v102, v6, v7
    v_lshlrev_b32 v6, 16, v102
    v_and_b32 v7, 0xffff0000, v102
    v_cvt_pk_bf16_f32 v102, v8, v9
    v_lshlrev_b32 v8, 16, v102
    v_and_b32 v9, 0xffff0000, v102
    v_cvt_pk_bf16_f32 v102, v10, v11
    v_lshlrev_b32 v10, 16, v102
    v_and_b32 v11, 0xffff0000, v102
    v_cvt_pk_bf16_f32 v102, v12, v13
    v_lshlrev_b32 v12, 16, v102
    v_and_b32 v13, 0xffff0000, v102
    v_cvt_pk_bf16_f32 v102, v14, v15
    v_lshlrev_b32 v14, 16, v102
    v_and_b32 v15, 0xffff0000, v102
    s_waitcnt vmcnt(0)
    v_lshlrev_b32 v102, 16, v128
    v_add_f32 v0, v0, v102
    v_and_b32 v102, 0xffff0000, v128
    v_add_f32 v1, v1, v102
    v_lshlrev_b32 v102, 16, v129
    v_add_f32 v2, v2, v102
    v_and_b32 v102, 0xffff0000, v129
    v_add_f32 v3, v3, v102
    v_lshlrev_b32 v102, 16, v130
    v_add_f32 v4, v4, v102
    v_and_b32 v102, 0xffff0000, v130
    v_add_f32 v5, v5, v102
    v_lshlrev_b32 v102, 16, v131
    v_add_f32 v6, v6, v102
    v_and_b32 v102, 0xffff0000, v131
    v_add_f32 v7, v7, v102
    v_lshlrev_b32 v102, 16, v132
    v_add_f32 v8, v8, v102
    v_and_b32 v102, 0xffff0000, v132
    v_add_f32 v9, v9, v102
    v_lshlrev_b32 v102, 16, v133
    v_add_f32 v10, v10, v102
    v_and_b32 v102, 0xffff0000, v133
    v_add_f32 v11, v11, v102
    v_lshlrev_b32 v102, 16, v134
    v_add_f32 v12, v12, v102
    v_and_b32 v102, 0xffff0000, v134
    v_add_f32 v13, v13, v102
    v_lshlrev_b32 v102, 16, v135
    v_add_f32 v14, v14, v102
    v_and_b32 v102, 0xffff0000, v135
    v_add_f32 v15, v15, v102
    v_cvt_pk_bf16_f32 v102, v0, v1
    v_lshlrev_b32 v0, 16, v102
    v_and_b32 v1, 0xffff0000, v102
    v_cvt_pk_bf16_f32 v102, v2, v3
    v_lshlrev_b32 v2, 16, v102
    v_and_b32 v3, 0xffff0000, v102
    v_cvt_pk_bf16_f32 v102, v4, v5
    v_lshlrev_b32 v4, 16, v102
    v_and_b32 v5, 0xffff0000, v102
    v_cvt_pk_bf16_f32 v102, v6, v7
    v_lshlrev_b32 v6, 16, v102
    v_and_b32 v7, 0xffff0000, v102
    v_cvt_pk_bf16_f32 v102, v8, v9
    v_lshlrev_b32 v8, 16, v102
    v_and_b32 v9, 0xffff0000, v102
    v_cvt_pk_bf16_f32 v102, v10, v11
    v_lshlrev_b32 v10, 16, v102
    v_and_b32 v11, 0xffff0000, v102
    v_cvt_pk_bf16_f32 v102, v12, v13
    v_lshlrev_b32 v12, 16, v102
    v_and_b32 v13, 0xffff0000, v102
    v_cvt_pk_bf16_f32 v102, v14, v15
    v_lshlrev_b32 v14, 16, v102
    v_and_b32 v15, 0xffff0000, v102
    v_add_f32 v100, v100, v0
    v_fmac_f32 v101, v0, v0
    v_add_f32 v100, v100, v1
    v_fmac_f32 v101, v1, v1
    v_add_f32 v100, v100, v2
    v_fmac_f32 v101, v2, v2
    v_add_f32 v100, v100, v3
    v_fmac_f32 v101, v3, v3
    v_add_f32 v100, v100, v4
    v_fmac_f32 v101, v4, v4
    v_add_f32 v100, v100, v5
    v_fmac_f32 v101, v5, v5
    v_add_f32 v100, v100, v6
    v_fmac_f32 v101, v6, v6
    v_add_f32 v100, v100, v7
    v_fmac_f32 v101, v7, v7
    v_add_f32 v100, v100, v8
    v_fmac_f32 v101, v8, v8
    v_add_f32 v100, v100, v9
    v_fmac_f32 v101, v9, v9
    v_add_f32 v100, v100, v10
    v_fmac_f32 v101, v10, v10
    v_add_f32 v100, v100, v11
    v_fmac_f32 v101, v11, v11
    v_add_f32 v100, v100, v12
    v_fmac_f32 v101, v12, v12
    v_add_f32 v100, v100, v13
    v_fmac_f32 v101, v13, v13
    v_add_f32 v100, v100, v14
    v_fmac_f32 v101, v14, v14
    v_add_f32 v100, v100, v15
    v_fmac_f32 v101, v15, v15
    v_cvt_pk_bf16_f32 v72, v0, v1
    v_cvt_pk_bf16_f32 v73, v2, v3
    v_cvt_pk_bf16_f32 v74, v4, v5
    v_cvt_pk_bf16_f32 v75, v6, v7
    v_cvt_pk_bf16_f32 v76, v8, v9
    v_cvt_pk_bf16_f32 v77, v10, v11
    v_cvt_pk_bf16_f32 v78, v12, v13
    v_cvt_pk_bf16_f32 v79, v14, v15
    v_permlane32_swap_b32 v72, v74
    v_permlane32_swap_b32 v73, v75
    v_permlane32_swap_b32 v76, v78
    v_permlane32_swap_b32 v77, v79
    ds_write_b128 v81, v[72:75] offset:0
    ds_write_b128 v82, v[76:79] offset:0
    v_cvt_pk_bf16_f32 v102, v32, v33
    v_lshlrev_b32 v32, 16, v102
    v_and_b32 v33, 0xffff0000, v102
    v_cvt_pk_bf16_f32 v102, v34, v35
    v_lshlrev_b32 v34, 16, v102
    v_and_b32 v35, 0xffff0000, v102
    v_cvt_pk_bf16_f32 v102, v36, v37
    v_lshlrev_b32 v36, 16, v102
    v_and_b32 v37, 0xffff0000, v102
    v_cvt_pk_bf16_f32 v102, v38, v39
    v_lshlrev_b32 v38, 16, v102
    v_and_b32 v39, 0xffff0000, v102
    v_cvt_pk_bf16_f32 v102, v40, v41
    v_lshlrev_b32 v40, 16, v102
    v_and_b32 v41, 0xffff0000, v102
    v_cvt_pk_bf16_f32 v102, v42, v43
    v_lshlrev_b32 v42, 16, v102
    v_and_b32 v43, 0xffff0000, v102
    v_cvt_pk_bf16_f32 v102, v44, v45
    v_lshlrev_b32 v44, 16, v102
    v_and_b32 v45, 0xffff0000, v102
    v_cvt_pk_bf16_f32 v102, v46, v47
    v_lshlrev_b32 v46, 16, v102
    v_and_b32 v47, 0xffff0000, v102
    v_lshlrev_b32 v102, 16, v144
    v_add_f32 v32, v32, v102
    v_and_b32 v102, 0xffff0000, v144
    v_add_f32 v33, v33, v102
    v_lshlrev_b32 v102, 16, v145
    v_add_f32 v34, v34, v102
    v_and_b32 v102, 0xffff0000, v145
    v_add_f32 v35, v35, v102
    v_lshlrev_b32 v102, 16, v146
    v_add_f32 v36, v36, v102
    v_and_b32 v102, 0xffff0000, v146
    v_add_f32 v37, v37, v102
    v_lshlrev_b32 v102, 16, v147
    v_add_f32 v38, v38, v102
    v_and_b32 v102, 0xffff0000, v147
    v_add_f32 v39, v39, v102
    v_lshlrev_b32 v102, 16, v148
    v_add_f32 v40, v40, v102
    v_and_b32 v102, 0xffff0000, v148
    v_add_f32 v41, v41, v102
    v_lshlrev_b32 v102, 16, v149
    v_add_f32 v42, v42, v102
    v_and_b32 v102, 0xffff0000, v149
    v_add_f32 v43, v43, v102
    v_lshlrev_b32 v102, 16, v150
    v_add_f32 v44, v44, v102
    v_and_b32 v102, 0xffff0000, v150
    v_add_f32 v45, v45, v102
    v_lshlrev_b32 v102, 16, v151
    v_add_f32 v46, v46, v102
    v_and_b32 v102, 0xffff0000, v151
    v_add_f32 v47, v47, v102
    v_cvt_pk_bf16_f32 v102, v32, v33
    v_lshlrev_b32 v32, 16, v102
    v_and_b32 v33, 0xffff0000, v102
    v_cvt_pk_bf16_f32 v102, v34, v35
    v_lshlrev_b32 v34, 16, v102
    v_and_b32 v35, 0xffff0000, v102
    v_cvt_pk_bf16_f32 v102, v36, v37
    v_lshlrev_b32 v36, 16, v102
    v_and_b32 v37, 0xffff0000, v102
    v_cvt_pk_bf16_f32 v102, v38, v39
    v_lshlrev_b32 v38, 16, v102
    v_and_b32 v39, 0xffff0000, v102
    v_cvt_pk_bf16_f32 v102, v40, v41
    v_lshlrev_b32 v40, 16, v102
    v_and_b32 v41, 0xffff0000, v102
    v_cvt_pk_bf16_f32 v102, v42, v43
    v_lshlrev_b32 v42, 16, v102
    v_and_b32 v43, 0xffff0000, v102
    v_cvt_pk_bf16_f32 v102, v44, v45
    v_lshlrev_b32 v44, 16, v102
    v_and_b32 v45, 0xffff0000, v102
    v_cvt_pk_bf16_f32 v102, v46, v47
    v_lshlrev_b32 v46, 16, v102
    v_and_b32 v47, 0xffff0000, v102
    v_add_f32 v100, v100, v32
    v_fmac_f32 v101, v32, v32
    v_add_f32 v100, v100, v33
    v_fmac_f32 v101, v33, v33
    v_add_f32 v100, v100, v34
    v_fmac_f32 v101, v34, v34
    v_add_f32 v100, v100, v35
    v_fmac_f32 v101, v35, v35
    v_add_f32 v100, v100, v36
    v_fmac_f32 v101, v36, v36
    v_add_f32 v100, v100, v37
    v_fmac_f32 v101, v37, v37
    v_add_f32 v100, v100, v38
    v_fmac_f32 v101, v38, v38
    v_add_f32 v100, v100, v39
    v_fmac_f32 v101, v39, v39
    v_add_f32 v100, v100, v40
    v_fmac_f32 v101, v40, v40
    v_add_f32 v100, v100, v41
    v_fmac_f32 v101, v41, v41
    v_add_f32 v100, v100, v42
    v_fmac_f32 v101, v42, v42
    v_add_f32 v100, v100, v43
    v_fmac_f32 v101, v43, v43
    v_add_f32 v100, v100, v44
    v_fmac_f32 v101, v44, v44
    v_add_f32 v100, v100, v45
    v_fmac_f32 v101, v45, v45
    v_add_f32 v100, v100, v46
    v_fmac_f32 v101, v46, v46
    v_add_f32 v100, v100, v47
    v_fmac_f32 v101, v47, v47
    v_mov_b32 v102, v100
    s_nop 1
    v_permlane32_swap_b32 v100, v102
    v_add_f32 v100, v100, v102
    v_mov_b32 v102, v101
    s_nop 1
    v_permlane32_swap_b32 v101, v102
    v_add_f32 v101, v101, v102
    v_cmp_gt_u32 vcc, 32, v64
    s_nop 0
    s_and_saveexec_b64 s[56:57], vcc
    buffer_store_dwordx2 v[100:101], v103, s[44:47], 0 offen
    s_mov_b64 exec, s[56:57]
    v_add_u32 v103, 4096, v103
    v_cvt_pk_bf16_f32 v72, v32, v33
    v_cvt_pk_bf16_f32 v73, v34, v35
    v_cvt_pk_bf16_f32 v74, v36, v37
    v_cvt_pk_bf16_f32 v75, v38, v39
    v_cvt_pk_bf16_f32 v76, v40, v41
    v_cvt_pk_bf16_f32 v77, v42, v43
    v_cvt_pk_bf16_f32 v78, v44, v45
    v_cvt_pk_bf16_f32 v79, v46, v47
    v_permlane32_swap_b32 v72, v74
    v_permlane32_swap_b32 v73, v75
    v_permlane32_swap_b32 v76, v78
    v_permlane32_swap_b32 v77, v79
    ds_write_b128 v83, v[72:75] offset:0
    ds_write_b128 v84, v[76:79] offset:0
    v_mov_b32 v100, 0
    v_mov_b32 v101, 0
    v_cvt_pk_bf16_f32 v102, v16, v17
    v_lshlrev_b32 v16, 16, v102
    v_and_b32 v17, 0xffff0000, v102
    v_cvt_pk_bf16_f32 v102, v18, v19
    v_lshlrev_b32 v18, 16, v102
    v_and_b32 v19, 0xffff0000, v102
    v_cvt_pk_bf16_f32 v102, v20, v21
    v_lshlrev_b32 v20, 16, v102
    v_and_b32 v21, 0xffff0000, v102
    v_cvt_pk_bf16_f32 v102, v22, v23
    v_lshlrev_b32 v22, 16, v102
    v_and_b32 v23, 0xffff0000, v102
    v_cvt_pk_bf16_f32 v102, v24, v25
    v_lshlrev_b32 v24, 16, v102
    v_and_b32 v25, 0xffff0000, v102
    v_cvt_pk_bf16_f32 v102, v26, v27
    v_lshlrev_b32 v26, 16, v102
    v_and_b32 v27, 0xffff0000, v102
    v_cvt_pk_bf16_f32 v102, v28, v29
    v_lshlrev_b32 v28, 16, v102
    v_and_b32 v29, 0xffff0000, v102
    v_cvt_pk_bf16_f32 v102, v30, v31
    v_lshlrev_b32 v30, 16, v102
    v_and_b32 v31, 0xffff0000, v102
    v_lshlrev_b32 v102, 16, v136
    v_add_f32 v16, v16, v102
    v_and_b32 v102, 0xffff0000, v136
    v_add_f32 v17, v17, v102
    v_lshlrev_b32 v102, 16, v137
    v_add_f32 v18, v18, v102
    v_and_b32 v102, 0xffff0000, v137
    v_add_f32 v19, v19, v102
    v_lshlrev_b32 v102, 16, v138
    v_add_f32 v20, v20, v102
    v_and_b32 v102, 0xffff0000, v138
    v_add_f32 v21, v21, v102
    v_lshlrev_b32 v102, 16, v139
    v_add_f32 v22, v22, v102
    v_and_b32 v102, 0xffff0000, v139
    v_add_f32 v23, v23, v102
    v_lshlrev_b32 v102, 16, v140
    v_add_f32 v24, v24, v102
    v_and_b32 v102, 0xffff0000, v140
    v_add_f32 v25, v25, v102
    v_lshlrev_b32 v102, 16, v141
    v_add_f32 v26, v26, v102
    v_and_b32 v102, 0xffff0000, v141
    v_add_f32 v27, v27, v102
    v_lshlrev_b32 v102, 16, v142
    v_add_f32 v28, v28, v102
    v_and_b32 v102, 0xffff0000, v142
    v_add_f32 v29, v29, v102
    v_lshlrev_b32 v102, 16, v143
    v_add_f32 v30, v30, v102
    v_and_b32 v102, 0xffff0000, v143
    v_add_f32 v31, v31, v102
    v_cvt_pk_bf16_f32 v102, v16, v17
    v_lshlrev_b32 v16, 16, v102
    v_and_b32 v17, 0xffff0000, v102
    v_cvt_pk_bf16_f32 v102, v18, v19
    v_lshlrev_b32 v18, 16, v102
    v_and_b32 v19, 0xffff0000, v102
    v_cvt_pk_bf16_f32 v102, v20, v21
    v_lshlrev_b32 v20, 16, v102
    v_and_b32 v21, 0xffff0000, v102
    v_cvt_pk_bf16_f32 v102, v22, v23
    v_lshlrev_b32 v22, 16, v102
    v_and_b32 v23, 0xffff0000, v102
    v_cvt_pk_bf16_f32 v102, v24, v25
    v_lshlrev_b32 v24, 16, v102
    v_and_b32 v25, 0xffff0000, v102
    v_cvt_pk_bf16_f32 v102, v26, v27
    v_lshlrev_b32 v26, 16, v102
    v_and_b32 v27, 0xffff0000, v102
    v_cvt_pk_bf16_f32 v102, v28, v29
    v_lshlrev_b32 v28, 16, v102
    v_and_b32 v29, 0xffff0000, v102
    v_cvt_pk_bf16_f32 v102, v30, v31
    v_lshlrev_b32 v30, 16, v102
    v_and_b32 v31, 0xffff0000, v102
    v_add_f32 v100, v100, v16
    v_fmac_f32 v101, v16, v16
    v_add_f32 v100, v100, v17
    v_fmac_f32 v101, v17, v17
    v_add_f32 v100, v100, v18
    v_fmac_f32 v101, v18, v18
    v_add_f32 v100, v100, v19
    v_fmac_f32 v101, v19, v19
    v_add_f32 v100, v100, v20
    v_fmac_f32 v101, v20, v20
    v_add_f32 v100, v100, v21
    v_fmac_f32 v101, v21, v21
    v_add_f32 v100, v100, v22
    v_fmac_f32 v101, v22, v22
    v_add_f32 v100, v100, v23
    v_fmac_f32 v101, v23, v23
    v_add_f32 v100, v100, v24
    v_fmac_f32 v101, v24, v24
    v_add_f32 v100, v100, v25
    v_fmac_f32 v101, v25, v25
    v_add_f32 v100, v100, v26
    v_fmac_f32 v101, v26, v26
    v_add_f32 v100, v100, v27
    v_fmac_f32 v101, v27, v27
    v_add_f32 v100, v100, v28
    v_fmac_f32 v101, v28, v28
    v_add_f32 v100, v100, v29
    v_fmac_f32 v101, v29, v29
    v_add_f32 v100, v100, v30
    v_fmac_f32 v101, v30, v30
    v_add_f32 v100, v100, v31
    v_fmac_f32 v101, v31, v31
    v_cvt_pk_bf16_f32 v72, v16, v17
    v_cvt_pk_bf16_f32 v73, v18, v19
    v_cvt_pk_bf16_f32 v74, v20, v21
    v_cvt_pk_bf16_f32 v75, v22, v23
    v_cvt_pk_bf16_f32 v76, v24, v25
    v_cvt_pk_bf16_f32 v77, v26, v27
    v_cvt_pk_bf16_f32 v78, v28, v29
    v_cvt_pk_bf16_f32 v79, v30, v31
    v_permlane32_swap_b32 v72, v74
    v_permlane32_swap_b32 v73, v75
    v_permlane32_swap_b32 v76, v78
    v_permlane32_swap_b32 v77, v79
    ds_write_b128 v81, v[72:75] offset:4096
    ds_write_b128 v82, v[76:79] offset:4096
    v_cvt_pk_bf16_f32 v102, v48, v49
    v_lshlrev_b32 v48, 16, v102
    v_and_b32 v49, 0xffff0000, v102
    v_cvt_pk_bf16_f32 v102, v50, v51
    v_lshlrev_b32 v50, 16, v102
    v_and_b32 v51, 0xffff0000, v102
    v_cvt_pk_bf16_f32 v102, v52, v53
    v_lshlrev_b32 v52, 16, v102
    v_and_b32 v53, 0xffff0000, v102
    v_cvt_pk_bf16_f32 v102, v54, v55
    v_lshlrev_b32 v54, 16, v102
    v_and_b32 v55, 0xffff0000, v102
    v_cvt_pk_bf16_f32 v102, v56, v57
    v_lshlrev_b32 v56, 16, v102
    v_and_b32 v57, 0xffff0000, v102
    v_cvt_pk_bf16_f32 v102, v58, v59
    v_lshlrev_b32 v58, 16, v102
    v_and_b32 v59, 0xffff0000, v102
    v_cvt_pk_bf16_f32 v102, v60, v61
    v_lshlrev_b32 v60, 16, v102
    v_and_b32 v61, 0xffff0000, v102
    v_cvt_pk_bf16_f32 v102, v62, v63
    v_lshlrev_b32 v62, 16, v102
    v_and_b32 v63, 0xffff0000, v102
    v_lshlrev_b32 v102, 16, v152
    v_add_f32 v48, v48, v102
    v_and_b32 v102, 0xffff0000, v152
    v_add_f32 v49, v49, v102
    v_lshlrev_b32 v102, 16, v153
    v_add_f32 v50, v50, v102
    v_and_b32 v102, 0xffff0000, v153
    v_add_f32 v51, v51, v102
    v_lshlrev_b32 v102, 16, v154
    v_add_f32 v52, v52, v102
    v_and_b32 v102, 0xffff0000, v154
    v_add_f32 v53, v53, v102
    v_lshlrev_b32 v102, 16, v155
    v_add_f32 v54, v54, v102
    v_and_b32 v102, 0xffff0000, v155
    v_add_f32 v55, v55, v102
    v_lshlrev_b32 v102, 16, v156
    v_add_f32 v56, v56, v102
    v_and_b32 v102, 0xffff0000, v156
    v_add_f32 v57, v57, v102
    v_lshlrev_b32 v102, 16, v157
    v_add_f32 v58, v58, v102
    v_and_b32 v102, 0xffff0000, v157
    v_add_f32 v59, v59, v102
    v_lshlrev_b32 v102, 16, v158
    v_add_f32 v60, v60, v102
    v_and_b32 v102, 0xffff0000, v158
    v_add_f32 v61, v61, v102
    v_lshlrev_b32 v102, 16, v159
    v_add_f32 v62, v62, v102
    v_and_b32 v102, 0xffff0000, v159
    v_add_f32 v63, v63, v102
    v_cvt_pk_bf16_f32 v102, v48, v49
    v_lshlrev_b32 v48, 16, v102
    v_and_b32 v49, 0xffff0000, v102
    v_cvt_pk_bf16_f32 v102, v50, v51
    v_lshlrev_b32 v50, 16, v102
    v_and_b32 v51, 0xffff0000, v102
    v_cvt_pk_bf16_f32 v102, v52, v53
    v_lshlrev_b32 v52, 16, v102
    v_and_b32 v53, 0xffff0000, v102
    v_cvt_pk_bf16_f32 v102, v54, v55
    v_lshlrev_b32 v54, 16, v102
    v_and_b32 v55, 0xffff0000, v102
    v_cvt_pk_bf16_f32 v102, v56, v57
    v_lshlrev_b32 v56, 16, v102
    v_and_b32 v57, 0xffff0000, v102
    v_cvt_pk_bf16_f32 v102, v58, v59
    v_lshlrev_b32 v58, 16, v102
    v_and_b32 v59, 0xffff0000, v102
    v_cvt_pk_bf16_f32 v102, v60, v61
    v_lshlrev_b32 v60, 16, v102
    v_and_b32 v61, 0xffff0000, v102
    v_cvt_pk_bf16_f32 v102, v62, v63
    v_lshlrev_b32 v62, 16, v102
    v_and_b32 v63, 0xffff0000, v102
    v_add_f32 v100, v100, v48
    v_fmac_f32 v101, v48, v48
    v_add_f32 v100, v100, v49
    v_fmac_f32 v101, v49, v49
    v_add_f32 v100, v100, v50
    v_fmac_f32 v101, v50, v50
    v_add_f32 v100, v100, v51
    v_fmac_f32 v101, v51, v51
    v_add_f32 v100, v100, v52
    v_fmac_f32 v101, v52, v52
    v_add_f32 v100, v100, v53
    v_fmac_f32 v101, v53, v53
    v_add_f32 v100, v100, v54
    v_fmac_f32 v101, v54, v54
    v_add_f32 v100, v100, v55
    v_fmac_f32 v101, v55, v55
    v_add_f32 v100, v100, v56
    v_fmac_f32 v101, v56, v56
    v_add_f32 v100, v100, v57
    v_fmac_f32 v101, v57, v57
    v_add_f32 v100, v100, v58
    v_fmac_f32 v101, v58, v58
    v_add_f32 v100, v100, v59
    v_fmac_f32 v101, v59, v59
    v_add_f32 v100, v100, v60
    v_fmac_f32 v101, v60, v60
    v_add_f32 v100, v100, v61
    v_fmac_f32 v101, v61, v61
    v_add_f32 v100, v100, v62
    v_fmac_f32 v101, v62, v62
    v_add_f32 v100, v100, v63
    v_fmac_f32 v101, v63, v63
    v_mov_b32 v102, v100
    s_nop 1
    v_permlane32_swap_b32 v100, v102
    v_add_f32 v100, v100, v102
    v_mov_b32 v102, v101
    s_nop 1
    v_permlane32_swap_b32 v101, v102
    v_add_f32 v101, v101, v102
    v_cmp_gt_u32 vcc, 32, v64
    s_nop 0
    s_and_saveexec_b64 s[56:57], vcc
    buffer_store_dwordx2 v[100:101], v103, s[44:47], 0 offen
    s_mov_b64 exec, s[56:57]
    v_add_u32 v103, 4096, v103
    v_cvt_pk_bf16_f32 v72, v48, v49
    v_cvt_pk_bf16_f32 v73, v50, v51
    v_cvt_pk_bf16_f32 v74, v52, v53
    v_cvt_pk_bf16_f32 v75, v54, v55
    v_cvt_pk_bf16_f32 v76, v56, v57
    v_cvt_pk_bf16_f32 v77, v58, v59
    v_cvt_pk_bf16_f32 v78, v60, v61
    v_cvt_pk_bf16_f32 v79, v62, v63
    v_permlane32_swap_b32 v72, v74
    v_permlane32_swap_b32 v73, v75
    v_permlane32_swap_b32 v76, v78
    v_permlane32_swap_b32 v77, v79
    ds_write_b128 v83, v[72:75] offset:4096
    ds_write_b128 v84, v[76:79] offset:4096
    s_waitcnt lgkmcnt(0)
    ds_read_b128 v[0:3], v80 offset:0
    ds_read_b128 v[4:7], v80 offset:1024
    ds_read_b128 v[8:11], v80 offset:2048
    ds_read_b128 v[12:15], v80 offset:3072
    ds_read_b128 v[16:19], v80 offset:4096
    ds_read_b128 v[20:23], v80 offset:5120
    ds_read_b128 v[24:27], v80 offset:6144
    ds_read_b128 v[28:31], v80 offset:7168
    s_waitcnt lgkmcnt(7)
    buffer_store_dwordx4 v[0:3], v67, s[16:19], 0 offen
    v_add_u32 v67, 16384, v67
    s_waitcnt lgkmcnt(6)
    buffer_store_dwordx4 v[4:7], v67, s[16:19], 0 offen
    v_add_u32 v67, 16384, v67
    s_waitcnt lgkmcnt(5)
    buffer_store_dwordx4 v[8:11], v67, s[16:19], 0 offen
    v_add_u32 v67, 16384, v67
    s_waitcnt lgkmcnt(4)
    buffer_store_dwordx4 v[12:15], v67, s[16:19], 0 offen
    v_add_u32 v67, 16384, v67
    s_waitcnt lgkmcnt(3)
    buffer_store_dwordx4 v[16:19], v67, s[16:19], 0 offen
    v_add_u32 v67, 16384, v67
    s_waitcnt lgkmcnt(2)
    buffer_store_dwordx4 v[20:23], v67, s[16:19], 0 offen
    v_add_u32 v67, 16384, v67
    s_waitcnt lgkmcnt(1)
    buffer_store_dwordx4 v[24:27], v67, s[16:19], 0 offen
    v_add_u32 v67, 16384, v67
    s_waitcnt lgkmcnt(0)
    buffer_store_dwordx4 v[28:31], v67, s[16:19], 0 offen
    s_endpgm
l2_kernel_qs_3:
    s_sub_u32 s52, s2, 128
    s_lshr_b32 s54, s52, 5
    s_and_b32 s52, s52, 31
    s_load_dwordx2 s[40:41], s[0:1], 96
    s_load_dwordx2 s[6:7], s[0:1], 16
    v_lshrrev_b32 v1, 6, v0
    s_nop 0
    v_readfirstlane_b32 s24, v1
    s_waitcnt lgkmcnt(0)
    s_add_u32 s8, s40, 4194304
    s_addc_u32 s9, s41, 0
    s_and_b32 s9, s9, 0xffff
    s_mov_b32 s10, 4194304
    s_mov_b32 s11, 0x00020000
    s_mov_b32 s12, s6
    s_mov_b32 s13, s7
    s_and_b32 s13, s13, 0xffff
    s_mov_b32 s14, 65536
    s_mov_b32 s15, 0x00020000
    s_add_u32 s16, s40, 42991616
    s_addc_u32 s17, s41, 0
    s_and_b32 s17, s17, 0xffff
    s_mov_b32 s18, 4194304
    s_mov_b32 s19, 0x00020000
    s_add_u32 s20, s40, 49348608
    s_addc_u32 s21, s41, 0
    s_and_b32 s21, s21, 0xffff
    s_mov_b32 s22, 2162688
    s_mov_b32 s23, 0x00020000
    v_and_b32 v2, 63, v0
    v_lshlrev_b32 v3, 4, v2
    s_cmp_lg_u32 s24, 11
    s_cbranch_scc1 l2_kernel_nw_19
    s_lshl_b32 s29, s52, 11
    s_mov_b32 m0, 0
    s_nop 0
    buffer_load_dwordx4 v3, s[12:15], s29 offen lds
    s_add_u32 s29, s29, 1024
    s_mov_b32 m0, 1024
    s_nop 0
    buffer_load_dwordx4 v3, s[12:15], s29 offen lds
    s_waitcnt vmcnt(0)
l2_kernel_nw_19:
    v_cmp_gt_u32 vcc, 528, v0
    s_nop 0
    s_and_saveexec_b64 s[56:57], vcc
    s_cbranch_execz l2_kernel_ns_20
    v_lshlrev_b32 v4, 4, v0
    s_mul_i32 s29, s52, 67584
    buffer_load_dwordx4 v[16:19], v4, s[20:23], s29 offen
    s_add_u32 s29, s29, 8448
    buffer_load_dwordx4 v[20:23], v4, s[20:23], s29 offen
    s_add_u32 s29, s29, 8448
    buffer_load_dwordx4 v[24:27], v4, s[20:23], s29 offen
    s_add_u32 s29, s29, 8448
    buffer_load_dwordx4 v[28:31], v4, s[20:23], s29 offen
    s_add_u32 s29, s29, 8448
    buffer_load_dwordx4 v[32:35], v4, s[20:23], s29 offen
    s_add_u32 s29, s29, 8448
    buffer_load_dwordx4 v[36:39], v4, s[20:23], s29 offen
    s_add_u32 s29, s29, 8448
    buffer_load_dwordx4 v[40:43], v4, s[20:23], s29 offen
    s_add_u32 s29, s29, 8448
    buffer_load_dwordx4 v[44:47], v4, s[20:23], s29 offen
    s_waitcnt vmcnt(0)
    v_add_f32 v16, v16, v32
    v_add_f32 v17, v17, v33
    v_add_f32 v18, v18, v34
    v_add_f32 v19, v19, v35
    v_add_f32 v20, v20, v36
    v_add_f32 v21, v21, v37
    v_add_f32 v22, v22, v38
    v_add_f32 v23, v23, v39
    v_add_f32 v24, v24, v40
    v_add_f32 v25, v25, v41
    v_add_f32 v26, v26, v42
    v_add_f32 v27, v27, v43
    v_add_f32 v28, v28, v44
    v_add_f32 v29, v29, v45
    v_add_f32 v30, v30, v46
    v_add_f32 v31, v31, v47
    v_add_f32 v16, v16, v24
    v_add_f32 v17, v17, v25
    v_add_f32 v18, v18, v26
    v_add_f32 v19, v19, v27
    v_add_f32 v20, v20, v28
    v_add_f32 v21, v21, v29
    v_add_f32 v22, v22, v30
    v_add_f32 v23, v23, v31
    v_add_f32 v16, v16, v20
    v_add_f32 v17, v17, v21
    v_add_f32 v18, v18, v22
    v_add_f32 v19, v19, v23
    ds_write_b128 v4, v[16:19] offset:4096
l2_kernel_ns_20:
    s_mov_b64 exec, s[56:57]
    v_and_b32 v7, 31, v2
    v_lshrrev_b32 v8, 5, v2
    s_mul_i32 s36, s54, 22
    s_add_u32 s37, s36, 22
    s_min_u32 s37, s37, 64
    s_add_u32 s36, s36, s24
    s_lshl_b32 s29, s36, 5
    v_add_u32 v9, s29, v7
    v_lshlrev_b32 v9, 11, v9
    v_lshl_add_u32 v9, v8, 4, v9
    s_lshl_b32 s29, s52, 6
    v_add_u32 v9, s29, v9
    buffer_load_dwordx4 v[72:75], v9, s[8:11], 0 offen
    buffer_load_dwordx4 v[76:79], v9, s[8:11], 0 offen offset:32
    s_waitcnt lgkmcnt(0)
    s_barrier
    v_lshrrev_b32 v11, 4, v2
    v_and_b32 v12, 15, v2
    v_lshrrev_b32 v12, 2, v12
    v_and_b32 v13, 3, v2
    v_lshrrev_b32 v4, 1, v11
    v_lshlrev_b32 v4, 3, v4
    v_add_u32 v4, v4, v12
    v_mul_u32_u24 v4, 64, v4
    v_and_b32 v11, 1, v11
    v_lshl_add_u32 v4, v11, 5, v4
    v_lshl_add_u32 v4, v13, 3, v4
    ds_read_b64_tr_b16 v[16:17], v4 offset:0
    ds_read_b64_tr_b16 v[18:19], v4 offset:256
    ds_read_b64_tr_b16 v[20:21], v4 offset:1024
    ds_read_b64_tr_b16 v[22:23], v4 offset:1280
    v_lshlrev_b32 v11, 10, v8
    v_lshl_add_u32 v11, v7, 5, v11
    ds_read_b128 v[112:115], v11 offset:4096
    ds_read_b128 v[116:119], v11 offset:4112
    ds_read_b128 v[120:123], v11 offset:6144
    ds_read_b128 v[124:127], v11 offset:6160
    ds_read_b128 v[128:131], v11 offset:8192
    ds_read_b128 v[132:135], v11 offset:8208
    ds_read_b128 v[136:139], v11 offset:10240
    ds_read_b128 v[140:143], v11 offset:10256
    v_lshlrev_b32 v11, 5, v8
    ds_read_b128 v[40:43], v11 offset:12288
    ds_read_b128 v[44:47], v11 offset:12304
    ds_read_b128 v[48:51], v11 offset:12352
    ds_read_b128 v[52:55], v11 offset:12368
    ds_read_b128 v[56:59], v11 offset:12416
    ds_read_b128 v[60:63], v11 offset:12432
    ds_read_b128 v[64:67], v11 offset:12480
    ds_read_b128 v[68:71], v11 offset:12496
    s_waitcnt lgkmcnt(0)
    v_cvt_pk_bf16_f32 v24, v112, v113
    v_cvt_pk_bf16_f32 v25, v114, v115
    v_cvt_pk_bf16_f32 v26, v116, v117
    v_cvt_pk_bf16_f32 v27, v118, v119
    v_cvt_pk_bf16_f32 v28, v120, v121
    v_cvt_pk_bf16_f32 v29, v122, v123
    v_cvt_pk_bf16_f32 v30, v124, v125
    v_cvt_pk_bf16_f32 v31, v126, v127
    v_cvt_pk_bf16_f32 v32, v128, v129
    v_cvt_pk_bf16_f32 v33, v130, v131
    v_cvt_pk_bf16_f32 v34, v132, v133
    v_cvt_pk_bf16_f32 v35, v134, v135
    v_cvt_pk_bf16_f32 v36, v136, v137
    v_cvt_pk_bf16_f32 v37, v138, v139
    v_cvt_pk_bf16_f32 v38, v140, v141
    v_cvt_pk_bf16_f32 v39, v142, v143
    v_cvt_pk_bf16_f32 v112, v40, v41
    v_lshlrev_b32 v40, 16, v112
    v_and_b32 v41, 0xffff0000, v112
    v_cvt_pk_bf16_f32 v112, v42, v43
    v_lshlrev_b32 v42, 16, v112
    v_and_b32 v43, 0xffff0000, v112
    v_cvt_pk_bf16_f32 v112, v44, v45
    v_lshlrev_b32 v44, 16, v112
    v_and_b32 v45, 0xffff0000, v112
    v_cvt_pk_bf16_f32 v112, v46, v47
    v_lshlrev_b32 v46, 16, v112
    v_and_b32 v47, 0xffff0000, v112
    v_cvt_pk_bf16_f32 v112, v48, v49
    v_lshlrev_b32 v48, 16, v112
    v_and_b32 v49, 0xffff0000, v112
    v_cvt_pk_bf16_f32 v112, v50, v51
    v_lshlrev_b32 v50, 16, v112
    v_and_b32 v51, 0xffff0000, v112
    v_cvt_pk_bf16_f32 v112, v52, v53
    v_lshlrev_b32 v52, 16, v112
    v_and_b32 v53, 0xffff0000, v112
    v_cvt_pk_bf16_f32 v112, v54, v55
    v_lshlrev_b32 v54, 16, v112
    v_and_b32 v55, 0xffff0000, v112
    v_cvt_pk_bf16_f32 v112, v56, v57
    v_lshlrev_b32 v56, 16, v112
    v_and_b32 v57, 0xffff0000, v112
    v_cvt_pk_bf16_f32 v112, v58, v59
    v_lshlrev_b32 v58, 16, v112
    v_and_b32 v59, 0xffff0000, v112
    v_cvt_pk_bf16_f32 v112, v60, v61
    v_lshlrev_b32 v60, 16, v112
    v_and_b32 v61, 0xffff0000, v112
    v_cvt_pk_bf16_f32 v112, v62, v63
    v_lshlrev_b32 v62, 16, v112
    v_and_b32 v63, 0xffff0000, v112
    v_cvt_pk_bf16_f32 v112, v64, v65
    v_lshlrev_b32 v64, 16, v112
    v_and_b32 v65, 0xffff0000, v112
    v_cvt_pk_bf16_f32 v112, v66, v67
    v_lshlrev_b32 v66, 16, v112
    v_and_b32 v67, 0xffff0000, v112
    v_cvt_pk_bf16_f32 v112, v68, v69
    v_lshlrev_b32 v68, 16, v112
    v_and_b32 v69, 0xffff0000, v112
    v_cvt_pk_bf16_f32 v112, v70, v71
    v_lshlrev_b32 v70, 16, v112
    v_and_b32 v71, 0xffff0000, v112
    s_mov_b32 s58, 0x3fb8aa3b
    s_mov_b32 s59, 0x3fb8aa3b
l2_kernel_qsl_21:
    s_cmp_ge_u32 s36, s37
    s_cbranch_scc1 l2_kernel_qsx_22
    s_waitcnt vmcnt(0)
    v_mfma_f32_32x32x16_bf16 v[80:95], v[16:19], v[72:75], 0
    v_mfma_f32_32x32x16_bf16 v[80:95], v[20:23], v[76:79], v[80:95]
    v_add_u32 v10, 786432, v9
    buffer_load_dwordx4 v[72:75], v10, s[8:11], 0 offen
    buffer_load_dwordx4 v[76:79], v10, s[8:11], 0 offen offset:32
    s_nop 8
    v_cvt_pk_bf16_f32 v144, v80, v81
    v_lshlrev_b32 v80, 16, v144
    v_and_b32 v81, 0xffff0000, v144
    v_cvt_pk_bf16_f32 v144, v82, v83
    v_lshlrev_b32 v82, 16, v144
    v_and_b32 v83, 0xffff0000, v144
    v_cvt_pk_bf16_f32 v144, v84, v85
    v_lshlrev_b32 v84, 16, v144
    v_and_b32 v85, 0xffff0000, v144
    v_cvt_pk_bf16_f32 v144, v86, v87
    v_lshlrev_b32 v86, 16, v144
    v_and_b32 v87, 0xffff0000, v144
    v_cvt_pk_bf16_f32 v144, v88, v89
    v_lshlrev_b32 v88, 16, v144
    v_and_b32 v89, 0xffff0000, v144
    v_cvt_pk_bf16_f32 v144, v90, v91
    v_lshlrev_b32 v90, 16, v144
    v_and_b32 v91, 0xffff0000, v144
    v_cvt_pk_bf16_f32 v144, v92, v93
    v_lshlrev_b32 v92, 16, v144
    v_and_b32 v93, 0xffff0000, v144
    v_cvt_pk_bf16_f32 v144, v94, v95
    v_lshlrev_b32 v94, 16, v144
    v_and_b32 v95, 0xffff0000, v144
    v_max3_f32 v144, v80, v81, v82
    v_min3_f32 v145, v80, v81, v82
    v_max3_f32 v144, v144, v83, v84
    v_min3_f32 v145, v145, v83, v84
    v_max3_f32 v144, v144, v85, v86
    v_min3_f32 v145, v145, v85, v86
    v_max3_f32 v144, v144, v87, v88
    v_min3_f32 v145, v145, v87, v88
    v_max3_f32 v144, v144, v89, v90
    v_min3_f32 v145, v145, v89, v90
    v_max3_f32 v144, v144, v91, v92
    v_min3_f32 v145, v145, v91, v92
    v_max3_f32 v144, v144, v93, v94
    v_min3_f32 v145, v145, v93, v94
    v_max_f32 v144, v144, v95
    v_min_f32 v145, v145, v95
    v_mov_b32 v146, v144
    s_nop 1
    v_permlane32_swap_b32 v144, v146
    v_max_f32 v144, v144, v146
    v_mov_b32 v146, v145
    s_nop 1
    v_permlane32_swap_b32 v145, v146
    v_min_f32 v145, v145, v146
    v_mul_f32 v148, 0xbfb8aa3b, v144
    v_mul_f32 v150, 0x3fb8aa3b, v145
    v_mov_b32 v149, v148
    v_mov_b32 v151, v150
    v_pk_fma_f32 v[112:113], v[80:81], s[58:59], v[148:149]
    v_pk_fma_f32 v[128:129], v[80:81], s[58:59], v[150:151] neg_lo:[1,0,0] neg_hi:[1,0,0]
    v_pk_fma_f32 v[114:115], v[82:83], s[58:59], v[148:149]
    v_pk_fma_f32 v[130:131], v[82:83], s[58:59], v[150:151] neg_lo:[1,0,0] neg_hi:[1,0,0]
    v_pk_fma_f32 v[116:117], v[84:85], s[58:59], v[148:149]
    v_pk_fma_f32 v[132:133], v[84:85], s[58:59], v[150:151] neg_lo:[1,0,0] neg_hi:[1,0,0]
    v_pk_fma_f32 v[118:119], v[86:87], s[58:59], v[148:149]
    v_pk_fma_f32 v[134:135], v[86:87], s[58:59], v[150:151] neg_lo:[1,0,0] neg_hi:[1,0,0]
    v_pk_fma_f32 v[120:121], v[88:89], s[58:59], v[148:149]
    v_pk_fma_f32 v[136:137], v[88:89], s[58:59], v[150:151] neg_lo:[1,0,0] neg_hi:[1,0,0]
    v_pk_fma_f32 v[122:123], v[90:91], s[58:59], v[148:149]
    v_pk_fma_f32 v[138:139], v[90:91], s[58:59], v[150:151] neg_lo:[1,0,0] neg_hi:[1,0,0]
    v_pk_fma_f32 v[124:125], v[92:93], s[58:59], v[148:149]
    v_pk_fma_f32 v[140:141], v[92:93], s[58:59], v[150:151] neg_lo:[1,0,0] neg_hi:[1,0,0]
    v_pk_fma_f32 v[126:127], v[94:95], s[58:59], v[148:149]
    v_pk_fma_f32 v[142:143], v[94:95], s[58:59], v[150:151] neg_lo:[1,0,0] neg_hi:[1,0,0]
    v_exp_f32 v112, v112
    v_exp_f32 v128, v128
    v_exp_f32 v113, v113
    v_exp_f32 v129, v129
    v_exp_f32 v114, v114
    v_exp_f32 v130, v130
    v_exp_f32 v115, v115
    v_exp_f32 v131, v131
    v_exp_f32 v116, v116
    v_exp_f32 v132, v132
    v_exp_f32 v117, v117
    v_exp_f32 v133, v133
    v_exp_f32 v118, v118
    v_exp_f32 v134, v134
    v_exp_f32 v119, v119
    v_exp_f32 v135, v135
    v_exp_f32 v120, v120
    v_exp_f32 v136, v136
    v_exp_f32 v121, v121
    v_exp_f32 v137, v137
    v_exp_f32 v122, v122
    v_exp_f32 v138, v138
    v_exp_f32 v123, v123
    v_exp_f32 v139, v139
    v_exp_f32 v124, v124
    v_exp_f32 v140, v140
    v_exp_f32 v125, v125
    v_exp_f32 v141, v141
    v_exp_f32 v126, v126
    v_exp_f32 v142, v142
    v_exp_f32 v127, v127
    v_exp_f32 v143, v143
    v_pk_add_f32 v[148:149], v[112:113], v[114:115]
    v_pk_add_f32 v[150:151], v[128:129], v[130:131]
    v_pk_add_f32 v[148:149], v[148:149], v[116:117]
    v_pk_add_f32 v[150:151], v[150:151], v[132:133]
    v_pk_add_f32 v[148:149], v[148:149], v[118:119]
    v_pk_add_f32 v[150:151], v[150:151], v[134:135]
    v_pk_add_f32 v[148:149], v[148:149], v[120:121]
    v_pk_add_f32 v[150:151], v[150:151], v[136:137]
    v_pk_add_f32 v[148:149], v[148:149], v[122:123]
    v_pk_add_f32 v[150:151], v[150:151], v[138:139]
    v_pk_add_f32 v[148:149], v[148:149], v[124:125]
    v_pk_add_f32 v[150:151], v[150:151], v[140:141]
    v_pk_add_f32 v[148:149], v[148:149], v[126:127]
    v_pk_add_f32 v[150:151], v[150:151], v[142:143]
    v_add_f32 v144, v148, v149
    v_add_f32 v145, v150, v151
    v_mov_b32 v146, v144
    s_nop 1
    v_permlane32_swap_b32 v144, v146
    v_add_f32 v144, v144, v146
    v_mov_b32 v146, v145
    s_nop 1
    v_permlane32_swap_b32 v145, v146
    v_add_f32 v145, v145, v146
    v_rcp_f32 v148, v144
    v_rcp_f32 v150, v145
    v_mov_b32 v149, v148
    v_mov_b32 v151, v150
    v_pk_mul_f32 v[112:113], v[112:113], v[148:149]
    v_pk_mul_f32 v[128:129], v[128:129], v[150:151]
    v_pk_mul_f32 v[114:115], v[114:115], v[148:149]
    v_pk_mul_f32 v[130:131], v[130:131], v[150:151]
    v_pk_mul_f32 v[116:117], v[116:117], v[148:149]
    v_pk_mul_f32 v[132:133], v[132:133], v[150:151]
    v_pk_mul_f32 v[118:119], v[118:119], v[148:149]
    v_pk_mul_f32 v[134:135], v[134:135], v[150:151]
    v_pk_mul_f32 v[120:121], v[120:121], v[148:149]
    v_pk_mul_f32 v[136:137], v[136:137], v[150:151]
    v_pk_mul_f32 v[122:123], v[122:123], v[148:149]
    v_pk_mul_f32 v[138:139], v[138:139], v[150:151]
    v_pk_mul_f32 v[124:125], v[124:125], v[148:149]
    v_pk_mul_f32 v[140:141], v[140:141], v[150:151]
    v_pk_mul_f32 v[126:127], v[126:127], v[148:149]
    v_pk_mul_f32 v[142:143], v[142:143], v[150:151]
    v_cvt_pk_bf16_f32 v96, v112, v113
    v_cvt_pk_bf16_f32 v104, v128, v129
    v_cvt_pk_bf16_f32 v97, v114, v115
    v_cvt_pk_bf16_f32 v105, v130, v131
    v_cvt_pk_bf16_f32 v98, v116, v117
    v_cvt_pk_bf16_f32 v106, v132, v133
    v_cvt_pk_bf16_f32 v99, v118, v119
    v_cvt_pk_bf16_f32 v107, v134, v135
    v_cvt_pk_bf16_f32 v100, v120, v121
    v_cvt_pk_bf16_f32 v108, v136, v137
    v_cvt_pk_bf16_f32 v101, v122, v123
    v_cvt_pk_bf16_f32 v109, v138, v139
    v_cvt_pk_bf16_f32 v102, v124, v125
    v_cvt_pk_bf16_f32 v110, v140, v141
    v_cvt_pk_bf16_f32 v103, v126, v127
    v_cvt_pk_bf16_f32 v111, v142, v143
    v_mfma_f32_32x32x16_bf16 v[152:167], v[24:27], v[96:99], 0
    v_mfma_f32_32x32x16_bf16 v[152:167], v[28:31], v[100:103], v[152:167]
    v_mfma_f32_32x32x16_bf16 v[152:167], v[32:35], v[104:107], v[152:167]
    v_mfma_f32_32x32x16_bf16 v[152:167], v[36:39], v[108:111], v[152:167]
    v_mov_b32 v144, 0
    v_lshlrev_b32 v145, 16, v96
    v_fmac_f32 v144, v145, v40
    v_and_b32 v145, 0xffff0000, v96
    v_fmac_f32 v144, v145, v41
    v_lshlrev_b32 v145, 16, v97
    v_fmac_f32 v144, v145, v42
    v_and_b32 v145, 0xffff0000, v97
    v_fmac_f32 v144, v145, v43
    v_lshlrev_b32 v145, 16, v98
    v_fmac_f32 v144, v145, v44
    v_and_b32 v145, 0xffff0000, v98
    v_fmac_f32 v144, v145, v45
    v_lshlrev_b32 v145, 16, v99
    v_fmac_f32 v144, v145, v46
    v_and_b32 v145, 0xffff0000, v99
    v_fmac_f32 v144, v145, v47
    v_lshlrev_b32 v145, 16, v100
    v_fmac_f32 v144, v145, v48
    v_and_b32 v145, 0xffff0000, v100
    v_fmac_f32 v144, v145, v49
    v_lshlrev_b32 v145, 16, v101
    v_fmac_f32 v144, v145, v50
    v_and_b32 v145, 0xffff0000, v101
    v_fmac_f32 v144, v145, v51
    v_lshlrev_b32 v145, 16, v102
    v_fmac_f32 v144, v145, v52
    v_and_b32 v145, 0xffff0000, v102
    v_fmac_f32 v144, v145, v53
    v_lshlrev_b32 v145, 16, v103
    v_fmac_f32 v144, v145, v54
    v_and_b32 v145, 0xffff0000, v103
    v_fmac_f32 v144, v145, v55
    v_lshlrev_b32 v145, 16, v104
    v_fmac_f32 v144, v145, v56
    v_and_b32 v145, 0xffff0000, v104
    v_fmac_f32 v144, v145, v57
    v_lshlrev_b32 v145, 16, v105
    v_fmac_f32 v144, v145, v58
    v_and_b32 v145, 0xffff0000, v105
    v_fmac_f32 v144, v145, v59
    v_lshlrev_b32 v145, 16, v106
    v_fmac_f32 v144, v145, v60
    v_and_b32 v145, 0xffff0000, v106
    v_fmac_f32 v144, v145, v61
    v_lshlrev_b32 v145, 16, v107
    v_fmac_f32 v144, v145, v62
    v_and_b32 v145, 0xffff0000, v107
    v_fmac_f32 v144, v145, v63
    v_lshlrev_b32 v145, 16, v108
    v_fmac_f32 v144, v145, v64
    v_and_b32 v145, 0xffff0000, v108
    v_fmac_f32 v144, v145, v65
    v_lshlrev_b32 v145, 16, v109
    v_fmac_f32 v144, v145, v66
    v_and_b32 v145, 0xffff0000, v109
    v_fmac_f32 v144, v145, v67
    v_lshlrev_b32 v145, 16, v110
    v_fmac_f32 v144, v145, v68
    v_and_b32 v145, 0xffff0000, v110
    v_fmac_f32 v144, v145, v69
    v_lshlrev_b32 v145, 16, v111
    v_fmac_f32 v144, v145, v70
    v_and_b32 v145, 0xffff0000, v111
    v_fmac_f32 v144, v145, v71
    v_mov_b32 v145, v144
    s_nop 1
    v_permlane32_swap_b32 v144, v145
    v_add_f32 v144, v144, v145
    v_cvt_pk_bf16_f32 v145, v144, v144
    v_lshlrev_b32 v144, 16, v145
    v_add_f32 v144, 0x358637bd, v144
    v_cvt_pk_bf16_f32 v145, v144, v144
    v_lshlrev_b32 v144, 16, v145
    v_rcp_f32 v144, v144
    v_cvt_pk_bf16_f32 v145, v152, v153
    v_lshlrev_b32 v152, 16, v145
    v_and_b32 v153, 0xffff0000, v145
    v_cvt_pk_bf16_f32 v145, v154, v155
    v_lshlrev_b32 v154, 16, v145
    v_and_b32 v155, 0xffff0000, v145
    v_cvt_pk_bf16_f32 v145, v156, v157
    v_lshlrev_b32 v156, 16, v145
    v_and_b32 v157, 0xffff0000, v145
    v_cvt_pk_bf16_f32 v145, v158, v159
    v_lshlrev_b32 v158, 16, v145
    v_and_b32 v159, 0xffff0000, v145
    v_cvt_pk_bf16_f32 v145, v160, v161
    v_lshlrev_b32 v160, 16, v145
    v_and_b32 v161, 0xffff0000, v145
    v_cvt_pk_bf16_f32 v145, v162, v163
    v_lshlrev_b32 v162, 16, v145
    v_and_b32 v163, 0xffff0000, v145
    v_cvt_pk_bf16_f32 v145, v164, v165
    v_lshlrev_b32 v164, 16, v145
    v_and_b32 v165, 0xffff0000, v145
    v_cvt_pk_bf16_f32 v145, v166, v167
    v_lshlrev_b32 v166, 16, v145
    v_and_b32 v167, 0xffff0000, v145
    v_mul_f32 v152, v152, v144
    v_mul_f32 v153, v153, v144
    v_mul_f32 v154, v154, v144
    v_mul_f32 v155, v155, v144
    v_mul_f32 v156, v156, v144
    v_mul_f32 v157, v157, v144
    v_mul_f32 v158, v158, v144
    v_mul_f32 v159, v159, v144
    v_mul_f32 v160, v160, v144
    v_mul_f32 v161, v161, v144
    v_mul_f32 v162, v162, v144
    v_mul_f32 v163, v163, v144
    v_mul_f32 v164, v164, v144
    v_mul_f32 v165, v165, v144
    v_mul_f32 v166, v166, v144
    v_mul_f32 v167, v167, v144
    v_cvt_pk_bf16_f32 v112, v152, v153
    v_cvt_pk_bf16_f32 v113, v154, v155
    v_cvt_pk_bf16_f32 v114, v156, v157
    v_cvt_pk_bf16_f32 v115, v158, v159
    v_cvt_pk_bf16_f32 v116, v160, v161
    v_cvt_pk_bf16_f32 v117, v162, v163
    v_cvt_pk_bf16_f32 v118, v164, v165
    v_cvt_pk_bf16_f32 v119, v166, v167
    v_permlane32_swap_b32 v112, v114
    v_permlane32_swap_b32 v113, v115
    v_permlane32_swap_b32 v116, v118
    v_permlane32_swap_b32 v117, v119
    buffer_store_dwordx4 v[112:115], v9, s[16:19], 0 offen
    buffer_store_dwordx4 v[116:119], v9, s[16:19], 0 offen offset:32
    v_mov_b32 v9, v10
    s_add_u32 s36, s36, 12
    s_branch l2_kernel_qsl_21
l2_kernel_qsx_22:
    s_endpgm
l2_kernel_cs_2:
    s_load_dwordx2 s[40:41], s[0:1], 96
    s_load_dwordx2 s[6:7], s[0:1], 56
    s_waitcnt lgkmcnt(0)
    s_mov_b32 s12, s6
    s_mov_b32 s13, s7
    s_and_b32 s13, s13, 0xffff
    s_mov_b32 s14, 7340032
    s_mov_b32 s15, 0x00020000
    s_add_u32 s16, s40, 49283072
    s_addc_u32 s17, s41, 0
    s_and_b32 s17, s17, 0xffff
    s_mov_b32 s18, 14336
    s_mov_b32 s19, 0x00020000
    s_sub_u32 s52, s71, 28
    s_lshl_b32 s52, s52, 3
    s_add_u32 s52, s52, s70
    v_cmp_gt_u32 vcc, 512, v0
    s_nop 0
    s_and_saveexec_b64 s[56:57], vcc
    s_cbranch_execz l2_kernel_csx_23
    v_and_b32 v1, 15, v0
    v_lshrrev_b32 v2, 4, v0
    s_mov_b32 s29, 229376
    v_mul_lo_u32 v3, v2, s29
    v_lshl_add_u32 v3, v1, 4, v3
    s_lshl_b32 s30, s52, 8
    v_mov_b32 v8, 0
    v_mov_b32 v9, 0
    v_mov_b32 v10, 0
    v_mov_b32 v11, 0
    v_mov_b32 v12, 0
    v_mov_b32 v13, 0
    v_mov_b32 v14, 0
    v_mov_b32 v15, 0
    buffer_load_dwordx4 v[40:43], v3, s[12:15], s30 offen
    v_add_u32 v3, 7168, v3
    buffer_load_dwordx4 v[44:47], v3, s[12:15], s30 offen
    v_add_u32 v3, 7168, v3
    buffer_load_dwordx4 v[48:51], v3, s[12:15], s30 offen
    v_add_u32 v3, 7168, v3
    buffer_load_dwordx4 v[52:55], v3, s[12:15], s30 offen
    v_add_u32 v3, 7168, v3
    buffer_load_dwordx4 v[56:59], v3, s[12:15], s30 offen
    v_add_u32 v3, 7168, v3
    buffer_load_dwordx4 v[60:63], v3, s[12:15], s30 offen
    v_add_u32 v3, 7168, v3
    buffer_load_dwordx4 v[64:67], v3, s[12:15], s30 offen
    v_add_u32 v3, 7168, v3
    buffer_load_dwordx4 v[68:71], v3, s[12:15], s30 offen
    v_add_u32 v3, 7168, v3
    buffer_load_dwordx4 v[72:75], v3, s[12:15], s30 offen
    v_add_u32 v3, 7168, v3
    buffer_load_dwordx4 v[76:79], v3, s[12:15], s30 offen
    v_add_u32 v3, 7168, v3
    buffer_load_dwordx4 v[80:83], v3, s[12:15], s30 offen
    v_add_u32 v3, 7168, v3
    buffer_load_dwordx4 v[84:87], v3, s[12:15], s30 offen
    v_add_u32 v3, 7168, v3
    buffer_load_dwordx4 v[88:91], v3, s[12:15], s30 offen
    v_add_u32 v3, 7168, v3
    buffer_load_dwordx4 v[92:95], v3, s[12:15], s30 offen
    v_add_u32 v3, 7168, v3
    buffer_load_dwordx4 v[96:99], v3, s[12:15], s30 offen
    v_add_u32 v3, 7168, v3
    buffer_load_dwordx4 v[100:103], v3, s[12:15], s30 offen
    v_add_u32 v3, 7168, v3
    buffer_load_dwordx4 v[104:107], v3, s[12:15], s30 offen
    v_add_u32 v3, 7168, v3
    buffer_load_dwordx4 v[108:111], v3, s[12:15], s30 offen
    v_add_u32 v3, 7168, v3
    buffer_load_dwordx4 v[112:115], v3, s[12:15], s30 offen
    v_add_u32 v3, 7168, v3
    buffer_load_dwordx4 v[116:119], v3, s[12:15], s30 offen
    v_add_u32 v3, 7168, v3
    buffer_load_dwordx4 v[120:123], v3, s[12:15], s30 offen
    v_add_u32 v3, 7168, v3
    buffer_load_dwordx4 v[124:127], v3, s[12:15], s30 offen
    v_add_u32 v3, 7168, v3
    buffer_load_dwordx4 v[128:131], v3, s[12:15], s30 offen
    v_add_u32 v3, 7168, v3
    buffer_load_dwordx4 v[132:135], v3, s[12:15], s30 offen
    v_add_u32 v3, 7168, v3
    buffer_load_dwordx4 v[136:139], v3, s[12:15], s30 offen
    v_add_u32 v3, 7168, v3
    buffer_load_dwordx4 v[140:143], v3, s[12:15], s30 offen
    v_add_u32 v3, 7168, v3
    buffer_load_dwordx4 v[144:147], v3, s[12:15], s30 offen
    v_add_u32 v3, 7168, v3
    buffer_load_dwordx4 v[148:151], v3, s[12:15], s30 offen
    v_add_u32 v3, 7168, v3
    buffer_load_dwordx4 v[152:155], v3, s[12:15], s30 offen
    v_add_u32 v3, 7168, v3
    buffer_load_dwordx4 v[156:159], v3, s[12:15], s30 offen
    v_add_u32 v3, 7168, v3
    buffer_load_dwordx4 v[160:163], v3, s[12:15], s30 offen
    v_add_u32 v3, 7168, v3
    buffer_load_dwordx4 v[164:167], v3, s[12:15], s30 offen
    v_add_u32 v3, 7168, v3
    s_waitcnt vmcnt(31)
    v_lshlrev_b32 v32, 16, v40
    v_and_b32 v33, 0xffff0000, v40
    v_lshlrev_b32 v34, 16, v41
    v_and_b32 v35, 0xffff0000, v41
    v_lshlrev_b32 v36, 16, v42
    v_and_b32 v37, 0xffff0000, v42
    v_lshlrev_b32 v38, 16, v43
    v_and_b32 v39, 0xffff0000, v43
    v_add_f32 v8, v8, v32
    v_add_f32 v9, v9, v33
    v_add_f32 v10, v10, v34
    v_add_f32 v11, v11, v35
    v_add_f32 v12, v12, v36
    v_add_f32 v13, v13, v37
    v_add_f32 v14, v14, v38
    v_add_f32 v15, v15, v39
    s_waitcnt vmcnt(30)
    v_lshlrev_b32 v32, 16, v44
    v_and_b32 v33, 0xffff0000, v44
    v_lshlrev_b32 v34, 16, v45
    v_and_b32 v35, 0xffff0000, v45
    v_lshlrev_b32 v36, 16, v46
    v_and_b32 v37, 0xffff0000, v46
    v_lshlrev_b32 v38, 16, v47
    v_and_b32 v39, 0xffff0000, v47
    v_add_f32 v8, v8, v32
    v_add_f32 v9, v9, v33
    v_add_f32 v10, v10, v34
    v_add_f32 v11, v11, v35
    v_add_f32 v12, v12, v36
    v_add_f32 v13, v13, v37
    v_add_f32 v14, v14, v38
    v_add_f32 v15, v15, v39
    s_waitcnt vmcnt(29)
    v_lshlrev_b32 v32, 16, v48
    v_and_b32 v33, 0xffff0000, v48
    v_lshlrev_b32 v34, 16, v49
    v_and_b32 v35, 0xffff0000, v49
    v_lshlrev_b32 v36, 16, v50
    v_and_b32 v37, 0xffff0000, v50
    v_lshlrev_b32 v38, 16, v51
    v_and_b32 v39, 0xffff0000, v51
    v_add_f32 v8, v8, v32
    v_add_f32 v9, v9, v33
    v_add_f32 v10, v10, v34
    v_add_f32 v11, v11, v35
    v_add_f32 v12, v12, v36
    v_add_f32 v13, v13, v37
    v_add_f32 v14, v14, v38
    v_add_f32 v15, v15, v39
    s_waitcnt vmcnt(28)
    v_lshlrev_b32 v32, 16, v52
    v_and_b32 v33, 0xffff0000, v52
    v_lshlrev_b32 v34, 16, v53
    v_and_b32 v35, 0xffff0000, v53
    v_lshlrev_b32 v36, 16, v54
    v_and_b32 v37, 0xffff0000, v54
    v_lshlrev_b32 v38, 16, v55
    v_and_b32 v39, 0xffff0000, v55
    v_add_f32 v8, v8, v32
    v_add_f32 v9, v9, v33
    v_add_f32 v10, v10, v34
    v_add_f32 v11, v11, v35
    v_add_f32 v12, v12, v36
    v_add_f32 v13, v13, v37
    v_add_f32 v14, v14, v38
    v_add_f32 v15, v15, v39
    s_waitcnt vmcnt(27)
    v_lshlrev_b32 v32, 16, v56
    v_and_b32 v33, 0xffff0000, v56
    v_lshlrev_b32 v34, 16, v57
    v_and_b32 v35, 0xffff0000, v57
    v_lshlrev_b32 v36, 16, v58
    v_and_b32 v37, 0xffff0000, v58
    v_lshlrev_b32 v38, 16, v59
    v_and_b32 v39, 0xffff0000, v59
    v_add_f32 v8, v8, v32
    v_add_f32 v9, v9, v33
    v_add_f32 v10, v10, v34
    v_add_f32 v11, v11, v35
    v_add_f32 v12, v12, v36
    v_add_f32 v13, v13, v37
    v_add_f32 v14, v14, v38
    v_add_f32 v15, v15, v39
    s_waitcnt vmcnt(26)
    v_lshlrev_b32 v32, 16, v60
    v_and_b32 v33, 0xffff0000, v60
    v_lshlrev_b32 v34, 16, v61
    v_and_b32 v35, 0xffff0000, v61
    v_lshlrev_b32 v36, 16, v62
    v_and_b32 v37, 0xffff0000, v62
    v_lshlrev_b32 v38, 16, v63
    v_and_b32 v39, 0xffff0000, v63
    v_add_f32 v8, v8, v32
    v_add_f32 v9, v9, v33
    v_add_f32 v10, v10, v34
    v_add_f32 v11, v11, v35
    v_add_f32 v12, v12, v36
    v_add_f32 v13, v13, v37
    v_add_f32 v14, v14, v38
    v_add_f32 v15, v15, v39
    s_waitcnt vmcnt(25)
    v_lshlrev_b32 v32, 16, v64
    v_and_b32 v33, 0xffff0000, v64
    v_lshlrev_b32 v34, 16, v65
    v_and_b32 v35, 0xffff0000, v65
    v_lshlrev_b32 v36, 16, v66
    v_and_b32 v37, 0xffff0000, v66
    v_lshlrev_b32 v38, 16, v67
    v_and_b32 v39, 0xffff0000, v67
    v_add_f32 v8, v8, v32
    v_add_f32 v9, v9, v33
    v_add_f32 v10, v10, v34
    v_add_f32 v11, v11, v35
    v_add_f32 v12, v12, v36
    v_add_f32 v13, v13, v37
    v_add_f32 v14, v14, v38
    v_add_f32 v15, v15, v39
    s_waitcnt vmcnt(24)
    v_lshlrev_b32 v32, 16, v68
    v_and_b32 v33, 0xffff0000, v68
    v_lshlrev_b32 v34, 16, v69
    v_and_b32 v35, 0xffff0000, v69
    v_lshlrev_b32 v36, 16, v70
    v_and_b32 v37, 0xffff0000, v70
    v_lshlrev_b32 v38, 16, v71
    v_and_b32 v39, 0xffff0000, v71
    v_add_f32 v8, v8, v32
    v_add_f32 v9, v9, v33
    v_add_f32 v10, v10, v34
    v_add_f32 v11, v11, v35
    v_add_f32 v12, v12, v36
    v_add_f32 v13, v13, v37
    v_add_f32 v14, v14, v38
    v_add_f32 v15, v15, v39
    s_waitcnt vmcnt(23)
    v_lshlrev_b32 v32, 16, v72
    v_and_b32 v33, 0xffff0000, v72
    v_lshlrev_b32 v34, 16, v73
    v_and_b32 v35, 0xffff0000, v73
    v_lshlrev_b32 v36, 16, v74
    v_and_b32 v37, 0xffff0000, v74
    v_lshlrev_b32 v38, 16, v75
    v_and_b32 v39, 0xffff0000, v75
    v_add_f32 v8, v8, v32
    v_add_f32 v9, v9, v33
    v_add_f32 v10, v10, v34
    v_add_f32 v11, v11, v35
    v_add_f32 v12, v12, v36
    v_add_f32 v13, v13, v37
    v_add_f32 v14, v14, v38
    v_add_f32 v15, v15, v39
    s_waitcnt vmcnt(22)
    v_lshlrev_b32 v32, 16, v76
    v_and_b32 v33, 0xffff0000, v76
    v_lshlrev_b32 v34, 16, v77
    v_and_b32 v35, 0xffff0000, v77
    v_lshlrev_b32 v36, 16, v78
    v_and_b32 v37, 0xffff0000, v78
    v_lshlrev_b32 v38, 16, v79
    v_and_b32 v39, 0xffff0000, v79
    v_add_f32 v8, v8, v32
    v_add_f32 v9, v9, v33
    v_add_f32 v10, v10, v34
    v_add_f32 v11, v11, v35
    v_add_f32 v12, v12, v36
    v_add_f32 v13, v13, v37
    v_add_f32 v14, v14, v38
    v_add_f32 v15, v15, v39
    s_waitcnt vmcnt(21)
    v_lshlrev_b32 v32, 16, v80
    v_and_b32 v33, 0xffff0000, v80
    v_lshlrev_b32 v34, 16, v81
    v_and_b32 v35, 0xffff0000, v81
    v_lshlrev_b32 v36, 16, v82
    v_and_b32 v37, 0xffff0000, v82
    v_lshlrev_b32 v38, 16, v83
    v_and_b32 v39, 0xffff0000, v83
    v_add_f32 v8, v8, v32
    v_add_f32 v9, v9, v33
    v_add_f32 v10, v10, v34
    v_add_f32 v11, v11, v35
    v_add_f32 v12, v12, v36
    v_add_f32 v13, v13, v37
    v_add_f32 v14, v14, v38
    v_add_f32 v15, v15, v39
    s_waitcnt vmcnt(20)
    v_lshlrev_b32 v32, 16, v84
    v_and_b32 v33, 0xffff0000, v84
    v_lshlrev_b32 v34, 16, v85
    v_and_b32 v35, 0xffff0000, v85
    v_lshlrev_b32 v36, 16, v86
    v_and_b32 v37, 0xffff0000, v86
    v_lshlrev_b32 v38, 16, v87
    v_and_b32 v39, 0xffff0000, v87
    v_add_f32 v8, v8, v32
    v_add_f32 v9, v9, v33
    v_add_f32 v10, v10, v34
    v_add_f32 v11, v11, v35
    v_add_f32 v12, v12, v36
    v_add_f32 v13, v13, v37
    v_add_f32 v14, v14, v38
    v_add_f32 v15, v15, v39
    s_waitcnt vmcnt(19)
    v_lshlrev_b32 v32, 16, v88
    v_and_b32 v33, 0xffff0000, v88
    v_lshlrev_b32 v34, 16, v89
    v_and_b32 v35, 0xffff0000, v89
    v_lshlrev_b32 v36, 16, v90
    v_and_b32 v37, 0xffff0000, v90
    v_lshlrev_b32 v38, 16, v91
    v_and_b32 v39, 0xffff0000, v91
    v_add_f32 v8, v8, v32
    v_add_f32 v9, v9, v33
    v_add_f32 v10, v10, v34
    v_add_f32 v11, v11, v35
    v_add_f32 v12, v12, v36
    v_add_f32 v13, v13, v37
    v_add_f32 v14, v14, v38
    v_add_f32 v15, v15, v39
    s_waitcnt vmcnt(18)
    v_lshlrev_b32 v32, 16, v92
    v_and_b32 v33, 0xffff0000, v92
    v_lshlrev_b32 v34, 16, v93
    v_and_b32 v35, 0xffff0000, v93
    v_lshlrev_b32 v36, 16, v94
    v_and_b32 v37, 0xffff0000, v94
    v_lshlrev_b32 v38, 16, v95
    v_and_b32 v39, 0xffff0000, v95
    v_add_f32 v8, v8, v32
    v_add_f32 v9, v9, v33
    v_add_f32 v10, v10, v34
    v_add_f32 v11, v11, v35
    v_add_f32 v12, v12, v36
    v_add_f32 v13, v13, v37
    v_add_f32 v14, v14, v38
    v_add_f32 v15, v15, v39
    s_waitcnt vmcnt(17)
    v_lshlrev_b32 v32, 16, v96
    v_and_b32 v33, 0xffff0000, v96
    v_lshlrev_b32 v34, 16, v97
    v_and_b32 v35, 0xffff0000, v97
    v_lshlrev_b32 v36, 16, v98
    v_and_b32 v37, 0xffff0000, v98
    v_lshlrev_b32 v38, 16, v99
    v_and_b32 v39, 0xffff0000, v99
    v_add_f32 v8, v8, v32
    v_add_f32 v9, v9, v33
    v_add_f32 v10, v10, v34
    v_add_f32 v11, v11, v35
    v_add_f32 v12, v12, v36
    v_add_f32 v13, v13, v37
    v_add_f32 v14, v14, v38
    v_add_f32 v15, v15, v39
    s_waitcnt vmcnt(16)
    v_lshlrev_b32 v32, 16, v100
    v_and_b32 v33, 0xffff0000, v100
    v_lshlrev_b32 v34, 16, v101
    v_and_b32 v35, 0xffff0000, v101
    v_lshlrev_b32 v36, 16, v102
    v_and_b32 v37, 0xffff0000, v102
    v_lshlrev_b32 v38, 16, v103
    v_and_b32 v39, 0xffff0000, v103
    v_add_f32 v8, v8, v32
    v_add_f32 v9, v9, v33
    v_add_f32 v10, v10, v34
    v_add_f32 v11, v11, v35
    v_add_f32 v12, v12, v36
    v_add_f32 v13, v13, v37
    v_add_f32 v14, v14, v38
    v_add_f32 v15, v15, v39
    s_waitcnt vmcnt(15)
    v_lshlrev_b32 v32, 16, v104
    v_and_b32 v33, 0xffff0000, v104
    v_lshlrev_b32 v34, 16, v105
    v_and_b32 v35, 0xffff0000, v105
    v_lshlrev_b32 v36, 16, v106
    v_and_b32 v37, 0xffff0000, v106
    v_lshlrev_b32 v38, 16, v107
    v_and_b32 v39, 0xffff0000, v107
    v_add_f32 v8, v8, v32
    v_add_f32 v9, v9, v33
    v_add_f32 v10, v10, v34
    v_add_f32 v11, v11, v35
    v_add_f32 v12, v12, v36
    v_add_f32 v13, v13, v37
    v_add_f32 v14, v14, v38
    v_add_f32 v15, v15, v39
    s_waitcnt vmcnt(14)
    v_lshlrev_b32 v32, 16, v108
    v_and_b32 v33, 0xffff0000, v108
    v_lshlrev_b32 v34, 16, v109
    v_and_b32 v35, 0xffff0000, v109
    v_lshlrev_b32 v36, 16, v110
    v_and_b32 v37, 0xffff0000, v110
    v_lshlrev_b32 v38, 16, v111
    v_and_b32 v39, 0xffff0000, v111
    v_add_f32 v8, v8, v32
    v_add_f32 v9, v9, v33
    v_add_f32 v10, v10, v34
    v_add_f32 v11, v11, v35
    v_add_f32 v12, v12, v36
    v_add_f32 v13, v13, v37
    v_add_f32 v14, v14, v38
    v_add_f32 v15, v15, v39
    s_waitcnt vmcnt(13)
    v_lshlrev_b32 v32, 16, v112
    v_and_b32 v33, 0xffff0000, v112
    v_lshlrev_b32 v34, 16, v113
    v_and_b32 v35, 0xffff0000, v113
    v_lshlrev_b32 v36, 16, v114
    v_and_b32 v37, 0xffff0000, v114
    v_lshlrev_b32 v38, 16, v115
    v_and_b32 v39, 0xffff0000, v115
    v_add_f32 v8, v8, v32
    v_add_f32 v9, v9, v33
    v_add_f32 v10, v10, v34
    v_add_f32 v11, v11, v35
    v_add_f32 v12, v12, v36
    v_add_f32 v13, v13, v37
    v_add_f32 v14, v14, v38
    v_add_f32 v15, v15, v39
    s_waitcnt vmcnt(12)
    v_lshlrev_b32 v32, 16, v116
    v_and_b32 v33, 0xffff0000, v116
    v_lshlrev_b32 v34, 16, v117
    v_and_b32 v35, 0xffff0000, v117
    v_lshlrev_b32 v36, 16, v118
    v_and_b32 v37, 0xffff0000, v118
    v_lshlrev_b32 v38, 16, v119
    v_and_b32 v39, 0xffff0000, v119
    v_add_f32 v8, v8, v32
    v_add_f32 v9, v9, v33
    v_add_f32 v10, v10, v34
    v_add_f32 v11, v11, v35
    v_add_f32 v12, v12, v36
    v_add_f32 v13, v13, v37
    v_add_f32 v14, v14, v38
    v_add_f32 v15, v15, v39
    s_waitcnt vmcnt(11)
    v_lshlrev_b32 v32, 16, v120
    v_and_b32 v33, 0xffff0000, v120
    v_lshlrev_b32 v34, 16, v121
    v_and_b32 v35, 0xffff0000, v121
    v_lshlrev_b32 v36, 16, v122
    v_and_b32 v37, 0xffff0000, v122
    v_lshlrev_b32 v38, 16, v123
    v_and_b32 v39, 0xffff0000, v123
    v_add_f32 v8, v8, v32
    v_add_f32 v9, v9, v33
    v_add_f32 v10, v10, v34
    v_add_f32 v11, v11, v35
    v_add_f32 v12, v12, v36
    v_add_f32 v13, v13, v37
    v_add_f32 v14, v14, v38
    v_add_f32 v15, v15, v39
    s_waitcnt vmcnt(10)
    v_lshlrev_b32 v32, 16, v124
    v_and_b32 v33, 0xffff0000, v124
    v_lshlrev_b32 v34, 16, v125
    v_and_b32 v35, 0xffff0000, v125
    v_lshlrev_b32 v36, 16, v126
    v_and_b32 v37, 0xffff0000, v126
    v_lshlrev_b32 v38, 16, v127
    v_and_b32 v39, 0xffff0000, v127
    v_add_f32 v8, v8, v32
    v_add_f32 v9, v9, v33
    v_add_f32 v10, v10, v34
    v_add_f32 v11, v11, v35
    v_add_f32 v12, v12, v36
    v_add_f32 v13, v13, v37
    v_add_f32 v14, v14, v38
    v_add_f32 v15, v15, v39
    s_waitcnt vmcnt(9)
    v_lshlrev_b32 v32, 16, v128
    v_and_b32 v33, 0xffff0000, v128
    v_lshlrev_b32 v34, 16, v129
    v_and_b32 v35, 0xffff0000, v129
    v_lshlrev_b32 v36, 16, v130
    v_and_b32 v37, 0xffff0000, v130
    v_lshlrev_b32 v38, 16, v131
    v_and_b32 v39, 0xffff0000, v131
    v_add_f32 v8, v8, v32
    v_add_f32 v9, v9, v33
    v_add_f32 v10, v10, v34
    v_add_f32 v11, v11, v35
    v_add_f32 v12, v12, v36
    v_add_f32 v13, v13, v37
    v_add_f32 v14, v14, v38
    v_add_f32 v15, v15, v39
    s_waitcnt vmcnt(8)
    v_lshlrev_b32 v32, 16, v132
    v_and_b32 v33, 0xffff0000, v132
    v_lshlrev_b32 v34, 16, v133
    v_and_b32 v35, 0xffff0000, v133
    v_lshlrev_b32 v36, 16, v134
    v_and_b32 v37, 0xffff0000, v134
    v_lshlrev_b32 v38, 16, v135
    v_and_b32 v39, 0xffff0000, v135
    v_add_f32 v8, v8, v32
    v_add_f32 v9, v9, v33
    v_add_f32 v10, v10, v34
    v_add_f32 v11, v11, v35
    v_add_f32 v12, v12, v36
    v_add_f32 v13, v13, v37
    v_add_f32 v14, v14, v38
    v_add_f32 v15, v15, v39
    s_waitcnt vmcnt(7)
    v_lshlrev_b32 v32, 16, v136
    v_and_b32 v33, 0xffff0000, v136
    v_lshlrev_b32 v34, 16, v137
    v_and_b32 v35, 0xffff0000, v137
    v_lshlrev_b32 v36, 16, v138
    v_and_b32 v37, 0xffff0000, v138
    v_lshlrev_b32 v38, 16, v139
    v_and_b32 v39, 0xffff0000, v139
    v_add_f32 v8, v8, v32
    v_add_f32 v9, v9, v33
    v_add_f32 v10, v10, v34
    v_add_f32 v11, v11, v35
    v_add_f32 v12, v12, v36
    v_add_f32 v13, v13, v37
    v_add_f32 v14, v14, v38
    v_add_f32 v15, v15, v39
    s_waitcnt vmcnt(6)
    v_lshlrev_b32 v32, 16, v140
    v_and_b32 v33, 0xffff0000, v140
    v_lshlrev_b32 v34, 16, v141
    v_and_b32 v35, 0xffff0000, v141
    v_lshlrev_b32 v36, 16, v142
    v_and_b32 v37, 0xffff0000, v142
    v_lshlrev_b32 v38, 16, v143
    v_and_b32 v39, 0xffff0000, v143
    v_add_f32 v8, v8, v32
    v_add_f32 v9, v9, v33
    v_add_f32 v10, v10, v34
    v_add_f32 v11, v11, v35
    v_add_f32 v12, v12, v36
    v_add_f32 v13, v13, v37
    v_add_f32 v14, v14, v38
    v_add_f32 v15, v15, v39
    s_waitcnt vmcnt(5)
    v_lshlrev_b32 v32, 16, v144
    v_and_b32 v33, 0xffff0000, v144
    v_lshlrev_b32 v34, 16, v145
    v_and_b32 v35, 0xffff0000, v145
    v_lshlrev_b32 v36, 16, v146
    v_and_b32 v37, 0xffff0000, v146
    v_lshlrev_b32 v38, 16, v147
    v_and_b32 v39, 0xffff0000, v147
    v_add_f32 v8, v8, v32
    v_add_f32 v9, v9, v33
    v_add_f32 v10, v10, v34
    v_add_f32 v11, v11, v35
    v_add_f32 v12, v12, v36
    v_add_f32 v13, v13, v37
    v_add_f32 v14, v14, v38
    v_add_f32 v15, v15, v39
    s_waitcnt vmcnt(4)
    v_lshlrev_b32 v32, 16, v148
    v_and_b32 v33, 0xffff0000, v148
    v_lshlrev_b32 v34, 16, v149
    v_and_b32 v35, 0xffff0000, v149
    v_lshlrev_b32 v36, 16, v150
    v_and_b32 v37, 0xffff0000, v150
    v_lshlrev_b32 v38, 16, v151
    v_and_b32 v39, 0xffff0000, v151
    v_add_f32 v8, v8, v32
    v_add_f32 v9, v9, v33
    v_add_f32 v10, v10, v34
    v_add_f32 v11, v11, v35
    v_add_f32 v12, v12, v36
    v_add_f32 v13, v13, v37
    v_add_f32 v14, v14, v38
    v_add_f32 v15, v15, v39
    s_waitcnt vmcnt(3)
    v_lshlrev_b32 v32, 16, v152
    v_and_b32 v33, 0xffff0000, v152
    v_lshlrev_b32 v34, 16, v153
    v_and_b32 v35, 0xffff0000, v153
    v_lshlrev_b32 v36, 16, v154
    v_and_b32 v37, 0xffff0000, v154
    v_lshlrev_b32 v38, 16, v155
    v_and_b32 v39, 0xffff0000, v155
    v_add_f32 v8, v8, v32
    v_add_f32 v9, v9, v33
    v_add_f32 v10, v10, v34
    v_add_f32 v11, v11, v35
    v_add_f32 v12, v12, v36
    v_add_f32 v13, v13, v37
    v_add_f32 v14, v14, v38
    v_add_f32 v15, v15, v39
    s_waitcnt vmcnt(2)
    v_lshlrev_b32 v32, 16, v156
    v_and_b32 v33, 0xffff0000, v156
    v_lshlrev_b32 v34, 16, v157
    v_and_b32 v35, 0xffff0000, v157
    v_lshlrev_b32 v36, 16, v158
    v_and_b32 v37, 0xffff0000, v158
    v_lshlrev_b32 v38, 16, v159
    v_and_b32 v39, 0xffff0000, v159
    v_add_f32 v8, v8, v32
    v_add_f32 v9, v9, v33
    v_add_f32 v10, v10, v34
    v_add_f32 v11, v11, v35
    v_add_f32 v12, v12, v36
    v_add_f32 v13, v13, v37
    v_add_f32 v14, v14, v38
    v_add_f32 v15, v15, v39
    s_waitcnt vmcnt(1)
    v_lshlrev_b32 v32, 16, v160
    v_and_b32 v33, 0xffff0000, v160
    v_lshlrev_b32 v34, 16, v161
    v_and_b32 v35, 0xffff0000, v161
    v_lshlrev_b32 v36, 16, v162
    v_and_b32 v37, 0xffff0000, v162
    v_lshlrev_b32 v38, 16, v163
    v_and_b32 v39, 0xffff0000, v163
    v_add_f32 v8, v8, v32
    v_add_f32 v9, v9, v33
    v_add_f32 v10, v10, v34
    v_add_f32 v11, v11, v35
    v_add_f32 v12, v12, v36
    v_add_f32 v13, v13, v37
    v_add_f32 v14, v14, v38
    v_add_f32 v15, v15, v39
    s_waitcnt vmcnt(0)
    v_lshlrev_b32 v32, 16, v164
    v_and_b32 v33, 0xffff0000, v164
    v_lshlrev_b32 v34, 16, v165
    v_and_b32 v35, 0xffff0000, v165
    v_lshlrev_b32 v36, 16, v166
    v_and_b32 v37, 0xffff0000, v166
    v_lshlrev_b32 v38, 16, v167
    v_and_b32 v39, 0xffff0000, v167
    v_add_f32 v8, v8, v32
    v_add_f32 v9, v9, v33
    v_add_f32 v10, v10, v34
    v_add_f32 v11, v11, v35
    v_add_f32 v12, v12, v36
    v_add_f32 v13, v13, v37
    v_add_f32 v14, v14, v38
    v_add_f32 v15, v15, v39
    v_lshlrev_b32 v4, 9, v2
    v_lshl_add_u32 v4, v1, 5, v4
    ds_write_b128 v4, v[8:11]
    ds_write_b128 v4, v[12:15] offset:16
    s_waitcnt lgkmcnt(0)
l2_kernel_csx_23:
    s_mov_b64 exec, s[56:57]
    s_barrier
    v_cmp_gt_u32 vcc, 128, v0
    s_nop 0
    s_and_saveexec_b64 s[56:57], vcc
    s_cbranch_execz l2_kernel_csy_24
    v_lshlrev_b32 v4, 2, v0
    v_mov_b32 v5, 0
    ds_read_b32 v6, v4 offset:0
    s_waitcnt lgkmcnt(0)
    v_add_f32 v5, v5, v6
    ds_read_b32 v6, v4 offset:512
    s_waitcnt lgkmcnt(0)
    v_add_f32 v5, v5, v6
    ds_read_b32 v6, v4 offset:1024
    s_waitcnt lgkmcnt(0)
    v_add_f32 v5, v5, v6
    ds_read_b32 v6, v4 offset:1536
    s_waitcnt lgkmcnt(0)
    v_add_f32 v5, v5, v6
    ds_read_b32 v6, v4 offset:2048
    s_waitcnt lgkmcnt(0)
    v_add_f32 v5, v5, v6
    ds_read_b32 v6, v4 offset:2560
    s_waitcnt lgkmcnt(0)
    v_add_f32 v5, v5, v6
    ds_read_b32 v6, v4 offset:3072
    s_waitcnt lgkmcnt(0)
    v_add_f32 v5, v5, v6
    ds_read_b32 v6, v4 offset:3584
    s_waitcnt lgkmcnt(0)
    v_add_f32 v5, v5, v6
    ds_read_b32 v6, v4 offset:4096
    s_waitcnt lgkmcnt(0)
    v_add_f32 v5, v5, v6
    ds_read_b32 v6, v4 offset:4608
    s_waitcnt lgkmcnt(0)
    v_add_f32 v5, v5, v6
    ds_read_b32 v6, v4 offset:5120
    s_waitcnt lgkmcnt(0)
    v_add_f32 v5, v5, v6
    ds_read_b32 v6, v4 offset:5632
    s_waitcnt lgkmcnt(0)
    v_add_f32 v5, v5, v6
    ds_read_b32 v6, v4 offset:6144
    s_waitcnt lgkmcnt(0)
    v_add_f32 v5, v5, v6
    ds_read_b32 v6, v4 offset:6656
    s_waitcnt lgkmcnt(0)
    v_add_f32 v5, v5, v6
    ds_read_b32 v6, v4 offset:7168
    s_waitcnt lgkmcnt(0)
    v_add_f32 v5, v5, v6
    ds_read_b32 v6, v4 offset:7680
    s_waitcnt lgkmcnt(0)
    v_add_f32 v5, v5, v6
    ds_read_b32 v6, v4 offset:8192
    s_waitcnt lgkmcnt(0)
    v_add_f32 v5, v5, v6
    ds_read_b32 v6, v4 offset:8704
    s_waitcnt lgkmcnt(0)
    v_add_f32 v5, v5, v6
    ds_read_b32 v6, v4 offset:9216
    s_waitcnt lgkmcnt(0)
    v_add_f32 v5, v5, v6
    ds_read_b32 v6, v4 offset:9728
    s_waitcnt lgkmcnt(0)
    v_add_f32 v5, v5, v6
    ds_read_b32 v6, v4 offset:10240
    s_waitcnt lgkmcnt(0)
    v_add_f32 v5, v5, v6
    ds_read_b32 v6, v4 offset:10752
    s_waitcnt lgkmcnt(0)
    v_add_f32 v5, v5, v6
    ds_read_b32 v6, v4 offset:11264
    s_waitcnt lgkmcnt(0)
    v_add_f32 v5, v5, v6
    ds_read_b32 v6, v4 offset:11776
    s_waitcnt lgkmcnt(0)
    v_add_f32 v5, v5, v6
    ds_read_b32 v6, v4 offset:12288
    s_waitcnt lgkmcnt(0)
    v_add_f32 v5, v5, v6
    ds_read_b32 v6, v4 offset:12800
    s_waitcnt lgkmcnt(0)
    v_add_f32 v5, v5, v6
    ds_read_b32 v6, v4 offset:13312
    s_waitcnt lgkmcnt(0)
    v_add_f32 v5, v5, v6
    ds_read_b32 v6, v4 offset:13824
    s_waitcnt lgkmcnt(0)
    v_add_f32 v5, v5, v6
    ds_read_b32 v6, v4 offset:14336
    s_waitcnt lgkmcnt(0)
    v_add_f32 v5, v5, v6
    ds_read_b32 v6, v4 offset:14848
    s_waitcnt lgkmcnt(0)
    v_add_f32 v5, v5, v6
    ds_read_b32 v6, v4 offset:15360
    s_waitcnt lgkmcnt(0)
    v_add_f32 v5, v5, v6
    ds_read_b32 v6, v4 offset:15872
    s_waitcnt lgkmcnt(0)
    v_add_f32 v5, v5, v6
    s_lshl_b32 s30, s52, 9
    buffer_store_dword v5, v4, s[16:19], s30 offen
l2_kernel_csy_24:
    s_endpgm
l2_kernel_end_1:
    s_endpgm
.text
.globl l3_kernel
.p2align 8
.type l3_kernel,@function
l3_kernel:
    s_cmp_ge_u32 s2, 256
    s_cbranch_scc1 l3_kernel_end_1
    s_cmp_ge_u32 s2, 224
    s_cbranch_scc1 l3_kernel_pf_2
    s_sub_u32 s52, s2, 0
    s_mul_hi_u32 s34, s52, 153391690
    s_mul_i32 s29, s34, 28
    s_sub_u32 s35, s52, s29
    s_load_dwordx2 s[40:41], s[0:1], 96
    s_load_dwordx2 s[6:7], s[0:1], 56
    s_waitcnt lgkmcnt(0)
    s_add_u32 s8, s40, 22020096
    s_addc_u32 s9, s41, 0
    s_and_b32 s9, s9, 0xffff
    s_mov_b32 s10, 4194304
    s_mov_b32 s11, 0x00020000
    s_mov_b32 s12, s6
    s_mov_b32 s13, s7
    s_and_b32 s13, s13, 0xffff
    s_mov_b32 s14, 7340032
    s_mov_b32 s15, 0x00020000
    s_add_u32 s16, s40, 27262976
    s_addc_u32 s17, s41, 0
    s_and_b32 s17, s17, 0xffff
    s_mov_b32 s18, 14680064
    s_mov_b32 s19, 0x00020000
    s_mov_b32 s31, 0
    s_mov_b32 s32, 0
    s_mov_b32 s33, 16
    v_mov_b32 v146, v0
    v_lshrrev_b32 v148, 6, v0
    s_nop 0
    v_readfirstlane_b32 s24, v148
    s_nop 0
    s_cmp_lt_u32 s24, 8
    s_cbranch_scc1 l3_kernel_comp_3
    s_cmp_lt_u32 s24, 12
    s_cbranch_scc1 l3_kernel_lok_4
    s_endpgm
l3_kernel_lok_4:
    s_sub_u32 s24, s24, 8
    v_and_b32 v4, 63, v0
    s_mul_i32 s27, s24, 8192
    s_mul_i32 s28, s24, 4096
    s_add_u32 s28, s28, 32768
    v_lshrrev_b32 v6, 3, v4
    v_lshrrev_b32 v7, 4, v4
    v_and_b32 v8, 7, v4
    s_mul_i32 s29, s34, 256
    s_mul_i32 s30, s24, 64
    s_add_u32 s29, s29, s30
    s_mov_b32 s30, 2048
    v_add_u32 v9, s29, v6
    v_mul_lo_u32 v9, v9, s30
    v_xor_b32 v10, v7, v8
    v_lshlrev_b32 v10, 4, v10
    v_add_u32 v12, v9, v10
    v_add_u32 v9, s29, v6
    v_add_u32 v9, 8, v9
    v_mul_lo_u32 v9, v9, s30
    v_or_b32 v10, 4, v7
    v_xor_b32 v10, v10, v8
    v_lshlrev_b32 v10, 4, v10
    v_add_u32 v13, v9, v10
    v_add_u32 v9, s29, v6
    v_add_u32 v9, 16, v9
    v_mul_lo_u32 v9, v9, s30
    v_xor_b32 v10, v7, v8
    v_lshlrev_b32 v10, 4, v10
    v_add_u32 v14, v9, v10
    v_add_u32 v9, s29, v6
    v_add_u32 v9, 24, v9
    v_mul_lo_u32 v9, v9, s30
    v_or_b32 v10, 4, v7
    v_xor_b32 v10, v10, v8
    v_lshlrev_b32 v10, 4, v10
    v_add_u32 v15, v9, v10
    v_add_u32 v9, s29, v6
    v_add_u32 v9, 32, v9
    v_mul_lo_u32 v9, v9, s30
    v_xor_b32 v10, v7, v8
    v_lshlrev_b32 v10, 4, v10
    v_add_u32 v16, v9, v10
    v_add_u32 v9, s29, v6
    v_add_u32 v9, 40, v9
    v_mul_lo_u32 v9, v9, s30
    v_or_b32 v10, 4, v7
    v_xor_b32 v10, v10, v8
    v_lshlrev_b32 v10, 4, v10
    v_add_u32 v17, v9, v10
    v_add_u32 v9, s29, v6
    v_add_u32 v9, 48, v9
    v_mul_lo_u32 v9, v9, s30
    v_xor_b32 v10, v7, v8
    v_lshlrev_b32 v10, 4, v10
    v_add_u32 v18, v9, v10
    v_add_u32 v9, s29, v6
    v_add_u32 v9, 56, v9
    v_mul_lo_u32 v9, v9, s30
    v_or_b32 v10, 4, v7
    v_xor_b32 v10, v10, v8
    v_lshlrev_b32 v10, 4, v10
    v_add_u32 v19, v9, v10
    v_lshrrev_b32 v6, 4, v4
    v_and_b32 v8, 15, v4
    v_lshlrev_b32 v7, 2, v6
    v_xor_b32 v8, v8, v7
    v_lshlrev_b32 v8, 4, v8
    s_mul_i32 s30, s35, 256
    s_mul_i32 s29, s24, 16
    v_add_u32 v8, s30, v8
    s_mov_b32 s30, 7168
    v_add_u32 v9, s29, v6
    v_mul_lo_u32 v9, v9, s30
    v_add_u32 v20, v9, v8
    v_add_u32 v9, s29, v6
    v_add_u32 v9, 4, v9
    v_mul_lo_u32 v9, v9, s30
    v_add_u32 v21, v9, v8
    v_add_u32 v9, s29, v6
    v_add_u32 v9, 8, v9
    v_mul_lo_u32 v9, v9, s30
    v_add_u32 v22, v9, v8
    v_add_u32 v9, s29, v6
    v_add_u32 v9, 12, v9
    v_mul_lo_u32 v9, v9, s30
    v_add_u32 v23, v9, v8
    s_add_u32 m0, s27, 0
    s_nop 0
    buffer_load_dwordx4 v12, s[8:11], s31 offen lds
    s_add_u32 m0, s27, 1024
    s_nop 0
    buffer_load_dwordx4 v13, s[8:11], s31 offen lds
    s_add_u32 m0, s27, 2048
    s_nop 0
    buffer_load_dwordx4 v14, s[8:11], s31 offen lds
    s_add_u32 m0, s27, 3072
    s_nop 0
    buffer_load_dwordx4 v15, s[8:11], s31 offen lds
    s_add_u32 m0, s27, 4096
    s_nop 0
    buffer_load_dwordx4 v16, s[8:11], s31 offen lds
    s_add_u32 m0, s27, 5120
    s_nop 0
    buffer_load_dwordx4 v17, s[8:11], s31 offen lds
    s_add_u32 m0, s27, 6144
    s_nop 0
    buffer_load_dwordx4 v18, s[8:11], s31 offen lds
    s_add_u32 m0, s27, 7168
    s_nop 0
    buffer_load_dwordx4 v19, s[8:11], s31 offen lds
    s_add_u32 m0, s28, 0
    s_nop 0
    buffer_load_dwordx4 v20, s[12:15], s32 offen lds
    s_add_u32 m0, s28, 1024
    s_nop 0
    buffer_load_dwordx4 v21, s[12:15], s32 offen lds
    s_add_u32 m0, s28, 2048
    s_nop 0
    buffer_load_dwordx4 v22, s[12:15], s32 offen lds
    s_add_u32 m0, s28, 3072
    s_nop 0
    buffer_load_dwordx4 v23, s[12:15], s32 offen lds
    s_add_u32 s31, s31, 128
    s_add_u32 s32, s32, 458752
    s_add_u32 m0, s27, 49152
    s_nop 0
    buffer_load_dwordx4 v12, s[8:11], s31 offen lds
    s_add_u32 m0, s27, 50176
    s_nop 0
    buffer_load_dwordx4 v13, s[8:11], s31 offen lds
    s_add_u32 m0, s27, 51200
    s_nop 0
    buffer_load_dwordx4 v14, s[8:11], s31 offen lds
    s_add_u32 m0, s27, 52224
    s_nop 0
    buffer_load_dwordx4 v15, s[8:11], s31 offen lds
    s_add_u32 m0, s27, 53248
    s_nop 0
    buffer_load_dwordx4 v16, s[8:11], s31 offen lds
    s_add_u32 m0, s27, 54272
    s_nop 0
    buffer_load_dwordx4 v17, s[8:11], s31 offen lds
    s_add_u32 m0, s27, 55296
    s_nop 0
    buffer_load_dwordx4 v18, s[8:11], s31 offen lds
    s_add_u32 m0, s27, 56320
    s_nop 0
    buffer_load_dwordx4 v19, s[8:11], s31 offen lds
    s_add_u32 m0, s28, 49152
    s_nop 0
    buffer_load_dwordx4 v20, s[12:15], s32 offen lds
    s_add_u32 m0, s28, 50176
    s_nop 0
    buffer_load_dwordx4 v21, s[12:15], s32 offen lds
    s_add_u32 m0, s28, 51200
    s_nop 0
    buffer_load_dwordx4 v22, s[12:15], s32 offen lds
    s_add_u32 m0, s28, 52224
    s_nop 0
    buffer_load_dwordx4 v23, s[12:15], s32 offen lds
    s_add_u32 s31, s31, 128
    s_add_u32 s32, s32, 458752
l3_kernel_lloop_5:
    s_cmp_lt_u32 s33, 2
    s_cbranch_scc1 l3_kernel_w0_7
    s_waitcnt vmcnt(12)
    s_branch l3_kernel_w1_8
l3_kernel_w0_7:
    s_waitcnt vmcnt(0)
l3_kernel_w1_8:
    s_barrier
    s_cmp_le_u32 s33, 2
    s_cbranch_scc1 l3_kernel_nd_9
    s_add_u32 m0, s27, 98304
    s_nop 0
    buffer_load_dwordx4 v12, s[8:11], s31 offen lds
    s_add_u32 m0, s27, 99328
    s_nop 0
    buffer_load_dwordx4 v13, s[8:11], s31 offen lds
    s_add_u32 m0, s27, 100352
    s_nop 0
    buffer_load_dwordx4 v14, s[8:11], s31 offen lds
    s_add_u32 m0, s27, 101376
    s_nop 0
    buffer_load_dwordx4 v15, s[8:11], s31 offen lds
    s_add_u32 m0, s27, 102400
    s_nop 0
    buffer_load_dwordx4 v16, s[8:11], s31 offen lds
    s_add_u32 m0, s27, 103424
    s_nop 0
    buffer_load_dwordx4 v17, s[8:11], s31 offen lds
    s_add_u32 m0, s27, 104448
    s_nop 0
    buffer_load_dwordx4 v18, s[8:11], s31 offen lds
    s_add_u32 m0, s27, 105472
    s_nop 0
    buffer_load_dwordx4 v19, s[8:11], s31 offen lds
    s_add_u32 m0, s28, 98304
    s_nop 0
    buffer_load_dwordx4 v20, s[12:15], s32 offen lds
    s_add_u32 m0, s28, 99328
    s_nop 0
    buffer_load_dwordx4 v21, s[12:15], s32 offen lds
    s_add_u32 m0, s28, 100352
    s_nop 0
    buffer_load_dwordx4 v22, s[12:15], s32 offen lds
    s_add_u32 m0, s28, 101376
    s_nop 0
    buffer_load_dwordx4 v23, s[12:15], s32 offen lds
    s_add_u32 s31, s31, 128
    s_add_u32 s32, s32, 458752
l3_kernel_nd_9:
    s_sub_u32 s33, s33, 1
    s_cmp_eq_u32 s33, 0
    s_cbranch_scc1 l3_kernel_ldone_6
    s_cmp_lt_u32 s33, 2
    s_cbranch_scc1 l3_kernel_w0_10
    s_waitcnt vmcnt(12)
    s_branch l3_kernel_w1_11
l3_kernel_w0_10:
    s_waitcnt vmcnt(0)
l3_kernel_w1_11:
    s_barrier
    s_cmp_le_u32 s33, 2
    s_cbranch_scc1 l3_kernel_nd_12
    s_add_u32 m0, s27, 0
    s_nop 0
    buffer_load_dwordx4 v12, s[8:11], s31 offen lds
    s_add_u32 m0, s27, 1024
    s_nop 0
    buffer_load_dwordx4 v13, s[8:11], s31 offen lds
    s_add_u32 m0, s27, 2048
    s_nop 0
    buffer_load_dwordx4 v14, s[8:11], s31 offen lds
    s_add_u32 m0, s27, 3072
    s_nop 0
    buffer_load_dwordx4 v15, s[8:11], s31 offen lds
    s_add_u32 m0, s27, 4096
    s_nop 0
    buffer_load_dwordx4 v16, s[8:11], s31 offen lds
    s_add_u32 m0, s27, 5120
    s_nop 0
    buffer_load_dwordx4 v17, s[8:11], s31 offen lds
    s_add_u32 m0, s27, 6144
    s_nop 0
    buffer_load_dwordx4 v18, s[8:11], s31 offen lds
    s_add_u32 m0, s27, 7168
    s_nop 0
    buffer_load_dwordx4 v19, s[8:11], s31 offen lds
    s_add_u32 m0, s28, 0
    s_nop 0
    buffer_load_dwordx4 v20, s[12:15], s32 offen lds
    s_add_u32 m0, s28, 1024
    s_nop 0
    buffer_load_dwordx4 v21, s[12:15], s32 offen lds
    s_add_u32 m0, s28, 2048
    s_nop 0
    buffer_load_dwordx4 v22, s[12:15], s32 offen lds
    s_add_u32 m0, s28, 3072
    s_nop 0
    buffer_load_dwordx4 v23, s[12:15], s32 offen lds
    s_add_u32 s31, s31, 128
    s_add_u32 s32, s32, 458752
l3_kernel_nd_12:
    s_sub_u32 s33, s33, 1
    s_cmp_eq_u32 s33, 0
    s_cbranch_scc1 l3_kernel_ldone_6
    s_cmp_lt_u32 s33, 2
    s_cbranch_scc1 l3_kernel_w0_13
    s_waitcnt vmcnt(12)
    s_branch l3_kernel_w1_14
l3_kernel_w0_13:
    s_waitcnt vmcnt(0)
l3_kernel_w1_14:
    s_barrier
    s_cmp_le_u32 s33, 2
    s_cbranch_scc1 l3_kernel_nd_15
    s_add_u32 m0, s27, 49152
    s_nop 0
    buffer_load_dwordx4 v12, s[8:11], s31 offen lds
    s_add_u32 m0, s27, 50176
    s_nop 0
    buffer_load_dwordx4 v13, s[8:11], s31 offen lds
    s_add_u32 m0, s27, 51200
    s_nop 0
    buffer_load_dwordx4 v14, s[8:11], s31 offen lds
    s_add_u32 m0, s27, 52224
    s_nop 0
    buffer_load_dwordx4 v15, s[8:11], s31 offen lds
    s_add_u32 m0, s27, 53248
    s_nop 0
    buffer_load_dwordx4 v16, s[8:11], s31 offen lds
    s_add_u32 m0, s27, 54272
    s_nop 0
    buffer_load_dwordx4 v17, s[8:11], s31 offen lds
    s_add_u32 m0, s27, 55296
    s_nop 0
    buffer_load_dwordx4 v18, s[8:11], s31 offen lds
    s_add_u32 m0, s27, 56320
    s_nop 0
    buffer_load_dwordx4 v19, s[8:11], s31 offen lds
    s_add_u32 m0, s28, 49152
    s_nop 0
    buffer_load_dwordx4 v20, s[12:15], s32 offen lds
    s_add_u32 m0, s28, 50176
    s_nop 0
    buffer_load_dwordx4 v21, s[12:15], s32 offen lds
    s_add_u32 m0, s28, 51200
    s_nop 0
    buffer_load_dwordx4 v22, s[12:15], s32 offen lds
    s_add_u32 m0, s28, 52224
    s_nop 0
    buffer_load_dwordx4 v23, s[12:15], s32 offen lds
    s_add_u32 s31, s31, 128
    s_add_u32 s32, s32, 458752
l3_kernel_nd_15:
    s_sub_u32 s33, s33, 1
    s_cmp_eq_u32 s33, 0
    s_cbranch_scc0 l3_kernel_lloop_5
l3_kernel_ldone_6:
    s_endpgm
l3_kernel_comp_3:
    v_and_b32 v148, 63, v146
    s_lshr_b32 s25, s24, 1
    s_and_b32 s26, s24, 1
    v_and_b32 v150, 31, v148
    v_lshrrev_b32 v151, 5, v148
    v_lshrrev_b32 v152, 1, v148
    v_and_b32 v152, 7, v152
    s_mul_i32 s29, s25, 64
    v_add_u32 v153, s29, v150
    v_lshlrev_b32 v153, 7, v153
    v_add_u32 v154, 0, v151
    v_xor_b32 v154, v154, v152
    v_lshlrev_b32 v154, 4, v154
    v_add_u32 v128, v153, v154
    v_add_u32 v132, 49152, v128
    v_add_u32 v136, 98304, v128
    v_add_u32 v154, 2, v151
    v_xor_b32 v154, v154, v152
    v_lshlrev_b32 v154, 4, v154
    v_add_u32 v129, v153, v154
    v_add_u32 v133, 49152, v129
    v_add_u32 v137, 98304, v129
    v_add_u32 v154, 4, v151
    v_xor_b32 v154, v154, v152
    v_lshlrev_b32 v154, 4, v154
    v_add_u32 v130, v153, v154
    v_add_u32 v134, 49152, v130
    v_add_u32 v138, 98304, v130
    v_add_u32 v154, 6, v151
    v_xor_b32 v154, v154, v152
    v_lshlrev_b32 v154, 4, v154
    v_add_u32 v131, v153, v154
    v_add_u32 v135, 49152, v131
    v_add_u32 v139, 98304, v131
    v_lshrrev_b32 v150, 4, v148
    v_and_b32 v151, 15, v148
    v_lshrrev_b32 v151, 2, v151
    v_and_b32 v152, 3, v148
    v_lshrrev_b32 v153, 1, v150
    v_lshlrev_b32 v153, 3, v153
    v_add_u32 v153, v153, v151
    v_mul_u32_u24 v153, 256, v153
    v_and_b32 v154, 1, v150
    v_lshlrev_b32 v154, 1, v154
    v_lshrrev_b32 v155, 1, v152
    v_add_u32 v154, v154, v155
    s_mul_i32 s29, s26, 8
    v_add_u32 v154, s29, v154
    v_lshlrev_b32 v155, 2, v151
    v_and_b32 v152, 1, v152
    v_lshlrev_b32 v152, 3, v152
    v_add_u32 v153, v153, v152
    v_add_u32 v153, 32768, v153
    v_add_u32 v140, 0, v154
    v_xor_b32 v140, v140, v155
    v_lshlrev_b32 v140, 4, v140
    v_add_u32 v140, v140, v153
    v_add_u32 v142, 49152, v140
    v_add_u32 v144, 98304, v140
    v_add_u32 v141, 4, v154
    v_xor_b32 v141, v141, v155
    v_lshlrev_b32 v141, 4, v141
    v_add_u32 v141, v141, v153
    v_add_u32 v143, 49152, v141
    v_add_u32 v145, 98304, v141
    v_mov_b32 v0, 0
    v_mov_b32 v1, 0
    v_mov_b32 v2, 0
    v_mov_b32 v3, 0
    v_mov_b32 v4, 0
    v_mov_b32 v5, 0
    v_mov_b32 v6, 0
    v_mov_b32 v7, 0
    v_mov_b32 v8, 0
    v_mov_b32 v9, 0
    v_mov_b32 v10, 0
    v_mov_b32 v11, 0
    v_mov_b32 v12, 0
    v_mov_b32 v13, 0
    v_mov_b32 v14, 0
    v_mov_b32 v15, 0
    v_mov_b32 v16, 0
    v_mov_b32 v17, 0
    v_mov_b32 v18, 0
    v_mov_b32 v19, 0
    v_mov_b32 v20, 0
    v_mov_b32 v21, 0
    v_mov_b32 v22, 0
    v_mov_b32 v23, 0
    v_mov_b32 v24, 0
    v_mov_b32 v25, 0
    v_mov_b32 v26, 0
    v_mov_b32 v27, 0
    v_mov_b32 v28, 0
    v_mov_b32 v29, 0
    v_mov_b32 v30, 0
    v_mov_b32 v31, 0
    v_mov_b32 v32, 0
    v_mov_b32 v33, 0
    v_mov_b32 v34, 0
    v_mov_b32 v35, 0
    v_mov_b32 v36, 0
    v_mov_b32 v37, 0
    v_mov_b32 v38, 0
    v_mov_b32 v39, 0
    v_mov_b32 v40, 0
    v_mov_b32 v41, 0
    v_mov_b32 v42, 0
    v_mov_b32 v43, 0
    v_mov_b32 v44, 0
    v_mov_b32 v45, 0
    v_mov_b32 v46, 0
    v_mov_b32 v47, 0
    v_mov_b32 v48, 0
    v_mov_b32 v49, 0
    v_mov_b32 v50, 0
    v_mov_b32 v51, 0
    v_mov_b32 v52, 0
    v_mov_b32 v53, 0
    v_mov_b32 v54, 0
    v_mov_b32 v55, 0
    v_mov_b32 v56, 0
    v_mov_b32 v57, 0
    v_mov_b32 v58, 0
    v_mov_b32 v59, 0
    v_mov_b32 v60, 0
    v_mov_b32 v61, 0
    v_mov_b32 v62, 0
    v_mov_b32 v63, 0
    v_mov_b32 v80, 0
    v_mov_b32 v81, 0
    v_mov_b32 v82, 0
    v_mov_b32 v83, 0
    v_mov_b32 v84, 0
    v_mov_b32 v85, 0
    v_mov_b32 v86, 0
    v_mov_b32 v87, 0
    v_mov_b32 v112, 0
    v_mov_b32 v113, 0
    v_mov_b32 v114, 0
    v_mov_b32 v115, 0
    v_mov_b32 v116, 0
    v_mov_b32 v117, 0
    v_mov_b32 v118, 0
    v_mov_b32 v119, 0
    v_mov_b32 v88, 0
    v_mov_b32 v89, 0
    v_mov_b32 v90, 0
    v_mov_b32 v91, 0
    v_mov_b32 v92, 0
    v_mov_b32 v93, 0
    v_mov_b32 v94, 0
    v_mov_b32 v95, 0
    v_mov_b32 v120, 0
    v_mov_b32 v121, 0
    v_mov_b32 v122, 0
    v_mov_b32 v123, 0
    v_mov_b32 v124, 0
    v_mov_b32 v125, 0
    v_mov_b32 v126, 0
    v_mov_b32 v127, 0
    s_mov_b32 s38, 0xbdd2d3e8
    s_mov_b32 s39, 0xbdd2d3e8
    s_mov_b32 s62, 1.0
    s_mov_b32 s63, 1.0
    s_add_u32 s20, s40, 48300032
    s_addc_u32 s21, s41, 0
    s_and_b32 s21, s21, 0xffff
    s_mov_b32 s22, 262144
    s_mov_b32 s23, 0x00020000
    s_add_u32 s44, s40, 49283072
    s_addc_u32 s45, s41, 0
    s_and_b32 s45, s45, 0xffff
    s_mov_b32 s46, 14336
    s_mov_b32 s47, 0x00020000
l3_kernel_loop_16:
    s_waitcnt lgkmcnt(0)
    s_barrier
    ds_read_b128 v[64:67], v128 offset:0
    ds_read_b128 v[68:71], v128 offset:4096
    ds_read_b64_tr_b16 v[96:97], v140 offset:0
    ds_read_b64_tr_b16 v[98:99], v140 offset:1024
    ds_read_b64_tr_b16 v[100:101], v141 offset:0
    ds_read_b64_tr_b16 v[102:103], v141 offset:1024
    v_mfma_f32_32x32x16_bf16 v[0:15], v[112:115], v[80:83], v[0:15]
    v_mfma_f32_32x32x16_bf16 v[16:31], v[112:115], v[84:87], v[16:31]
    v_mfma_f32_32x32x16_bf16 v[32:47], v[116:119], v[80:83], v[32:47]
    v_mfma_f32_32x32x16_bf16 v[48:63], v[116:119], v[84:87], v[48:63]
    ds_read_b128 v[72:75], v129 offset:0
    ds_read_b128 v[76:79], v129 offset:4096
    ds_read_b64_tr_b16 v[104:105], v140 offset:4096
    ds_read_b64_tr_b16 v[106:107], v140 offset:5120
    ds_read_b64_tr_b16 v[108:109], v141 offset:4096
    ds_read_b64_tr_b16 v[110:111], v141 offset:5120
    v_mfma_f32_32x32x16_bf16 v[0:15], v[120:123], v[88:91], v[0:15]
    v_mfma_f32_32x32x16_bf16 v[16:31], v[120:123], v[92:95], v[16:31]
    v_mfma_f32_32x32x16_bf16 v[32:47], v[124:127], v[88:91], v[32:47]
    v_mfma_f32_32x32x16_bf16 v[48:63], v[124:127], v[92:95], v[48:63]
    ds_read_b128 v[80:83], v130 offset:0
    ds_read_b128 v[84:87], v130 offset:4096
    ds_read_b64_tr_b16 v[112:113], v140 offset:8192
    ds_read_b64_tr_b16 v[114:115], v140 offset:9216
    ds_read_b64_tr_b16 v[116:117], v141 offset:8192
    ds_read_b64_tr_b16 v[118:119], v141 offset:9216
    s_waitcnt lgkmcnt(12)
    v_mfma_f32_32x32x16_bf16 v[0:15], v[96:99], v[64:67], v[0:15]
    v_mfma_f32_32x32x16_bf16 v[16:31], v[96:99], v[68:71], v[16:31]
    v_mfma_f32_32x32x16_bf16 v[32:47], v[100:103], v[64:67], v[32:47]
    v_mfma_f32_32x32x16_bf16 v[48:63], v[100:103], v[68:71], v[48:63]
    ds_read_b128 v[88:91], v131 offset:0
    ds_read_b128 v[92:95], v131 offset:4096
    ds_read_b64_tr_b16 v[120:121], v140 offset:12288
    ds_read_b64_tr_b16 v[122:123], v140 offset:13312
    ds_read_b64_tr_b16 v[124:125], v141 offset:12288
    ds_read_b64_tr_b16 v[126:127], v141 offset:13312
    s_waitcnt lgkmcnt(12)
    v_mfma_f32_32x32x16_bf16 v[0:15], v[104:107], v[72:75], v[0:15]
    v_mfma_f32_32x32x16_bf16 v[16:31], v[104:107], v[76:79], v[16:31]
    v_mfma_f32_32x32x16_bf16 v[32:47], v[108:111], v[72:75], v[32:47]
    v_mfma_f32_32x32x16_bf16 v[48:63], v[108:111], v[76:79], v[48:63]
    s_sub_u32 s33, s33, 1
    s_cmp_eq_u32 s33, 0
    s_cbranch_scc1 l3_kernel_exit_17
    s_waitcnt lgkmcnt(0)
    s_barrier
    ds_read_b128 v[64:67], v132 offset:0
    ds_read_b128 v[68:71], v132 offset:4096
    ds_read_b64_tr_b16 v[96:97], v142 offset:0
    ds_read_b64_tr_b16 v[98:99], v142 offset:1024
    ds_read_b64_tr_b16 v[100:101], v143 offset:0
    ds_read_b64_tr_b16 v[102:103], v143 offset:1024
    v_mfma_f32_32x32x16_bf16 v[0:15], v[112:115], v[80:83], v[0:15]
    v_mfma_f32_32x32x16_bf16 v[16:31], v[112:115], v[84:87], v[16:31]
    v_mfma_f32_32x32x16_bf16 v[32:47], v[116:119], v[80:83], v[32:47]
    v_mfma_f32_32x32x16_bf16 v[48:63], v[116:119], v[84:87], v[48:63]
    ds_read_b128 v[72:75], v133 offset:0
    ds_read_b128 v[76:79], v133 offset:4096
    ds_read_b64_tr_b16 v[104:105], v142 offset:4096
    ds_read_b64_tr_b16 v[106:107], v142 offset:5120
    ds_read_b64_tr_b16 v[108:109], v143 offset:4096
    ds_read_b64_tr_b16 v[110:111], v143 offset:5120
    v_mfma_f32_32x32x16_bf16 v[0:15], v[120:123], v[88:91], v[0:15]
    v_mfma_f32_32x32x16_bf16 v[16:31], v[120:123], v[92:95], v[16:31]
    v_mfma_f32_32x32x16_bf16 v[32:47], v[124:127], v[88:91], v[32:47]
    v_mfma_f32_32x32x16_bf16 v[48:63], v[124:127], v[92:95], v[48:63]
    ds_read_b128 v[80:83], v134 offset:0
    ds_read_b128 v[84:87], v134 offset:4096
    ds_read_b64_tr_b16 v[112:113], v142 offset:8192
    ds_read_b64_tr_b16 v[114:115], v142 offset:9216
    ds_read_b64_tr_b16 v[116:117], v143 offset:8192
    ds_read_b64_tr_b16 v[118:119], v143 offset:9216
    s_waitcnt lgkmcnt(12)
    v_mfma_f32_32x32x16_bf16 v[0:15], v[96:99], v[64:67], v[0:15]
    v_mfma_f32_32x32x16_bf16 v[16:31], v[96:99], v[68:71], v[16:31]
    v_mfma_f32_32x32x16_bf16 v[32:47], v[100:103], v[64:67], v[32:47]
    v_mfma_f32_32x32x16_bf16 v[48:63], v[100:103], v[68:71], v[48:63]
    ds_read_b128 v[88:91], v135 offset:0
    ds_read_b128 v[92:95], v135 offset:4096
    ds_read_b64_tr_b16 v[120:121], v142 offset:12288
    ds_read_b64_tr_b16 v[122:123], v142 offset:13312
    ds_read_b64_tr_b16 v[124:125], v143 offset:12288
    ds_read_b64_tr_b16 v[126:127], v143 offset:13312
    s_waitcnt lgkmcnt(12)
    v_mfma_f32_32x32x16_bf16 v[0:15], v[104:107], v[72:75], v[0:15]
    v_mfma_f32_32x32x16_bf16 v[16:31], v[104:107], v[76:79], v[16:31]
    v_mfma_f32_32x32x16_bf16 v[32:47], v[108:111], v[72:75], v[32:47]
    v_mfma_f32_32x32x16_bf16 v[48:63], v[108:111], v[76:79], v[48:63]
    s_sub_u32 s33, s33, 1
    s_cmp_eq_u32 s33, 0
    s_cbranch_scc1 l3_kernel_exit_17
    s_waitcnt lgkmcnt(0)
    s_barrier
    ds_read_b128 v[64:67], v136 offset:0
    ds_read_b128 v[68:71], v136 offset:4096
    ds_read_b64_tr_b16 v[96:97], v144 offset:0
    ds_read_b64_tr_b16 v[98:99], v144 offset:1024
    ds_read_b64_tr_b16 v[100:101], v145 offset:0
    ds_read_b64_tr_b16 v[102:103], v145 offset:1024
    v_mfma_f32_32x32x16_bf16 v[0:15], v[112:115], v[80:83], v[0:15]
    v_mfma_f32_32x32x16_bf16 v[16:31], v[112:115], v[84:87], v[16:31]
    v_mfma_f32_32x32x16_bf16 v[32:47], v[116:119], v[80:83], v[32:47]
    v_mfma_f32_32x32x16_bf16 v[48:63], v[116:119], v[84:87], v[48:63]
    ds_read_b128 v[72:75], v137 offset:0
    ds_read_b128 v[76:79], v137 offset:4096
    ds_read_b64_tr_b16 v[104:105], v144 offset:4096
    ds_read_b64_tr_b16 v[106:107], v144 offset:5120
    ds_read_b64_tr_b16 v[108:109], v145 offset:4096
    ds_read_b64_tr_b16 v[110:111], v145 offset:5120
    v_mfma_f32_32x32x16_bf16 v[0:15], v[120:123], v[88:91], v[0:15]
    v_mfma_f32_32x32x16_bf16 v[16:31], v[120:123], v[92:95], v[16:31]
    v_mfma_f32_32x32x16_bf16 v[32:47], v[124:127], v[88:91], v[32:47]
    v_mfma_f32_32x32x16_bf16 v[48:63], v[124:127], v[92:95], v[48:63]
    ds_read_b128 v[80:83], v138 offset:0
    ds_read_b128 v[84:87], v138 offset:4096
    ds_read_b64_tr_b16 v[112:113], v144 offset:8192
    ds_read_b64_tr_b16 v[114:115], v144 offset:9216
    ds_read_b64_tr_b16 v[116:117], v145 offset:8192
    ds_read_b64_tr_b16 v[118:119], v145 offset:9216
    s_waitcnt lgkmcnt(12)
    v_mfma_f32_32x32x16_bf16 v[0:15], v[96:99], v[64:67], v[0:15]
    v_mfma_f32_32x32x16_bf16 v[16:31], v[96:99], v[68:71], v[16:31]
    v_mfma_f32_32x32x16_bf16 v[32:47], v[100:103], v[64:67], v[32:47]
    v_mfma_f32_32x32x16_bf16 v[48:63], v[100:103], v[68:71], v[48:63]
    ds_read_b128 v[88:91], v139 offset:0
    ds_read_b128 v[92:95], v139 offset:4096
    ds_read_b64_tr_b16 v[120:121], v144 offset:12288
    ds_read_b64_tr_b16 v[122:123], v144 offset:13312
    ds_read_b64_tr_b16 v[124:125], v145 offset:12288
    ds_read_b64_tr_b16 v[126:127], v145 offset:13312
    s_waitcnt lgkmcnt(12)
    v_mfma_f32_32x32x16_bf16 v[0:15], v[104:107], v[72:75], v[0:15]
    v_mfma_f32_32x32x16_bf16 v[16:31], v[104:107], v[76:79], v[16:31]
    v_mfma_f32_32x32x16_bf16 v[32:47], v[108:111], v[72:75], v[32:47]
    v_mfma_f32_32x32x16_bf16 v[48:63], v[108:111], v[76:79], v[48:63]
    s_sub_u32 s33, s33, 1
    s_cmp_eq_u32 s33, 0
    s_cbranch_scc0 l3_kernel_loop_16
l3_kernel_exit_17:
    s_waitcnt lgkmcnt(6)
    v_mfma_f32_32x32x16_bf16 v[0:15], v[112:115], v[80:83], v[0:15]
    v_mfma_f32_32x32x16_bf16 v[16:31], v[112:115], v[84:87], v[16:31]
    v_mfma_f32_32x32x16_bf16 v[32:47], v[116:119], v[80:83], v[32:47]
    v_mfma_f32_32x32x16_bf16 v[48:63], v[116:119], v[84:87], v[48:63]
    s_waitcnt lgkmcnt(0)
    v_mfma_f32_32x32x16_bf16 v[0:15], v[120:123], v[88:91], v[0:15]
    v_mfma_f32_32x32x16_bf16 v[16:31], v[120:123], v[92:95], v[16:31]
    v_mfma_f32_32x32x16_bf16 v[32:47], v[124:127], v[88:91], v[32:47]
    v_mfma_f32_32x32x16_bf16 v[48:63], v[124:127], v[92:95], v[48:63]
    s_barrier
    v_and_b32 v64, 63, v146
    v_and_b32 v65, 31, v64
    v_lshrrev_b32 v66, 5, v64
    s_mul_i32 s36, s24, 8192
    v_lshlrev_b32 v68, 7, v65
    v_add_u32 v68, s36, v68
    v_and_b32 v69, 7, v65
    v_lshrrev_b32 v70, 3, v64
    v_and_b32 v71, 7, v64
    v_lshlrev_b32 v80, 7, v70
    v_lshl_add_u32 v80, v71, 4, v80
    v_add_u32 v80, s36, v80
    s_mul_i32 s29, s34, 256
    s_mul_i32 s30, s25, 64
    s_add_u32 s29, s29, s30
    s_mov_b32 s53, s29
    v_add_u32 v67, s29, v70
    s_mov_b32 s30, 7168
    v_mul_lo_u32 v67, v67, s30
    v_xor_b32 v71, v71, v70
    v_lshlrev_b32 v71, 4, v71
    s_mul_i32 s54, s35, 128
    s_mul_i32 s30, s26, 64
    s_add_u32 s54, s54, s30
    s_lshl_b32 s29, s54, 1
    v_add3_u32 v67, v67, v71, s29
    v_add_u32 v81, 0, v66
    v_xor_b32 v81, v81, v69
    v_lshl_add_u32 v81, v81, 4, v68
    v_add_u32 v82, 2, v66
    v_xor_b32 v82, v82, v69
    v_lshl_add_u32 v82, v82, 4, v68
    v_add_u32 v83, 4, v66
    v_xor_b32 v83, v83, v69
    v_lshl_add_u32 v83, v83, 4, v68
    v_add_u32 v84, 6, v66
    v_xor_b32 v84, v84, v69
    v_lshl_add_u32 v84, v84, 4, v68
    v_lshlrev_b32 v124, 4, v66
    s_lshl_b32 s29, s54, 2
    v_add_u32 v124, s29, v124
    buffer_load_dwordx4 v[88:91], v124, s[44:47], 0 offen offset:0
    buffer_load_dwordx4 v[92:95], v124, s[44:47], 0 offen offset:32
    buffer_load_dwordx4 v[96:99], v124, s[44:47], 0 offen offset:64
    buffer_load_dwordx4 v[100:103], v124, s[44:47], 0 offen offset:96
    buffer_load_dwordx4 v[104:107], v124, s[44:47], 0 offen offset:128
    buffer_load_dwordx4 v[108:111], v124, s[44:47], 0 offen offset:160
    buffer_load_dwordx4 v[112:115], v124, s[44:47], 0 offen offset:192
    buffer_load_dwordx4 v[116:119], v124, s[44:47], 0 offen offset:224
    v_add_u32 v125, s53, v65
    v_lshlrev_b32 v125, 7, v125
    buffer_load_dwordx4 v[128:131], v125, s[20:23], 0 offen offset:0
    buffer_load_dwordx4 v[132:135], v125, s[20:23], 0 offen offset:16
    buffer_load_dwordx4 v[136:139], v125, s[20:23], 0 offen offset:32
    buffer_load_dwordx4 v[140:143], v125, s[20:23], 0 offen offset:48
    buffer_load_dwordx4 v[144:147], v125, s[20:23], 0 offen offset:64
    buffer_load_dwordx4 v[148:151], v125, s[20:23], 0 offen offset:80
    buffer_load_dwordx4 v[152:155], v125, s[20:23], 0 offen offset:96
    buffer_load_dwordx4 v[156:159], v125, s[20:23], 0 offen offset:112
    s_waitcnt vmcnt(0)
    v_add_f32 v120, v128, v130
    v_add_f32 v122, v129, v131
    v_add_f32 v120, v120, v132
    v_add_f32 v122, v122, v133
    v_add_f32 v120, v120, v134
    v_add_f32 v122, v122, v135
    v_add_f32 v120, v120, v136
    v_add_f32 v122, v122, v137
    v_add_f32 v120, v120, v138
    v_add_f32 v122, v122, v139
    v_add_f32 v120, v120, v140
    v_add_f32 v122, v122, v141
    v_add_f32 v120, v120, v142
    v_add_f32 v122, v122, v143
    v_add_f32 v120, v120, v144
    v_add_f32 v122, v122, v145
    v_add_f32 v120, v120, v146
    v_add_f32 v122, v122, v147
    v_add_f32 v120, v120, v148
    v_add_f32 v122, v122, v149
    v_add_f32 v120, v120, v150
    v_add_f32 v122, v122, v151
    v_add_f32 v120, v120, v152
    v_add_f32 v122, v122, v153
    v_add_f32 v120, v120, v154
    v_add_f32 v122, v122, v155
    v_add_f32 v120, v120, v156
    v_add_f32 v122, v122, v157
    v_add_f32 v120, v120, v158
    v_add_f32 v122, v122, v159
    v_mul_f32 v120, 0x3a800000, v120
    v_mul_f32 v122, 0x3a800000, v122
    v_fma_f32 v122, -v120, v120, v122
    v_max_f32 v122, 0, v122
    v_cvt_pk_bf16_f32 v126, v120, v122
    v_lshlrev_b32 v120, 16, v126
    v_and_b32 v122, 0xffff0000, v126
    v_add_f32 v122, 0x3727c5ac, v122
    v_cvt_pk_bf16_f32 v126, v122, v122
    v_lshlrev_b32 v122, 16, v126
    v_sqrt_f32 v122, v122
    s_nop 0
    v_cvt_pk_bf16_f32 v126, v122, v122
    v_lshlrev_b32 v122, 16, v126
    v_rcp_f32 v122, v122
    v_mov_b32 v160, v120
    v_mov_b32 v161, v120
    v_mov_b32 v164, v122
    v_mov_b32 v165, v122
    v_add_u32 v125, 4096, v125
    buffer_load_dwordx4 v[128:131], v125, s[20:23], 0 offen offset:0
    buffer_load_dwordx4 v[132:135], v125, s[20:23], 0 offen offset:16
    buffer_load_dwordx4 v[136:139], v125, s[20:23], 0 offen offset:32
    buffer_load_dwordx4 v[140:143], v125, s[20:23], 0 offen offset:48
    buffer_load_dwordx4 v[144:147], v125, s[20:23], 0 offen offset:64
    buffer_load_dwordx4 v[148:151], v125, s[20:23], 0 offen offset:80
    buffer_load_dwordx4 v[152:155], v125, s[20:23], 0 offen offset:96
    buffer_load_dwordx4 v[156:159], v125, s[20:23], 0 offen offset:112
    s_waitcnt vmcnt(0)
    v_add_f32 v121, v128, v130
    v_add_f32 v123, v129, v131
    v_add_f32 v121, v121, v132
    v_add_f32 v123, v123, v133
    v_add_f32 v121, v121, v134
    v_add_f32 v123, v123, v135
    v_add_f32 v121, v121, v136
    v_add_f32 v123, v123, v137
    v_add_f32 v121, v121, v138
    v_add_f32 v123, v123, v139
    v_add_f32 v121, v121, v140
    v_add_f32 v123, v123, v141
    v_add_f32 v121, v121, v142
    v_add_f32 v123, v123, v143
    v_add_f32 v121, v121, v144
    v_add_f32 v123, v123, v145
    v_add_f32 v121, v121, v146
    v_add_f32 v123, v123, v147
    v_add_f32 v121, v121, v148
    v_add_f32 v123, v123, v149
    v_add_f32 v121, v121, v150
    v_add_f32 v123, v123, v151
    v_add_f32 v121, v121, v152
    v_add_f32 v123, v123, v153
    v_add_f32 v121, v121, v154
    v_add_f32 v123, v123, v155
    v_add_f32 v121, v121, v156
    v_add_f32 v123, v123, v157
    v_add_f32 v121, v121, v158
    v_add_f32 v123, v123, v159
    v_mul_f32 v121, 0x3a800000, v121
    v_mul_f32 v123, 0x3a800000, v123
    v_fma_f32 v123, -v121, v121, v123
    v_max_f32 v123, 0, v123
    v_cvt_pk_bf16_f32 v126, v121, v123
    v_lshlrev_b32 v121, 16, v126
    v_and_b32 v123, 0xffff0000, v126
    v_add_f32 v123, 0x3727c5ac, v123
    v_cvt_pk_bf16_f32 v126, v123, v123
    v_lshlrev_b32 v123, 16, v126
    v_sqrt_f32 v123, v123
    s_nop 0
    v_cvt_pk_bf16_f32 v126, v123, v123
    v_lshlrev_b32 v123, 16, v126
    v_rcp_f32 v123, v123
    v_mov_b32 v162, v121
    v_mov_b32 v163, v121
    v_mov_b32 v166, v123
    v_mov_b32 v167, v123
    v_pk_fma_f32 v[0:1], v[160:161], v[88:89], v[0:1] neg_lo:[1,0,0] neg_hi:[1,0,0]
    v_pk_fma_f32 v[2:3], v[160:161], v[90:91], v[2:3] neg_lo:[1,0,0] neg_hi:[1,0,0]
    v_pk_fma_f32 v[4:5], v[160:161], v[92:93], v[4:5] neg_lo:[1,0,0] neg_hi:[1,0,0]
    v_pk_fma_f32 v[6:7], v[160:161], v[94:95], v[6:7] neg_lo:[1,0,0] neg_hi:[1,0,0]
    v_pk_fma_f32 v[8:9], v[160:161], v[96:97], v[8:9] neg_lo:[1,0,0] neg_hi:[1,0,0]
    v_pk_fma_f32 v[10:11], v[160:161], v[98:99], v[10:11] neg_lo:[1,0,0] neg_hi:[1,0,0]
    v_pk_fma_f32 v[12:13], v[160:161], v[100:101], v[12:13] neg_lo:[1,0,0] neg_hi:[1,0,0]
    v_pk_fma_f32 v[14:15], v[160:161], v[102:103], v[14:15] neg_lo:[1,0,0] neg_hi:[1,0,0]
    v_pk_mul_f32 v[0:1], v[0:1], v[164:165]
    v_pk_mul_f32 v[2:3], v[2:3], v[164:165]
    v_pk_mul_f32 v[4:5], v[4:5], v[164:165]
    v_pk_mul_f32 v[6:7], v[6:7], v[164:165]
    v_pk_mul_f32 v[8:9], v[8:9], v[164:165]
    v_pk_mul_f32 v[10:11], v[10:11], v[164:165]
    v_pk_mul_f32 v[12:13], v[12:13], v[164:165]
    v_pk_mul_f32 v[14:15], v[14:15], v[164:165]
    v_mov_b32 v136, 0xc0135761
    v_mov_b32 v137, 0xc0135761
    v_pk_mul_f32 v[128:129], v[0:1], v[0:1]
    v_pk_mul_f32 v[130:131], v[2:3], v[2:3]
    v_pk_mul_f32 v[132:133], v[4:5], v[4:5]
    v_pk_mul_f32 v[134:135], v[6:7], v[6:7]
    v_pk_fma_f32 v[128:129], v[128:129], s[38:39], v[136:137]
    v_pk_fma_f32 v[130:131], v[130:131], s[38:39], v[136:137]
    v_pk_fma_f32 v[132:133], v[132:133], s[38:39], v[136:137]
    v_pk_fma_f32 v[134:135], v[134:135], s[38:39], v[136:137]
    v_pk_mul_f32 v[128:129], v[128:129], v[0:1]
    v_pk_mul_f32 v[130:131], v[130:131], v[2:3]
    v_pk_mul_f32 v[132:133], v[132:133], v[4:5]
    v_pk_mul_f32 v[134:135], v[134:135], v[6:7]
    v_exp_f32 v128, v128
    v_exp_f32 v129, v129
    v_exp_f32 v130, v130
    v_exp_f32 v131, v131
    v_exp_f32 v132, v132
    v_exp_f32 v133, v133
    v_exp_f32 v134, v134
    v_exp_f32 v135, v135
    v_pk_add_f32 v[128:129], v[128:129], s[62:63]
    v_pk_add_f32 v[130:131], v[130:131], s[62:63]
    v_pk_add_f32 v[132:133], v[132:133], s[62:63]
    v_pk_add_f32 v[134:135], v[134:135], s[62:63]
    v_rcp_f32 v128, v128
    v_rcp_f32 v129, v129
    v_rcp_f32 v130, v130
    v_rcp_f32 v131, v131
    v_rcp_f32 v132, v132
    v_rcp_f32 v133, v133
    v_rcp_f32 v134, v134
    v_rcp_f32 v135, v135
    v_pk_mul_f32 v[0:1], v[0:1], v[128:129]
    v_pk_mul_f32 v[2:3], v[2:3], v[130:131]
    v_pk_mul_f32 v[4:5], v[4:5], v[132:133]
    v_pk_mul_f32 v[6:7], v[6:7], v[134:135]
    v_pk_mul_f32 v[128:129], v[8:9], v[8:9]
    v_pk_mul_f32 v[130:131], v[10:11], v[10:11]
    v_pk_mul_f32 v[132:133], v[12:13], v[12:13]
    v_pk_mul_f32 v[134:135], v[14:15], v[14:15]
    v_pk_fma_f32 v[128:129], v[128:129], s[38:39], v[136:137]
    v_pk_fma_f32 v[130:131], v[130:131], s[38:39], v[136:137]
    v_pk_fma_f32 v[132:133], v[132:133], s[38:39], v[136:137]
    v_pk_fma_f32 v[134:135], v[134:135], s[38:39], v[136:137]
    v_pk_mul_f32 v[128:129], v[128:129], v[8:9]
    v_pk_mul_f32 v[130:131], v[130:131], v[10:11]
    v_pk_mul_f32 v[132:133], v[132:133], v[12:13]
    v_pk_mul_f32 v[134:135], v[134:135], v[14:15]
    v_exp_f32 v128, v128
    v_exp_f32 v129, v129
    v_exp_f32 v130, v130
    v_exp_f32 v131, v131
    v_exp_f32 v132, v132
    v_exp_f32 v133, v133
    v_exp_f32 v134, v134
    v_exp_f32 v135, v135
    v_pk_add_f32 v[128:129], v[128:129], s[62:63]
    v_pk_add_f32 v[130:131], v[130:131], s[62:63]
    v_pk_add_f32 v[132:133], v[132:133], s[62:63]
    v_pk_add_f32 v[134:135], v[134:135], s[62:63]
    v_rcp_f32 v128, v128
    v_rcp_f32 v129, v129
    v_rcp_f32 v130, v130
    v_rcp_f32 v131, v131
    v_rcp_f32 v132, v132
    v_rcp_f32 v133, v133
    v_rcp_f32 v134, v134
    v_rcp_f32 v135, v135
    v_pk_mul_f32 v[8:9], v[8:9], v[128:129]
    v_pk_mul_f32 v[10:11], v[10:11], v[130:131]
    v_pk_mul_f32 v[12:13], v[12:13], v[132:133]
    v_pk_mul_f32 v[14:15], v[14:15], v[134:135]
    v_cvt_pk_bf16_f32 v72, v0, v1
    v_cvt_pk_bf16_f32 v73, v2, v3
    v_cvt_pk_bf16_f32 v74, v4, v5
    v_cvt_pk_bf16_f32 v75, v6, v7
    v_cvt_pk_bf16_f32 v76, v8, v9
    v_cvt_pk_bf16_f32 v77, v10, v11
    v_cvt_pk_bf16_f32 v78, v12, v13
    v_cvt_pk_bf16_f32 v79, v14, v15
    v_permlane32_swap_b32 v72, v74
    v_permlane32_swap_b32 v73, v75
    v_permlane32_swap_b32 v76, v78
    v_permlane32_swap_b32 v77, v79
    ds_write_b128 v81, v[72:75] offset:0
    ds_write_b128 v82, v[76:79] offset:0
    v_pk_fma_f32 v[32:33], v[160:161], v[104:105], v[32:33] neg_lo:[1,0,0] neg_hi:[1,0,0]
    v_pk_fma_f32 v[34:35], v[160:161], v[106:107], v[34:35] neg_lo:[1,0,0] neg_hi:[1,0,0]
    v_pk_fma_f32 v[36:37], v[160:161], v[108:109], v[36:37] neg_lo:[1,0,0] neg_hi:[1,0,0]
    v_pk_fma_f32 v[38:39], v[160:161], v[110:111], v[38:39] neg_lo:[1,0,0] neg_hi:[1,0,0]
    v_pk_fma_f32 v[40:41], v[160:161], v[112:113], v[40:41] neg_lo:[1,0,0] neg_hi:[1,0,0]
    v_pk_fma_f32 v[42:43], v[160:161], v[114:115], v[42:43] neg_lo:[1,0,0] neg_hi:[1,0,0]
    v_pk_fma_f32 v[44:45], v[160:161], v[116:117], v[44:45] neg_lo:[1,0,0] neg_hi:[1,0,0]
    v_pk_fma_f32 v[46:47], v[160:161], v[118:119], v[46:47] neg_lo:[1,0,0] neg_hi:[1,0,0]
    v_pk_mul_f32 v[32:33], v[32:33], v[164:165]
    v_pk_mul_f32 v[34:35], v[34:35], v[164:165]
    v_pk_mul_f32 v[36:37], v[36:37], v[164:165]
    v_pk_mul_f32 v[38:39], v[38:39], v[164:165]
    v_pk_mul_f32 v[40:41], v[40:41], v[164:165]
    v_pk_mul_f32 v[42:43], v[42:43], v[164:165]
    v_pk_mul_f32 v[44:45], v[44:45], v[164:165]
    v_pk_mul_f32 v[46:47], v[46:47], v[164:165]
    v_mov_b32 v136, 0xc0135761
    v_mov_b32 v137, 0xc0135761
    v_pk_mul_f32 v[128:129], v[32:33], v[32:33]
    v_pk_mul_f32 v[130:131], v[34:35], v[34:35]
    v_pk_mul_f32 v[132:133], v[36:37], v[36:37]
    v_pk_mul_f32 v[134:135], v[38:39], v[38:39]
    v_pk_fma_f32 v[128:129], v[128:129], s[38:39], v[136:137]
    v_pk_fma_f32 v[130:131], v[130:131], s[38:39], v[136:137]
    v_pk_fma_f32 v[132:133], v[132:133], s[38:39], v[136:137]
    v_pk_fma_f32 v[134:135], v[134:135], s[38:39], v[136:137]
    v_pk_mul_f32 v[128:129], v[128:129], v[32:33]
    v_pk_mul_f32 v[130:131], v[130:131], v[34:35]
    v_pk_mul_f32 v[132:133], v[132:133], v[36:37]
    v_pk_mul_f32 v[134:135], v[134:135], v[38:39]
    v_exp_f32 v128, v128
    v_exp_f32 v129, v129
    v_exp_f32 v130, v130
    v_exp_f32 v131, v131
    v_exp_f32 v132, v132
    v_exp_f32 v133, v133
    v_exp_f32 v134, v134
    v_exp_f32 v135, v135
    v_pk_add_f32 v[128:129], v[128:129], s[62:63]
    v_pk_add_f32 v[130:131], v[130:131], s[62:63]
    v_pk_add_f32 v[132:133], v[132:133], s[62:63]
    v_pk_add_f32 v[134:135], v[134:135], s[62:63]
    v_rcp_f32 v128, v128
    v_rcp_f32 v129, v129
    v_rcp_f32 v130, v130
    v_rcp_f32 v131, v131
    v_rcp_f32 v132, v132
    v_rcp_f32 v133, v133
    v_rcp_f32 v134, v134
    v_rcp_f32 v135, v135
    v_pk_mul_f32 v[32:33], v[32:33], v[128:129]
    v_pk_mul_f32 v[34:35], v[34:35], v[130:131]
    v_pk_mul_f32 v[36:37], v[36:37], v[132:133]
    v_pk_mul_f32 v[38:39], v[38:39], v[134:135]
    v_pk_mul_f32 v[128:129], v[40:41], v[40:41]
    v_pk_mul_f32 v[130:131], v[42:43], v[42:43]
    v_pk_mul_f32 v[132:133], v[44:45], v[44:45]
    v_pk_mul_f32 v[134:135], v[46:47], v[46:47]
    v_pk_fma_f32 v[128:129], v[128:129], s[38:39], v[136:137]
    v_pk_fma_f32 v[130:131], v[130:131], s[38:39], v[136:137]
    v_pk_fma_f32 v[132:133], v[132:133], s[38:39], v[136:137]
    v_pk_fma_f32 v[134:135], v[134:135], s[38:39], v[136:137]
    v_pk_mul_f32 v[128:129], v[128:129], v[40:41]
    v_pk_mul_f32 v[130:131], v[130:131], v[42:43]
    v_pk_mul_f32 v[132:133], v[132:133], v[44:45]
    v_pk_mul_f32 v[134:135], v[134:135], v[46:47]
    v_exp_f32 v128, v128
    v_exp_f32 v129, v129
    v_exp_f32 v130, v130
    v_exp_f32 v131, v131
    v_exp_f32 v132, v132
    v_exp_f32 v133, v133
    v_exp_f32 v134, v134
    v_exp_f32 v135, v135
    v_pk_add_f32 v[128:129], v[128:129], s[62:63]
    v_pk_add_f32 v[130:131], v[130:131], s[62:63]
    v_pk_add_f32 v[132:133], v[132:133], s[62:63]
    v_pk_add_f32 v[134:135], v[134:135], s[62:63]
    v_rcp_f32 v128, v128
    v_rcp_f32 v129, v129
    v_rcp_f32 v130, v130
    v_rcp_f32 v131, v131
    v_rcp_f32 v132, v132
    v_rcp_f32 v133, v133
    v_rcp_f32 v134, v134
    v_rcp_f32 v135, v135
    v_pk_mul_f32 v[40:41], v[40:41], v[128:129]
    v_pk_mul_f32 v[42:43], v[42:43], v[130:131]
    v_pk_mul_f32 v[44:45], v[44:45], v[132:133]
    v_pk_mul_f32 v[46:47], v[46:47], v[134:135]
    v_cvt_pk_bf16_f32 v72, v32, v33
    v_cvt_pk_bf16_f32 v73, v34, v35
    v_cvt_pk_bf16_f32 v74, v36, v37
    v_cvt_pk_bf16_f32 v75, v38, v39
    v_cvt_pk_bf16_f32 v76, v40, v41
    v_cvt_pk_bf16_f32 v77, v42, v43
    v_cvt_pk_bf16_f32 v78, v44, v45
    v_cvt_pk_bf16_f32 v79, v46, v47
    v_permlane32_swap_b32 v72, v74
    v_permlane32_swap_b32 v73, v75
    v_permlane32_swap_b32 v76, v78
    v_permlane32_swap_b32 v77, v79
    ds_write_b128 v83, v[72:75] offset:0
    ds_write_b128 v84, v[76:79] offset:0
    v_pk_fma_f32 v[16:17], v[162:163], v[88:89], v[16:17] neg_lo:[1,0,0] neg_hi:[1,0,0]
    v_pk_fma_f32 v[18:19], v[162:163], v[90:91], v[18:19] neg_lo:[1,0,0] neg_hi:[1,0,0]
    v_pk_fma_f32 v[20:21], v[162:163], v[92:93], v[20:21] neg_lo:[1,0,0] neg_hi:[1,0,0]
    v_pk_fma_f32 v[22:23], v[162:163], v[94:95], v[22:23] neg_lo:[1,0,0] neg_hi:[1,0,0]
    v_pk_fma_f32 v[24:25], v[162:163], v[96:97], v[24:25] neg_lo:[1,0,0] neg_hi:[1,0,0]
    v_pk_fma_f32 v[26:27], v[162:163], v[98:99], v[26:27] neg_lo:[1,0,0] neg_hi:[1,0,0]
    v_pk_fma_f32 v[28:29], v[162:163], v[100:101], v[28:29] neg_lo:[1,0,0] neg_hi:[1,0,0]
    v_pk_fma_f32 v[30:31], v[162:163], v[102:103], v[30:31] neg_lo:[1,0,0] neg_hi:[1,0,0]
    v_pk_mul_f32 v[16:17], v[16:17], v[166:167]
    v_pk_mul_f32 v[18:19], v[18:19], v[166:167]
    v_pk_mul_f32 v[20:21], v[20:21], v[166:167]
    v_pk_mul_f32 v[22:23], v[22:23], v[166:167]
    v_pk_mul_f32 v[24:25], v[24:25], v[166:167]
    v_pk_mul_f32 v[26:27], v[26:27], v[166:167]
    v_pk_mul_f32 v[28:29], v[28:29], v[166:167]
    v_pk_mul_f32 v[30:31], v[30:31], v[166:167]
    v_mov_b32 v136, 0xc0135761
    v_mov_b32 v137, 0xc0135761
    v_pk_mul_f32 v[128:129], v[16:17], v[16:17]
    v_pk_mul_f32 v[130:131], v[18:19], v[18:19]
    v_pk_mul_f32 v[132:133], v[20:21], v[20:21]
    v_pk_mul_f32 v[134:135], v[22:23], v[22:23]
    v_pk_fma_f32 v[128:129], v[128:129], s[38:39], v[136:137]
    v_pk_fma_f32 v[130:131], v[130:131], s[38:39], v[136:137]
    v_pk_fma_f32 v[132:133], v[132:133], s[38:39], v[136:137]
    v_pk_fma_f32 v[134:135], v[134:135], s[38:39], v[136:137]
    v_pk_mul_f32 v[128:129], v[128:129], v[16:17]
    v_pk_mul_f32 v[130:131], v[130:131], v[18:19]
    v_pk_mul_f32 v[132:133], v[132:133], v[20:21]
    v_pk_mul_f32 v[134:135], v[134:135], v[22:23]
    v_exp_f32 v128, v128
    v_exp_f32 v129, v129
    v_exp_f32 v130, v130
    v_exp_f32 v131, v131
    v_exp_f32 v132, v132
    v_exp_f32 v133, v133
    v_exp_f32 v134, v134
    v_exp_f32 v135, v135
    v_pk_add_f32 v[128:129], v[128:129], s[62:63]
    v_pk_add_f32 v[130:131], v[130:131], s[62:63]
    v_pk_add_f32 v[132:133], v[132:133], s[62:63]
    v_pk_add_f32 v[134:135], v[134:135], s[62:63]
    v_rcp_f32 v128, v128
    v_rcp_f32 v129, v129
    v_rcp_f32 v130, v130
    v_rcp_f32 v131, v131
    v_rcp_f32 v132, v132
    v_rcp_f32 v133, v133
    v_rcp_f32 v134, v134
    v_rcp_f32 v135, v135
    v_pk_mul_f32 v[16:17], v[16:17], v[128:129]
    v_pk_mul_f32 v[18:19], v[18:19], v[130:131]
    v_pk_mul_f32 v[20:21], v[20:21], v[132:133]
    v_pk_mul_f32 v[22:23], v[22:23], v[134:135]
    v_pk_mul_f32 v[128:129], v[24:25], v[24:25]
    v_pk_mul_f32 v[130:131], v[26:27], v[26:27]
    v_pk_mul_f32 v[132:133], v[28:29], v[28:29]
    v_pk_mul_f32 v[134:135], v[30:31], v[30:31]
    v_pk_fma_f32 v[128:129], v[128:129], s[38:39], v[136:137]
    v_pk_fma_f32 v[130:131], v[130:131], s[38:39], v[136:137]
    v_pk_fma_f32 v[132:133], v[132:133], s[38:39], v[136:137]
    v_pk_fma_f32 v[134:135], v[134:135], s[38:39], v[136:137]
    v_pk_mul_f32 v[128:129], v[128:129], v[24:25]
    v_pk_mul_f32 v[130:131], v[130:131], v[26:27]
    v_pk_mul_f32 v[132:133], v[132:133], v[28:29]
    v_pk_mul_f32 v[134:135], v[134:135], v[30:31]
    v_exp_f32 v128, v128
    v_exp_f32 v129, v129
    v_exp_f32 v130, v130
    v_exp_f32 v131, v131
    v_exp_f32 v132, v132
    v_exp_f32 v133, v133
    v_exp_f32 v134, v134
    v_exp_f32 v135, v135
    v_pk_add_f32 v[128:129], v[128:129], s[62:63]
    v_pk_add_f32 v[130:131], v[130:131], s[62:63]
    v_pk_add_f32 v[132:133], v[132:133], s[62:63]
    v_pk_add_f32 v[134:135], v[134:135], s[62:63]
    v_rcp_f32 v128, v128
    v_rcp_f32 v129, v129
    v_rcp_f32 v130, v130
    v_rcp_f32 v131, v131
    v_rcp_f32 v132, v132
    v_rcp_f32 v133, v133
    v_rcp_f32 v134, v134
    v_rcp_f32 v135, v135
    v_pk_mul_f32 v[24:25], v[24:25], v[128:129]
    v_pk_mul_f32 v[26:27], v[26:27], v[130:131]
    v_pk_mul_f32 v[28:29], v[28:29], v[132:133]
    v_pk_mul_f32 v[30:31], v[30:31], v[134:135]
    v_cvt_pk_bf16_f32 v72, v16, v17
    v_cvt_pk_bf16_f32 v73, v18, v19
    v_cvt_pk_bf16_f32 v74, v20, v21
    v_cvt_pk_bf16_f32 v75, v22, v23
    v_cvt_pk_bf16_f32 v76, v24, v25
    v_cvt_pk_bf16_f32 v77, v26, v27
    v_cvt_pk_bf16_f32 v78, v28, v29
    v_cvt_pk_bf16_f32 v79, v30, v31
    v_permlane32_swap_b32 v72, v74
    v_permlane32_swap_b32 v73, v75
    v_permlane32_swap_b32 v76, v78
    v_permlane32_swap_b32 v77, v79
    ds_write_b128 v81, v[72:75] offset:4096
    ds_write_b128 v82, v[76:79] offset:4096
    v_pk_fma_f32 v[48:49], v[162:163], v[104:105], v[48:49] neg_lo:[1,0,0] neg_hi:[1,0,0]
    v_pk_fma_f32 v[50:51], v[162:163], v[106:107], v[50:51] neg_lo:[1,0,0] neg_hi:[1,0,0]
    v_pk_fma_f32 v[52:53], v[162:163], v[108:109], v[52:53] neg_lo:[1,0,0] neg_hi:[1,0,0]
    v_pk_fma_f32 v[54:55], v[162:163], v[110:111], v[54:55] neg_lo:[1,0,0] neg_hi:[1,0,0]
    v_pk_fma_f32 v[56:57], v[162:163], v[112:113], v[56:57] neg_lo:[1,0,0] neg_hi:[1,0,0]
    v_pk_fma_f32 v[58:59], v[162:163], v[114:115], v[58:59] neg_lo:[1,0,0] neg_hi:[1,0,0]
    v_pk_fma_f32 v[60:61], v[162:163], v[116:117], v[60:61] neg_lo:[1,0,0] neg_hi:[1,0,0]
    v_pk_fma_f32 v[62:63], v[162:163], v[118:119], v[62:63] neg_lo:[1,0,0] neg_hi:[1,0,0]
    v_pk_mul_f32 v[48:49], v[48:49], v[166:167]
    v_pk_mul_f32 v[50:51], v[50:51], v[166:167]
    v_pk_mul_f32 v[52:53], v[52:53], v[166:167]
    v_pk_mul_f32 v[54:55], v[54:55], v[166:167]
    v_pk_mul_f32 v[56:57], v[56:57], v[166:167]
    v_pk_mul_f32 v[58:59], v[58:59], v[166:167]
    v_pk_mul_f32 v[60:61], v[60:61], v[166:167]
    v_pk_mul_f32 v[62:63], v[62:63], v[166:167]
    v_mov_b32 v136, 0xc0135761
    v_mov_b32 v137, 0xc0135761
    v_pk_mul_f32 v[128:129], v[48:49], v[48:49]
    v_pk_mul_f32 v[130:131], v[50:51], v[50:51]
    v_pk_mul_f32 v[132:133], v[52:53], v[52:53]
    v_pk_mul_f32 v[134:135], v[54:55], v[54:55]
    v_pk_fma_f32 v[128:129], v[128:129], s[38:39], v[136:137]
    v_pk_fma_f32 v[130:131], v[130:131], s[38:39], v[136:137]
    v_pk_fma_f32 v[132:133], v[132:133], s[38:39], v[136:137]
    v_pk_fma_f32 v[134:135], v[134:135], s[38:39], v[136:137]
    v_pk_mul_f32 v[128:129], v[128:129], v[48:49]
    v_pk_mul_f32 v[130:131], v[130:131], v[50:51]
    v_pk_mul_f32 v[132:133], v[132:133], v[52:53]
    v_pk_mul_f32 v[134:135], v[134:135], v[54:55]
    v_exp_f32 v128, v128
    v_exp_f32 v129, v129
    v_exp_f32 v130, v130
    v_exp_f32 v131, v131
    v_exp_f32 v132, v132
    v_exp_f32 v133, v133
    v_exp_f32 v134, v134
    v_exp_f32 v135, v135
    v_pk_add_f32 v[128:129], v[128:129], s[62:63]
    v_pk_add_f32 v[130:131], v[130:131], s[62:63]
    v_pk_add_f32 v[132:133], v[132:133], s[62:63]
    v_pk_add_f32 v[134:135], v[134:135], s[62:63]
    v_rcp_f32 v128, v128
    v_rcp_f32 v129, v129
    v_rcp_f32 v130, v130
    v_rcp_f32 v131, v131
    v_rcp_f32 v132, v132
    v_rcp_f32 v133, v133
    v_rcp_f32 v134, v134
    v_rcp_f32 v135, v135
    v_pk_mul_f32 v[48:49], v[48:49], v[128:129]
    v_pk_mul_f32 v[50:51], v[50:51], v[130:131]
    v_pk_mul_f32 v[52:53], v[52:53], v[132:133]
    v_pk_mul_f32 v[54:55], v[54:55], v[134:135]
    v_pk_mul_f32 v[128:129], v[56:57], v[56:57]
    v_pk_mul_f32 v[130:131], v[58:59], v[58:59]
    v_pk_mul_f32 v[132:133], v[60:61], v[60:61]
    v_pk_mul_f32 v[134:135], v[62:63], v[62:63]
    v_pk_fma_f32 v[128:129], v[128:129], s[38:39], v[136:137]
    v_pk_fma_f32 v[130:131], v[130:131], s[38:39], v[136:137]
    v_pk_fma_f32 v[132:133], v[132:133], s[38:39], v[136:137]
    v_pk_fma_f32 v[134:135], v[134:135], s[38:39], v[136:137]
    v_pk_mul_f32 v[128:129], v[128:129], v[56:57]
    v_pk_mul_f32 v[130:131], v[130:131], v[58:59]
    v_pk_mul_f32 v[132:133], v[132:133], v[60:61]
    v_pk_mul_f32 v[134:135], v[134:135], v[62:63]
    v_exp_f32 v128, v128
    v_exp_f32 v129, v129
    v_exp_f32 v130, v130
    v_exp_f32 v131, v131
    v_exp_f32 v132, v132
    v_exp_f32 v133, v133
    v_exp_f32 v134, v134
    v_exp_f32 v135, v135
    v_pk_add_f32 v[128:129], v[128:129], s[62:63]
    v_pk_add_f32 v[130:131], v[130:131], s[62:63]
    v_pk_add_f32 v[132:133], v[132:133], s[62:63]
    v_pk_add_f32 v[134:135], v[134:135], s[62:63]
    v_rcp_f32 v128, v128
    v_rcp_f32 v129, v129
    v_rcp_f32 v130, v130
    v_rcp_f32 v131, v131
    v_rcp_f32 v132, v132
    v_rcp_f32 v133, v133
    v_rcp_f32 v134, v134
    v_rcp_f32 v135, v135
    v_pk_mul_f32 v[56:57], v[56:57], v[128:129]
    v_pk_mul_f32 v[58:59], v[58:59], v[130:131]
    v_pk_mul_f32 v[60:61], v[60:61], v[132:133]
    v_pk_mul_f32 v[62:63], v[62:63], v[134:135]
    v_cvt_pk_bf16_f32 v72, v48, v49
    v_cvt_pk_bf16_f32 v73, v50, v51
    v_cvt_pk_bf16_f32 v74, v52, v53
    v_cvt_pk_bf16_f32 v75, v54, v55
    v_cvt_pk_bf16_f32 v76, v56, v57
    v_cvt_pk_bf16_f32 v77, v58, v59
    v_cvt_pk_bf16_f32 v78, v60, v61
    v_cvt_pk_bf16_f32 v79, v62, v63
    v_permlane32_swap_b32 v72, v74
    v_permlane32_swap_b32 v73, v75
    v_permlane32_swap_b32 v76, v78
    v_permlane32_swap_b32 v77, v79
    ds_write_b128 v83, v[72:75] offset:4096
    ds_write_b128 v84, v[76:79] offset:4096
    s_waitcnt lgkmcnt(0)
    ds_read_b128 v[0:3], v80 offset:0
    ds_read_b128 v[4:7], v80 offset:1024
    ds_read_b128 v[8:11], v80 offset:2048
    ds_read_b128 v[12:15], v80 offset:3072
    ds_read_b128 v[16:19], v80 offset:4096
    ds_read_b128 v[20:23], v80 offset:5120
    ds_read_b128 v[24:27], v80 offset:6144
    ds_read_b128 v[28:31], v80 offset:7168
    s_waitcnt lgkmcnt(7)
    buffer_store_dwordx4 v[0:3], v67, s[16:19], 0 offen
    v_add_u32 v67, 57344, v67
    s_waitcnt lgkmcnt(6)
    buffer_store_dwordx4 v[4:7], v67, s[16:19], 0 offen
    v_add_u32 v67, 57344, v67
    s_waitcnt lgkmcnt(5)
    buffer_store_dwordx4 v[8:11], v67, s[16:19], 0 offen
    v_add_u32 v67, 57344, v67
    s_waitcnt lgkmcnt(4)
    buffer_store_dwordx4 v[12:15], v67, s[16:19], 0 offen
    v_add_u32 v67, 57344, v67
    s_waitcnt lgkmcnt(3)
    buffer_store_dwordx4 v[16:19], v67, s[16:19], 0 offen
    v_add_u32 v67, 57344, v67
    s_waitcnt lgkmcnt(2)
    buffer_store_dwordx4 v[20:23], v67, s[16:19], 0 offen
    v_add_u32 v67, 57344, v67
    s_waitcnt lgkmcnt(1)
    buffer_store_dwordx4 v[24:27], v67, s[16:19], 0 offen
    v_add_u32 v67, 57344, v67
    s_waitcnt lgkmcnt(0)
    buffer_store_dwordx4 v[28:31], v67, s[16:19], 0 offen
    s_endpgm
l3_kernel_pf_2:
    s_sub_u32 s52, s2, 224
    s_load_dwordx2 s[6:7], s[0:1], 64
    s_waitcnt lgkmcnt(0)
    s_mov_b32 s12, s6
    s_mov_b32 s13, s7
    s_and_b32 s13, s13, 0xffff
    s_mov_b32 s14, 7340032
    s_mov_b32 s15, 0x00020000
    s_mul_i32 s29, s52, 229376
    v_lshlrev_b32 v1, 4, v0
    buffer_load_dwordx4 v[4:7], v1, s[12:15], s29 offen
    s_add_u32 s29, s29, 12288
    buffer_load_dwordx4 v[8:11], v1, s[12:15], s29 offen
    s_add_u32 s29, s29, 12288
    buffer_load_dwordx4 v[12:15], v1, s[12:15], s29 offen
    s_add_u32 s29, s29, 12288
    buffer_load_dwordx4 v[16:19], v1, s[12:15], s29 offen
    s_add_u32 s29, s29, 12288
    buffer_load_dwordx4 v[20:23], v1, s[12:15], s29 offen
    s_add_u32 s29, s29, 12288
    buffer_load_dwordx4 v[24:27], v1, s[12:15], s29 offen
    s_add_u32 s29, s29, 12288
    buffer_load_dwordx4 v[28:31], v1, s[12:15], s29 offen
    s_add_u32 s29, s29, 12288
    buffer_load_dwordx4 v[32:35], v1, s[12:15], s29 offen
    s_add_u32 s29, s29, 12288
    s_waitcnt vmcnt(4)
    buffer_load_dwordx4 v[4:7], v1, s[12:15], s29 offen
    s_add_u32 s29, s29, 12288
    buffer_load_dwordx4 v[8:11], v1, s[12:15], s29 offen
    s_add_u32 s29, s29, 12288
    buffer_load_dwordx4 v[12:15], v1, s[12:15], s29 offen
    s_add_u32 s29, s29, 12288
    buffer_load_dwordx4 v[16:19], v1, s[12:15], s29 offen
    s_add_u32 s29, s29, 12288
    buffer_load_dwordx4 v[20:23], v1, s[12:15], s29 offen
    s_add_u32 s29, s29, 12288
    buffer_load_dwordx4 v[24:27], v1, s[12:15], s29 offen
    s_add_u32 s29, s29, 12288
    buffer_load_dwordx4 v[28:31], v1, s[12:15], s29 offen
    s_add_u32 s29, s29, 12288
    buffer_load_dwordx4 v[32:35], v1, s[12:15], s29 offen
    s_add_u32 s29, s29, 12288
    s_waitcnt vmcnt(4)
    buffer_load_dwordx4 v[4:7], v1, s[12:15], s29 offen
    s_add_u32 s29, s29, 12288
    buffer_load_dwordx4 v[8:11], v1, s[12:15], s29 offen
    s_add_u32 s29, s29, 12288
    buffer_load_dwordx4 v[12:15], v1, s[12:15], s29 offen
    s_add_u32 s29, s29, 12288
    s_waitcnt vmcnt(0)
    s_load_dwordx2 s[6:7], s[0:1], 24
    s_waitcnt lgkmcnt(0)
    s_mov_b32 s12, s6
    s_mov_b32 s13, s7
    s_and_b32 s13, s13, 0xffff
    s_mov_b32 s14, 2097152
    s_mov_b32 s15, 0x00020000
    s_mul_i32 s29, s52, 65536
    v_lshlrev_b32 v1, 4, v0
    buffer_load_dwordx4 v[4:7], v1, s[12:15], s29 offen
    s_add_u32 s29, s29, 12288
    buffer_load_dwordx4 v[8:11], v1, s[12:15], s29 offen
    s_add_u32 s29, s29, 12288
    buffer_load_dwordx4 v[12:15], v1, s[12:15], s29 offen
    s_add_u32 s29, s29, 12288
    buffer_load_dwordx4 v[16:19], v1, s[12:15], s29 offen
    s_add_u32 s29, s29, 12288
    buffer_load_dwordx4 v[20:23], v1, s[12:15], s29 offen
    s_add_u32 s29, s29, 12288
    buffer_load_dwordx4 v[24:27], v1, s[12:15], s29 offen
    s_add_u32 s29, s29, 12288
    s_waitcnt vmcnt(0)
l3_kernel_end_1:
    s_endpgm
.text
.globl l4_kernel
.p2align 8
.type l4_kernel,@function
l4_kernel:
    s_cmp_ge_u32 s2, 256
    s_cbranch_scc1 l4_kernel_end_1
    s_and_b32 s70, s2, 7
    s_lshr_b32 s71, s2, 3
    s_lshr_b32 s55, s71, 4
    s_and_b32 s29, s71, 15
    s_lshr_b32 s34, s70, 1
    s_lshl_b32 s34, s34, 2
    s_lshr_b32 s30, s29, 2
    s_add_u32 s34, s34, s30
    s_and_b32 s35, s70, 1
    s_lshl_b32 s35, s35, 2
    s_and_b32 s30, s29, 3
    s_add_u32 s35, s35, s30
    s_lshl_b32 s62, s34, 3
    s_add_u32 s62, s62, s35
    s_load_dwordx2 s[40:41], s[0:1], 96
    s_load_dwordx2 s[4:5], s[0:1], 24
    s_load_dwordx2 s[6:7], s[0:1], 64
    s_load_dwordx2 s[58:59], s[0:1], 80
    s_waitcnt lgkmcnt(0)
    s_mov_b32 s16, s58
    s_mov_b32 s17, s59
    s_and_b32 s17, s17, 0xffff
    s_mov_b32 s18, 4194304
    s_mov_b32 s19, 0x00020000
    v_mov_b32 v80, v0
    v_lshrrev_b32 v84, 6, v0
    s_nop 0
    v_readfirstlane_b32 s24, v84
    s_cmp_lg_u32 s55, 0
    s_cbranch_scc1 l4_kernel_h1_2
    s_add_u32 s8, s40, 42991616
    s_addc_u32 s9, s41, 0
    s_and_b32 s9, s9, 0xffff
    s_mov_b32 s10, 4194304
    s_mov_b32 s11, 0x00020000
    s_mov_b32 s12, s4
    s_mov_b32 s13, s5
    s_and_b32 s13, s13, 0xffff
    s_mov_b32 s14, 2097152
    s_mov_b32 s15, 0x00020000
    s_mov_b32 s31, 0
    s_mov_b32 s32, 0
    s_mov_b32 s33, 16
    s_cmp_lt_u32 s24, 8
    s_cbranch_scc1 l4_kernel_comp_3
    s_cmp_lt_u32 s24, 12
    s_cbranch_scc1 l4_kernel_lok_4
    s_endpgm
l4_kernel_lok_4:
    s_sub_u32 s24, s24, 8
    v_and_b32 v4, 63, v0
    s_mul_i32 s27, s24, 4096
    s_mul_i32 s28, s24, 4096
    s_add_u32 s28, s28, 16384
    v_lshrrev_b32 v6, 3, v4
    v_lshrrev_b32 v7, 4, v4
    v_and_b32 v8, 7, v4
    s_mul_i32 s29, s34, 128
    s_mul_i32 s30, s24, 32
    s_add_u32 s29, s29, s30
    s_mov_b32 s30, 2048
    v_add_u32 v9, s29, v6
    v_mul_lo_u32 v9, v9, s30
    v_xor_b32 v10, v7, v8
    v_lshlrev_b32 v10, 4, v10
    v_add_u32 v12, v9, v10
    v_add_u32 v9, s29, v6
    v_add_u32 v9, 8, v9
    v_mul_lo_u32 v9, v9, s30
    v_or_b32 v10, 4, v7
    v_xor_b32 v10, v10, v8
    v_lshlrev_b32 v10, 4, v10
    v_add_u32 v13, v9, v10
    v_add_u32 v9, s29, v6
    v_add_u32 v9, 16, v9
    v_mul_lo_u32 v9, v9, s30
    v_xor_b32 v10, v7, v8
    v_lshlrev_b32 v10, 4, v10
    v_add_u32 v14, v9, v10
    v_add_u32 v9, s29, v6
    v_add_u32 v9, 24, v9
    v_mul_lo_u32 v9, v9, s30
    v_or_b32 v10, 4, v7
    v_xor_b32 v10, v10, v8
    v_lshlrev_b32 v10, 4, v10
    v_add_u32 v15, v9, v10
    v_lshrrev_b32 v6, 4, v4
    v_and_b32 v8, 15, v4
    v_lshlrev_b32 v7, 2, v6
    v_xor_b32 v8, v8, v7
    v_lshlrev_b32 v8, 4, v8
    s_mul_i32 s30, s35, 256
    s_mul_i32 s29, s24, 16
    v_add_u32 v8, s30, v8
    s_mov_b32 s30, 2048
    v_add_u32 v9, s29, v6
    v_mul_lo_u32 v9, v9, s30
    v_add_u32 v16, v9, v8
    v_add_u32 v9, s29, v6
    v_add_u32 v9, 4, v9
    v_mul_lo_u32 v9, v9, s30
    v_add_u32 v17, v9, v8
    v_add_u32 v9, s29, v6
    v_add_u32 v9, 8, v9
    v_mul_lo_u32 v9, v9, s30
    v_add_u32 v18, v9, v8
    v_add_u32 v9, s29, v6
    v_add_u32 v9, 12, v9
    v_mul_lo_u32 v9, v9, s30
    v_add_u32 v19, v9, v8
    s_add_u32 m0, s27, 0
    s_nop 0
    buffer_load_dwordx4 v12, s[8:11], s31 offen lds
    s_add_u32 m0, s27, 1024
    s_nop 0
    buffer_load_dwordx4 v13, s[8:11], s31 offen lds
    s_add_u32 m0, s27, 2048
    s_nop 0
    buffer_load_dwordx4 v14, s[8:11], s31 offen lds
    s_add_u32 m0, s27, 3072
    s_nop 0
    buffer_load_dwordx4 v15, s[8:11], s31 offen lds
    s_add_u32 m0, s28, 0
    s_nop 0
    buffer_load_dwordx4 v16, s[12:15], s32 offen lds
    s_add_u32 m0, s28, 1024
    s_nop 0
    buffer_load_dwordx4 v17, s[12:15], s32 offen lds
    s_add_u32 m0, s28, 2048
    s_nop 0
    buffer_load_dwordx4 v18, s[12:15], s32 offen lds
    s_add_u32 m0, s28, 3072
    s_nop 0
    buffer_load_dwordx4 v19, s[12:15], s32 offen lds
    s_add_u32 s31, s31, 128
    s_add_u32 s32, s32, 131072
    s_add_u32 m0, s27, 32768
    s_nop 0
    buffer_load_dwordx4 v12, s[8:11], s31 offen lds
    s_add_u32 m0, s27, 33792
    s_nop 0
    buffer_load_dwordx4 v13, s[8:11], s31 offen lds
    s_add_u32 m0, s27, 34816
    s_nop 0
    buffer_load_dwordx4 v14, s[8:11], s31 offen lds
    s_add_u32 m0, s27, 35840
    s_nop 0
    buffer_load_dwordx4 v15, s[8:11], s31 offen lds
    s_add_u32 m0, s28, 32768
    s_nop 0
    buffer_load_dwordx4 v16, s[12:15], s32 offen lds
    s_add_u32 m0, s28, 33792
    s_nop 0
    buffer_load_dwordx4 v17, s[12:15], s32 offen lds
    s_add_u32 m0, s28, 34816
    s_nop 0
    buffer_load_dwordx4 v18, s[12:15], s32 offen lds
    s_add_u32 m0, s28, 35840
    s_nop 0
    buffer_load_dwordx4 v19, s[12:15], s32 offen lds
    s_add_u32 s31, s31, 128
    s_add_u32 s32, s32, 131072
    s_add_u32 m0, s27, 65536
    s_nop 0
    buffer_load_dwordx4 v12, s[8:11], s31 offen lds
    s_add_u32 m0, s27, 66560
    s_nop 0
    buffer_load_dwordx4 v13, s[8:11], s31 offen lds
    s_add_u32 m0, s27, 67584
    s_nop 0
    buffer_load_dwordx4 v14, s[8:11], s31 offen lds
    s_add_u32 m0, s27, 68608
    s_nop 0
    buffer_load_dwordx4 v15, s[8:11], s31 offen lds
    s_add_u32 m0, s28, 65536
    s_nop 0
    buffer_load_dwordx4 v16, s[12:15], s32 offen lds
    s_add_u32 m0, s28, 66560
    s_nop 0
    buffer_load_dwordx4 v17, s[12:15], s32 offen lds
    s_add_u32 m0, s28, 67584
    s_nop 0
    buffer_load_dwordx4 v18, s[12:15], s32 offen lds
    s_add_u32 m0, s28, 68608
    s_nop 0
    buffer_load_dwordx4 v19, s[12:15], s32 offen lds
    s_add_u32 s31, s31, 128
    s_add_u32 s32, s32, 131072
l4_kernel_lloop_5:
    s_cmp_lt_u32 s33, 3
    s_cbranch_scc1 l4_kernel_w0_7
    s_waitcnt vmcnt(16)
    s_branch l4_kernel_w1_8
l4_kernel_w0_7:
    s_waitcnt vmcnt(0)
l4_kernel_w1_8:
    s_barrier
    s_cmp_le_u32 s33, 3
    s_cbranch_scc1 l4_kernel_nd_9
    s_add_u32 m0, s27, 98304
    s_nop 0
    buffer_load_dwordx4 v12, s[8:11], s31 offen lds
    s_add_u32 m0, s27, 99328
    s_nop 0
    buffer_load_dwordx4 v13, s[8:11], s31 offen lds
    s_add_u32 m0, s27, 100352
    s_nop 0
    buffer_load_dwordx4 v14, s[8:11], s31 offen lds
    s_add_u32 m0, s27, 101376
    s_nop 0
    buffer_load_dwordx4 v15, s[8:11], s31 offen lds
    s_add_u32 m0, s28, 98304
    s_nop 0
    buffer_load_dwordx4 v16, s[12:15], s32 offen lds
    s_add_u32 m0, s28, 99328
    s_nop 0
    buffer_load_dwordx4 v17, s[12:15], s32 offen lds
    s_add_u32 m0, s28, 100352
    s_nop 0
    buffer_load_dwordx4 v18, s[12:15], s32 offen lds
    s_add_u32 m0, s28, 101376
    s_nop 0
    buffer_load_dwordx4 v19, s[12:15], s32 offen lds
    s_add_u32 s31, s31, 128
    s_add_u32 s32, s32, 131072
l4_kernel_nd_9:
    s_sub_u32 s33, s33, 1
    s_cmp_eq_u32 s33, 0
    s_cbranch_scc1 l4_kernel_ldone_6
    s_cmp_lt_u32 s33, 3
    s_cbranch_scc1 l4_kernel_w0_10
    s_waitcnt vmcnt(16)
    s_branch l4_kernel_w1_11
l4_kernel_w0_10:
    s_waitcnt vmcnt(0)
l4_kernel_w1_11:
    s_barrier
    s_cmp_le_u32 s33, 3
    s_cbranch_scc1 l4_kernel_nd_12
    s_add_u32 m0, s27, 0
    s_nop 0
    buffer_load_dwordx4 v12, s[8:11], s31 offen lds
    s_add_u32 m0, s27, 1024
    s_nop 0
    buffer_load_dwordx4 v13, s[8:11], s31 offen lds
    s_add_u32 m0, s27, 2048
    s_nop 0
    buffer_load_dwordx4 v14, s[8:11], s31 offen lds
    s_add_u32 m0, s27, 3072
    s_nop 0
    buffer_load_dwordx4 v15, s[8:11], s31 offen lds
    s_add_u32 m0, s28, 0
    s_nop 0
    buffer_load_dwordx4 v16, s[12:15], s32 offen lds
    s_add_u32 m0, s28, 1024
    s_nop 0
    buffer_load_dwordx4 v17, s[12:15], s32 offen lds
    s_add_u32 m0, s28, 2048
    s_nop 0
    buffer_load_dwordx4 v18, s[12:15], s32 offen lds
    s_add_u32 m0, s28, 3072
    s_nop 0
    buffer_load_dwordx4 v19, s[12:15], s32 offen lds
    s_add_u32 s31, s31, 128
    s_add_u32 s32, s32, 131072
l4_kernel_nd_12:
    s_sub_u32 s33, s33, 1
    s_cmp_eq_u32 s33, 0
    s_cbranch_scc1 l4_kernel_ldone_6
    s_cmp_lt_u32 s33, 3
    s_cbranch_scc1 l4_kernel_w0_13
    s_waitcnt vmcnt(16)
    s_branch l4_kernel_w1_14
l4_kernel_w0_13:
    s_waitcnt vmcnt(0)
l4_kernel_w1_14:
    s_barrier
    s_cmp_le_u32 s33, 3
    s_cbranch_scc1 l4_kernel_nd_15
    s_add_u32 m0, s27, 32768
    s_nop 0
    buffer_load_dwordx4 v12, s[8:11], s31 offen lds
    s_add_u32 m0, s27, 33792
    s_nop 0
    buffer_load_dwordx4 v13, s[8:11], s31 offen lds
    s_add_u32 m0, s27, 34816
    s_nop 0
    buffer_load_dwordx4 v14, s[8:11], s31 offen lds
    s_add_u32 m0, s27, 35840
    s_nop 0
    buffer_load_dwordx4 v15, s[8:11], s31 offen lds
    s_add_u32 m0, s28, 32768
    s_nop 0
    buffer_load_dwordx4 v16, s[12:15], s32 offen lds
    s_add_u32 m0, s28, 33792
    s_nop 0
    buffer_load_dwordx4 v17, s[12:15], s32 offen lds
    s_add_u32 m0, s28, 34816
    s_nop 0
    buffer_load_dwordx4 v18, s[12:15], s32 offen lds
    s_add_u32 m0, s28, 35840
    s_nop 0
    buffer_load_dwordx4 v19, s[12:15], s32 offen lds
    s_add_u32 s31, s31, 128
    s_add_u32 s32, s32, 131072
l4_kernel_nd_15:
    s_sub_u32 s33, s33, 1
    s_cmp_eq_u32 s33, 0
    s_cbranch_scc1 l4_kernel_ldone_6
    s_cmp_lt_u32 s33, 3
    s_cbranch_scc1 l4_kernel_w0_16
    s_waitcnt vmcnt(16)
    s_branch l4_kernel_w1_17
l4_kernel_w0_16:
    s_waitcnt vmcnt(0)
l4_kernel_w1_17:
    s_barrier
    s_cmp_le_u32 s33, 3
    s_cbranch_scc1 l4_kernel_nd_18
    s_add_u32 m0, s27, 65536
    s_nop 0
    buffer_load_dwordx4 v12, s[8:11], s31 offen lds
    s_add_u32 m0, s27, 66560
    s_nop 0
    buffer_load_dwordx4 v13, s[8:11], s31 offen lds
    s_add_u32 m0, s27, 67584
    s_nop 0
    buffer_load_dwordx4 v14, s[8:11], s31 offen lds
    s_add_u32 m0, s27, 68608
    s_nop 0
    buffer_load_dwordx4 v15, s[8:11], s31 offen lds
    s_add_u32 m0, s28, 65536
    s_nop 0
    buffer_load_dwordx4 v16, s[12:15], s32 offen lds
    s_add_u32 m0, s28, 66560
    s_nop 0
    buffer_load_dwordx4 v17, s[12:15], s32 offen lds
    s_add_u32 m0, s28, 67584
    s_nop 0
    buffer_load_dwordx4 v18, s[12:15], s32 offen lds
    s_add_u32 m0, s28, 68608
    s_nop 0
    buffer_load_dwordx4 v19, s[12:15], s32 offen lds
    s_add_u32 s31, s31, 128
    s_add_u32 s32, s32, 131072
l4_kernel_nd_18:
    s_sub_u32 s33, s33, 1
    s_cmp_eq_u32 s33, 0
    s_cbranch_scc0 l4_kernel_lloop_5
l4_kernel_ldone_6:
    s_barrier
    s_add_u32 s8, s40, 27262976
    s_addc_u32 s9, s41, 0
    s_and_b32 s9, s9, 0xffff
    s_mov_b32 s10, 14680064
    s_mov_b32 s11, 0x00020000
    s_mov_b32 s12, s6
    s_mov_b32 s13, s7
    s_and_b32 s13, s13, 0xffff
    s_mov_b32 s14, 7340032
    s_mov_b32 s15, 0x00020000
    s_mov_b32 s31, 0
    s_mov_b32 s32, 0
    s_mov_b32 s33, 19
    v_lshrrev_b32 v6, 3, v4
    v_lshrrev_b32 v7, 4, v4
    v_and_b32 v8, 7, v4
    s_mul_i32 s29, s34, 128
    s_mul_i32 s30, s24, 32
    s_add_u32 s29, s29, s30
    s_mov_b32 s30, 7168
    v_add_u32 v9, s29, v6
    v_mul_lo_u32 v9, v9, s30
    v_xor_b32 v10, v7, v8
    v_lshlrev_b32 v10, 4, v10
    v_add_u32 v12, v9, v10
    v_add_u32 v9, s29, v6
    v_add_u32 v9, 8, v9
    v_mul_lo_u32 v9, v9, s30
    v_or_b32 v10, 4, v7
    v_xor_b32 v10, v10, v8
    v_lshlrev_b32 v10, 4, v10
    v_add_u32 v13, v9, v10
    v_add_u32 v9, s29, v6
    v_add_u32 v9, 16, v9
    v_mul_lo_u32 v9, v9, s30
    v_xor_b32 v10, v7, v8
    v_lshlrev_b32 v10, 4, v10
    v_add_u32 v14, v9, v10
    v_add_u32 v9, s29, v6
    v_add_u32 v9, 24, v9
    v_mul_lo_u32 v9, v9, s30
    v_or_b32 v10, 4, v7
    v_xor_b32 v10, v10, v8
    v_lshlrev_b32 v10, 4, v10
    v_add_u32 v15, v9, v10
    v_lshrrev_b32 v6, 4, v4
    v_and_b32 v8, 15, v4
    v_lshlrev_b32 v7, 2, v6
    v_xor_b32 v8, v8, v7
    v_lshlrev_b32 v8, 4, v8
    s_mul_i32 s30, s35, 256
    s_mul_i32 s29, s24, 16
    v_add_u32 v8, s30, v8
    s_mov_b32 s30, 2048
    v_add_u32 v9, s29, v6
    v_mul_lo_u32 v9, v9, s30
    v_add_u32 v16, v9, v8
    v_add_u32 v9, s29, v6
    v_add_u32 v9, 4, v9
    v_mul_lo_u32 v9, v9, s30
    v_add_u32 v17, v9, v8
    v_add_u32 v9, s29, v6
    v_add_u32 v9, 8, v9
    v_mul_lo_u32 v9, v9, s30
    v_add_u32 v18, v9, v8
    v_add_u32 v9, s29, v6
    v_add_u32 v9, 12, v9
    v_mul_lo_u32 v9, v9, s30
    v_add_u32 v19, v9, v8
    s_add_u32 m0, s27, 0
    s_nop 0
    buffer_load_dwordx4 v12, s[8:11], s31 offen lds
    s_add_u32 m0, s27, 1024
    s_nop 0
    buffer_load_dwordx4 v13, s[8:11], s31 offen lds
    s_add_u32 m0, s27, 2048
    s_nop 0
    buffer_load_dwordx4 v14, s[8:11], s31 offen lds
    s_add_u32 m0, s27, 3072
    s_nop 0
    buffer_load_dwordx4 v15, s[8:11], s31 offen lds
    s_add_u32 m0, s28, 0
    s_nop 0
    buffer_load_dwordx4 v16, s[12:15], s32 offen lds
    s_add_u32 m0, s28, 1024
    s_nop 0
    buffer_load_dwordx4 v17, s[12:15], s32 offen lds
    s_add_u32 m0, s28, 2048
    s_nop 0
    buffer_load_dwordx4 v18, s[12:15], s32 offen lds
    s_add_u32 m0, s28, 3072
    s_nop 0
    buffer_load_dwordx4 v19, s[12:15], s32 offen lds
    s_add_u32 s31, s31, 128
    s_add_u32 s32, s32, 131072
    s_add_u32 m0, s27, 32768
    s_nop 0
    buffer_load_dwordx4 v12, s[8:11], s31 offen lds
    s_add_u32 m0, s27, 33792
    s_nop 0
    buffer_load_dwordx4 v13, s[8:11], s31 offen lds
    s_add_u32 m0, s27, 34816
    s_nop 0
    buffer_load_dwordx4 v14, s[8:11], s31 offen lds
    s_add_u32 m0, s27, 35840
    s_nop 0
    buffer_load_dwordx4 v15, s[8:11], s31 offen lds
    s_add_u32 m0, s28, 32768
    s_nop 0
    buffer_load_dwordx4 v16, s[12:15], s32 offen lds
    s_add_u32 m0, s28, 33792
    s_nop 0
    buffer_load_dwordx4 v17, s[12:15], s32 offen lds
    s_add_u32 m0, s28, 34816
    s_nop 0
    buffer_load_dwordx4 v18, s[12:15], s32 offen lds
    s_add_u32 m0, s28, 35840
    s_nop 0
    buffer_load_dwordx4 v19, s[12:15], s32 offen lds
    s_add_u32 s31, s31, 128
    s_add_u32 s32, s32, 131072
    s_add_u32 m0, s27, 65536
    s_nop 0
    buffer_load_dwordx4 v12, s[8:11], s31 offen lds
    s_add_u32 m0, s27, 66560
    s_nop 0
    buffer_load_dwordx4 v13, s[8:11], s31 offen lds
    s_add_u32 m0, s27, 67584
    s_nop 0
    buffer_load_dwordx4 v14, s[8:11], s31 offen lds
    s_add_u32 m0, s27, 68608
    s_nop 0
    buffer_load_dwordx4 v15, s[8:11], s31 offen lds
    s_add_u32 m0, s28, 65536
    s_nop 0
    buffer_load_dwordx4 v16, s[12:15], s32 offen lds
    s_add_u32 m0, s28, 66560
    s_nop 0
    buffer_load_dwordx4 v17, s[12:15], s32 offen lds
    s_add_u32 m0, s28, 67584
    s_nop 0
    buffer_load_dwordx4 v18, s[12:15], s32 offen lds
    s_add_u32 m0, s28, 68608
    s_nop 0
    buffer_load_dwordx4 v19, s[12:15], s32 offen lds
    s_add_u32 s31, s31, 128
    s_add_u32 s32, s32, 131072
l4_kernel_lloop_19:
    s_cmp_lt_u32 s33, 3
    s_cbranch_scc1 l4_kernel_w0_21
    s_waitcnt vmcnt(16)
    s_branch l4_kernel_w1_22
l4_kernel_w0_21:
    s_waitcnt vmcnt(0)
l4_kernel_w1_22:
    s_barrier
    s_cmp_le_u32 s33, 3
    s_cbranch_scc1 l4_kernel_nd_23
    s_add_u32 m0, s27, 98304
    s_nop 0
    buffer_load_dwordx4 v12, s[8:11], s31 offen lds
    s_add_u32 m0, s27, 99328
    s_nop 0
    buffer_load_dwordx4 v13, s[8:11], s31 offen lds
    s_add_u32 m0, s27, 100352
    s_nop 0
    buffer_load_dwordx4 v14, s[8:11], s31 offen lds
    s_add_u32 m0, s27, 101376
    s_nop 0
    buffer_load_dwordx4 v15, s[8:11], s31 offen lds
    s_add_u32 m0, s28, 98304
    s_nop 0
    buffer_load_dwordx4 v16, s[12:15], s32 offen lds
    s_add_u32 m0, s28, 99328
    s_nop 0
    buffer_load_dwordx4 v17, s[12:15], s32 offen lds
    s_add_u32 m0, s28, 100352
    s_nop 0
    buffer_load_dwordx4 v18, s[12:15], s32 offen lds
    s_add_u32 m0, s28, 101376
    s_nop 0
    buffer_load_dwordx4 v19, s[12:15], s32 offen lds
    s_add_u32 s31, s31, 128
    s_add_u32 s32, s32, 131072
l4_kernel_nd_23:
    s_sub_u32 s33, s33, 1
    s_cmp_eq_u32 s33, 0
    s_cbranch_scc1 l4_kernel_ldone_20
    s_cmp_lt_u32 s33, 3
    s_cbranch_scc1 l4_kernel_w0_24
    s_waitcnt vmcnt(16)
    s_branch l4_kernel_w1_25
l4_kernel_w0_24:
    s_waitcnt vmcnt(0)
l4_kernel_w1_25:
    s_barrier
    s_cmp_le_u32 s33, 3
    s_cbranch_scc1 l4_kernel_nd_26
    s_add_u32 m0, s27, 0
    s_nop 0
    buffer_load_dwordx4 v12, s[8:11], s31 offen lds
    s_add_u32 m0, s27, 1024
    s_nop 0
    buffer_load_dwordx4 v13, s[8:11], s31 offen lds
    s_add_u32 m0, s27, 2048
    s_nop 0
    buffer_load_dwordx4 v14, s[8:11], s31 offen lds
    s_add_u32 m0, s27, 3072
    s_nop 0
    buffer_load_dwordx4 v15, s[8:11], s31 offen lds
    s_add_u32 m0, s28, 0
    s_nop 0
    buffer_load_dwordx4 v16, s[12:15], s32 offen lds
    s_add_u32 m0, s28, 1024
    s_nop 0
    buffer_load_dwordx4 v17, s[12:15], s32 offen lds
    s_add_u32 m0, s28, 2048
    s_nop 0
    buffer_load_dwordx4 v18, s[12:15], s32 offen lds
    s_add_u32 m0, s28, 3072
    s_nop 0
    buffer_load_dwordx4 v19, s[12:15], s32 offen lds
    s_add_u32 s31, s31, 128
    s_add_u32 s32, s32, 131072
l4_kernel_nd_26:
    s_sub_u32 s33, s33, 1
    s_cmp_eq_u32 s33, 0
    s_cbranch_scc1 l4_kernel_ldone_20
    s_cmp_lt_u32 s33, 3
    s_cbranch_scc1 l4_kernel_w0_27
    s_waitcnt vmcnt(16)
    s_branch l4_kernel_w1_28
l4_kernel_w0_27:
    s_waitcnt vmcnt(0)
l4_kernel_w1_28:
    s_barrier
    s_cmp_le_u32 s33, 3
    s_cbranch_scc1 l4_kernel_nd_29
    s_add_u32 m0, s27, 32768
    s_nop 0
    buffer_load_dwordx4 v12, s[8:11], s31 offen lds
    s_add_u32 m0, s27, 33792
    s_nop 0
    buffer_load_dwordx4 v13, s[8:11], s31 offen lds
    s_add_u32 m0, s27, 34816
    s_nop 0
    buffer_load_dwordx4 v14, s[8:11], s31 offen lds
    s_add_u32 m0, s27, 35840
    s_nop 0
    buffer_load_dwordx4 v15, s[8:11], s31 offen lds
    s_add_u32 m0, s28, 32768
    s_nop 0
    buffer_load_dwordx4 v16, s[12:15], s32 offen lds
    s_add_u32 m0, s28, 33792
    s_nop 0
    buffer_load_dwordx4 v17, s[12:15], s32 offen lds
    s_add_u32 m0, s28, 34816
    s_nop 0
    buffer_load_dwordx4 v18, s[12:15], s32 offen lds
    s_add_u32 m0, s28, 35840
    s_nop 0
    buffer_load_dwordx4 v19, s[12:15], s32 offen lds
    s_add_u32 s31, s31, 128
    s_add_u32 s32, s32, 131072
l4_kernel_nd_29:
    s_sub_u32 s33, s33, 1
    s_cmp_eq_u32 s33, 0
    s_cbranch_scc1 l4_kernel_ldone_20
    s_cmp_lt_u32 s33, 3
    s_cbranch_scc1 l4_kernel_w0_30
    s_waitcnt vmcnt(16)
    s_branch l4_kernel_w1_31
l4_kernel_w0_30:
    s_waitcnt vmcnt(0)
l4_kernel_w1_31:
    s_barrier
    s_cmp_le_u32 s33, 3
    s_cbranch_scc1 l4_kernel_nd_32
    s_add_u32 m0, s27, 65536
    s_nop 0
    buffer_load_dwordx4 v12, s[8:11], s31 offen lds
    s_add_u32 m0, s27, 66560
    s_nop 0
    buffer_load_dwordx4 v13, s[8:11], s31 offen lds
    s_add_u32 m0, s27, 67584
    s_nop 0
    buffer_load_dwordx4 v14, s[8:11], s31 offen lds
    s_add_u32 m0, s27, 68608
    s_nop 0
    buffer_load_dwordx4 v15, s[8:11], s31 offen lds
    s_add_u32 m0, s28, 65536
    s_nop 0
    buffer_load_dwordx4 v16, s[12:15], s32 offen lds
    s_add_u32 m0, s28, 66560
    s_nop 0
    buffer_load_dwordx4 v17, s[12:15], s32 offen lds
    s_add_u32 m0, s28, 67584
    s_nop 0
    buffer_load_dwordx4 v18, s[12:15], s32 offen lds
    s_add_u32 m0, s28, 68608
    s_nop 0
    buffer_load_dwordx4 v19, s[12:15], s32 offen lds
    s_add_u32 s31, s31, 128
    s_add_u32 s32, s32, 131072
l4_kernel_nd_32:
    s_sub_u32 s33, s33, 1
    s_cmp_eq_u32 s33, 0
    s_cbranch_scc0 l4_kernel_lloop_19
l4_kernel_ldone_20:
    s_endpgm
l4_kernel_comp_3:
    v_and_b32 v84, 63, v80
    s_lshr_b32 s25, s24, 1
    s_and_b32 s26, s24, 1
    v_and_b32 v86, 31, v84
    v_lshrrev_b32 v87, 5, v84
    v_lshrrev_b32 v88, 1, v84
    v_and_b32 v88, 7, v88
    s_mul_i32 s29, s25, 32
    v_add_u32 v89, s29, v86
    v_lshlrev_b32 v89, 7, v89
    v_add_u32 v90, 0, v87
    v_xor_b32 v90, v90, v88
    v_lshlrev_b32 v90, 4, v90
    v_add_u32 v56, v89, v90
    v_add_u32 v60, 32768, v56
    v_add_u32 v64, 65536, v56
    v_add_u32 v68, 98304, v56
    v_add_u32 v90, 2, v87
    v_xor_b32 v90, v90, v88
    v_lshlrev_b32 v90, 4, v90
    v_add_u32 v57, v89, v90
    v_add_u32 v61, 32768, v57
    v_add_u32 v65, 65536, v57
    v_add_u32 v69, 98304, v57
    v_add_u32 v90, 4, v87
    v_xor_b32 v90, v90, v88
    v_lshlrev_b32 v90, 4, v90
    v_add_u32 v58, v89, v90
    v_add_u32 v62, 32768, v58
    v_add_u32 v66, 65536, v58
    v_add_u32 v70, 98304, v58
    v_add_u32 v90, 6, v87
    v_xor_b32 v90, v90, v88
    v_lshlrev_b32 v90, 4, v90
    v_add_u32 v59, v89, v90
    v_add_u32 v63, 32768, v59
    v_add_u32 v67, 65536, v59
    v_add_u32 v71, 98304, v59
    v_lshrrev_b32 v86, 4, v84
    v_and_b32 v87, 15, v84
    v_lshrrev_b32 v87, 2, v87
    v_and_b32 v88, 3, v84
    v_lshrrev_b32 v89, 1, v86
    v_lshlrev_b32 v89, 3, v89
    v_add_u32 v89, v89, v87
    v_mul_u32_u24 v89, 256, v89
    v_and_b32 v90, 1, v86
    v_lshlrev_b32 v90, 1, v90
    v_lshrrev_b32 v91, 1, v88
    v_add_u32 v90, v90, v91
    s_mul_i32 s29, s26, 8
    v_add_u32 v90, s29, v90
    v_lshlrev_b32 v91, 2, v87
    v_and_b32 v88, 1, v88
    v_lshlrev_b32 v88, 3, v88
    v_add_u32 v89, v89, v88
    v_add_u32 v89, 16384, v89
    v_add_u32 v72, 0, v90
    v_xor_b32 v72, v72, v91
    v_lshlrev_b32 v72, 4, v72
    v_add_u32 v72, v72, v89
    v_add_u32 v74, 32768, v72
    v_add_u32 v76, 65536, v72
    v_add_u32 v78, 98304, v72
    v_add_u32 v73, 4, v90
    v_xor_b32 v73, v73, v91
    v_lshlrev_b32 v73, 4, v73
    v_add_u32 v73, v73, v89
    v_add_u32 v75, 32768, v73
    v_add_u32 v77, 65536, v73
    v_add_u32 v79, 98304, v73
    v_mov_b32 v0, 0
    v_mov_b32 v1, 0
    v_mov_b32 v2, 0
    v_mov_b32 v3, 0
    v_mov_b32 v4, 0
    v_mov_b32 v5, 0
    v_mov_b32 v6, 0
    v_mov_b32 v7, 0
    v_mov_b32 v8, 0
    v_mov_b32 v9, 0
    v_mov_b32 v10, 0
    v_mov_b32 v11, 0
    v_mov_b32 v12, 0
    v_mov_b32 v13, 0
    v_mov_b32 v14, 0
    v_mov_b32 v15, 0
    v_mov_b32 v16, 0
    v_mov_b32 v17, 0
    v_mov_b32 v18, 0
    v_mov_b32 v19, 0
    v_mov_b32 v20, 0
    v_mov_b32 v21, 0
    v_mov_b32 v22, 0
    v_mov_b32 v23, 0
    v_mov_b32 v24, 0
    v_mov_b32 v25, 0
    v_mov_b32 v26, 0
    v_mov_b32 v27, 0
    v_mov_b32 v28, 0
    v_mov_b32 v29, 0
    v_mov_b32 v30, 0
    v_mov_b32 v31, 0
    v_mov_b32 v36, 0
    v_mov_b32 v37, 0
    v_mov_b32 v38, 0
    v_mov_b32 v39, 0
    v_mov_b32 v48, 0
    v_mov_b32 v49, 0
    v_mov_b32 v50, 0
    v_mov_b32 v51, 0
    v_mov_b32 v52, 0
    v_mov_b32 v53, 0
    v_mov_b32 v54, 0
    v_mov_b32 v55, 0
l4_kernel_loop_33:
    s_waitcnt lgkmcnt(0)
    s_barrier
    ds_read_b128 v[32:35], v56 offset:0
    ds_read_b64_tr_b16 v[40:41], v72 offset:0
    ds_read_b64_tr_b16 v[42:43], v72 offset:1024
    ds_read_b64_tr_b16 v[44:45], v73 offset:0
    ds_read_b64_tr_b16 v[46:47], v73 offset:1024
    v_mfma_f32_32x32x16_bf16 v[0:15], v[48:51], v[36:39], v[0:15]
    v_mfma_f32_32x32x16_bf16 v[16:31], v[52:55], v[36:39], v[16:31]
    ds_read_b128 v[36:39], v57 offset:0
    ds_read_b64_tr_b16 v[48:49], v72 offset:4096
    ds_read_b64_tr_b16 v[50:51], v72 offset:5120
    ds_read_b64_tr_b16 v[52:53], v73 offset:4096
    ds_read_b64_tr_b16 v[54:55], v73 offset:5120
    s_waitcnt lgkmcnt(5)
    v_mfma_f32_32x32x16_bf16 v[0:15], v[40:43], v[32:35], v[0:15]
    v_mfma_f32_32x32x16_bf16 v[16:31], v[44:47], v[32:35], v[16:31]
    ds_read_b128 v[32:35], v58 offset:0
    ds_read_b64_tr_b16 v[40:41], v72 offset:8192
    ds_read_b64_tr_b16 v[42:43], v72 offset:9216
    ds_read_b64_tr_b16 v[44:45], v73 offset:8192
    ds_read_b64_tr_b16 v[46:47], v73 offset:9216
    s_waitcnt lgkmcnt(5)
    v_mfma_f32_32x32x16_bf16 v[0:15], v[48:51], v[36:39], v[0:15]
    v_mfma_f32_32x32x16_bf16 v[16:31], v[52:55], v[36:39], v[16:31]
    ds_read_b128 v[36:39], v59 offset:0
    ds_read_b64_tr_b16 v[48:49], v72 offset:12288
    ds_read_b64_tr_b16 v[50:51], v72 offset:13312
    ds_read_b64_tr_b16 v[52:53], v73 offset:12288
    ds_read_b64_tr_b16 v[54:55], v73 offset:13312
    s_waitcnt lgkmcnt(5)
    v_mfma_f32_32x32x16_bf16 v[0:15], v[40:43], v[32:35], v[0:15]
    v_mfma_f32_32x32x16_bf16 v[16:31], v[44:47], v[32:35], v[16:31]
    s_sub_u32 s33, s33, 1
    s_cmp_eq_u32 s33, 0
    s_cbranch_scc1 l4_kernel_exit_34
    s_waitcnt lgkmcnt(0)
    s_barrier
    ds_read_b128 v[32:35], v60 offset:0
    ds_read_b64_tr_b16 v[40:41], v74 offset:0
    ds_read_b64_tr_b16 v[42:43], v74 offset:1024
    ds_read_b64_tr_b16 v[44:45], v75 offset:0
    ds_read_b64_tr_b16 v[46:47], v75 offset:1024
    v_mfma_f32_32x32x16_bf16 v[0:15], v[48:51], v[36:39], v[0:15]
    v_mfma_f32_32x32x16_bf16 v[16:31], v[52:55], v[36:39], v[16:31]
    ds_read_b128 v[36:39], v61 offset:0
    ds_read_b64_tr_b16 v[48:49], v74 offset:4096
    ds_read_b64_tr_b16 v[50:51], v74 offset:5120
    ds_read_b64_tr_b16 v[52:53], v75 offset:4096
    ds_read_b64_tr_b16 v[54:55], v75 offset:5120
    s_waitcnt lgkmcnt(5)
    v_mfma_f32_32x32x16_bf16 v[0:15], v[40:43], v[32:35], v[0:15]
    v_mfma_f32_32x32x16_bf16 v[16:31], v[44:47], v[32:35], v[16:31]
    ds_read_b128 v[32:35], v62 offset:0
    ds_read_b64_tr_b16 v[40:41], v74 offset:8192
    ds_read_b64_tr_b16 v[42:43], v74 offset:9216
    ds_read_b64_tr_b16 v[44:45], v75 offset:8192
    ds_read_b64_tr_b16 v[46:47], v75 offset:9216
    s_waitcnt lgkmcnt(5)
    v_mfma_f32_32x32x16_bf16 v[0:15], v[48:51], v[36:39], v[0:15]
    v_mfma_f32_32x32x16_bf16 v[16:31], v[52:55], v[36:39], v[16:31]
    ds_read_b128 v[36:39], v63 offset:0
    ds_read_b64_tr_b16 v[48:49], v74 offset:12288
    ds_read_b64_tr_b16 v[50:51], v74 offset:13312
    ds_read_b64_tr_b16 v[52:53], v75 offset:12288
    ds_read_b64_tr_b16 v[54:55], v75 offset:13312
    s_waitcnt lgkmcnt(5)
    v_mfma_f32_32x32x16_bf16 v[0:15], v[40:43], v[32:35], v[0:15]
    v_mfma_f32_32x32x16_bf16 v[16:31], v[44:47], v[32:35], v[16:31]
    s_sub_u32 s33, s33, 1
    s_cmp_eq_u32 s33, 0
    s_cbranch_scc1 l4_kernel_exit_34
    s_waitcnt lgkmcnt(0)
    s_barrier
    ds_read_b128 v[32:35], v64 offset:0
    ds_read_b64_tr_b16 v[40:41], v76 offset:0
    ds_read_b64_tr_b16 v[42:43], v76 offset:1024
    ds_read_b64_tr_b16 v[44:45], v77 offset:0
    ds_read_b64_tr_b16 v[46:47], v77 offset:1024
    v_mfma_f32_32x32x16_bf16 v[0:15], v[48:51], v[36:39], v[0:15]
    v_mfma_f32_32x32x16_bf16 v[16:31], v[52:55], v[36:39], v[16:31]
    ds_read_b128 v[36:39], v65 offset:0
    ds_read_b64_tr_b16 v[48:49], v76 offset:4096
    ds_read_b64_tr_b16 v[50:51], v76 offset:5120
    ds_read_b64_tr_b16 v[52:53], v77 offset:4096
    ds_read_b64_tr_b16 v[54:55], v77 offset:5120
    s_waitcnt lgkmcnt(5)
    v_mfma_f32_32x32x16_bf16 v[0:15], v[40:43], v[32:35], v[0:15]
    v_mfma_f32_32x32x16_bf16 v[16:31], v[44:47], v[32:35], v[16:31]
    ds_read_b128 v[32:35], v66 offset:0
    ds_read_b64_tr_b16 v[40:41], v76 offset:8192
    ds_read_b64_tr_b16 v[42:43], v76 offset:9216
    ds_read_b64_tr_b16 v[44:45], v77 offset:8192
    ds_read_b64_tr_b16 v[46:47], v77 offset:9216
    s_waitcnt lgkmcnt(5)
    v_mfma_f32_32x32x16_bf16 v[0:15], v[48:51], v[36:39], v[0:15]
    v_mfma_f32_32x32x16_bf16 v[16:31], v[52:55], v[36:39], v[16:31]
    ds_read_b128 v[36:39], v67 offset:0
    ds_read_b64_tr_b16 v[48:49], v76 offset:12288
    ds_read_b64_tr_b16 v[50:51], v76 offset:13312
    ds_read_b64_tr_b16 v[52:53], v77 offset:12288
    ds_read_b64_tr_b16 v[54:55], v77 offset:13312
    s_waitcnt lgkmcnt(5)
    v_mfma_f32_32x32x16_bf16 v[0:15], v[40:43], v[32:35], v[0:15]
    v_mfma_f32_32x32x16_bf16 v[16:31], v[44:47], v[32:35], v[16:31]
    s_sub_u32 s33, s33, 1
    s_cmp_eq_u32 s33, 0
    s_cbranch_scc1 l4_kernel_exit_34
    s_waitcnt lgkmcnt(0)
    s_barrier
    ds_read_b128 v[32:35], v68 offset:0
    ds_read_b64_tr_b16 v[40:41], v78 offset:0
    ds_read_b64_tr_b16 v[42:43], v78 offset:1024
    ds_read_b64_tr_b16 v[44:45], v79 offset:0
    ds_read_b64_tr_b16 v[46:47], v79 offset:1024
    v_mfma_f32_32x32x16_bf16 v[0:15], v[48:51], v[36:39], v[0:15]
    v_mfma_f32_32x32x16_bf16 v[16:31], v[52:55], v[36:39], v[16:31]
    ds_read_b128 v[36:39], v69 offset:0
    ds_read_b64_tr_b16 v[48:49], v78 offset:4096
    ds_read_b64_tr_b16 v[50:51], v78 offset:5120
    ds_read_b64_tr_b16 v[52:53], v79 offset:4096
    ds_read_b64_tr_b16 v[54:55], v79 offset:5120
    s_waitcnt lgkmcnt(5)
    v_mfma_f32_32x32x16_bf16 v[0:15], v[40:43], v[32:35], v[0:15]
    v_mfma_f32_32x32x16_bf16 v[16:31], v[44:47], v[32:35], v[16:31]
    ds_read_b128 v[32:35], v70 offset:0
    ds_read_b64_tr_b16 v[40:41], v78 offset:8192
    ds_read_b64_tr_b16 v[42:43], v78 offset:9216
    ds_read_b64_tr_b16 v[44:45], v79 offset:8192
    ds_read_b64_tr_b16 v[46:47], v79 offset:9216
    s_waitcnt lgkmcnt(5)
    v_mfma_f32_32x32x16_bf16 v[0:15], v[48:51], v[36:39], v[0:15]
    v_mfma_f32_32x32x16_bf16 v[16:31], v[52:55], v[36:39], v[16:31]
    ds_read_b128 v[36:39], v71 offset:0
    ds_read_b64_tr_b16 v[48:49], v78 offset:12288
    ds_read_b64_tr_b16 v[50:51], v78 offset:13312
    ds_read_b64_tr_b16 v[52:53], v79 offset:12288
    ds_read_b64_tr_b16 v[54:55], v79 offset:13312
    s_waitcnt lgkmcnt(5)
    v_mfma_f32_32x32x16_bf16 v[0:15], v[40:43], v[32:35], v[0:15]
    v_mfma_f32_32x32x16_bf16 v[16:31], v[44:47], v[32:35], v[16:31]
    s_sub_u32 s33, s33, 1
    s_cmp_eq_u32 s33, 0
    s_cbranch_scc0 l4_kernel_loop_33
l4_kernel_exit_34:
    s_waitcnt lgkmcnt(0)
    v_mfma_f32_32x32x16_bf16 v[0:15], v[48:51], v[36:39], v[0:15]
    v_mfma_f32_32x32x16_bf16 v[16:31], v[52:55], v[36:39], v[16:31]
    s_barrier
    s_nop 9
    v_cvt_pk_bf16_f32 v84, v0, v1
    v_cvt_pk_bf16_f32 v85, v2, v3
    v_cvt_pk_bf16_f32 v86, v4, v5
    v_cvt_pk_bf16_f32 v87, v6, v7
    v_cvt_pk_bf16_f32 v88, v8, v9
    v_cvt_pk_bf16_f32 v89, v10, v11
    v_cvt_pk_bf16_f32 v90, v12, v13
    v_cvt_pk_bf16_f32 v91, v14, v15
    v_cvt_pk_bf16_f32 v92, v16, v17
    v_cvt_pk_bf16_f32 v93, v18, v19
    v_cvt_pk_bf16_f32 v94, v20, v21
    v_cvt_pk_bf16_f32 v95, v22, v23
    v_cvt_pk_bf16_f32 v96, v24, v25
    v_cvt_pk_bf16_f32 v97, v26, v27
    v_cvt_pk_bf16_f32 v98, v28, v29
    v_cvt_pk_bf16_f32 v99, v30, v31
    v_mov_b32 v0, 0
    v_mov_b32 v1, 0
    v_mov_b32 v2, 0
    v_mov_b32 v3, 0
    v_mov_b32 v4, 0
    v_mov_b32 v5, 0
    v_mov_b32 v6, 0
    v_mov_b32 v7, 0
    v_mov_b32 v8, 0
    v_mov_b32 v9, 0
    v_mov_b32 v10, 0
    v_mov_b32 v11, 0
    v_mov_b32 v12, 0
    v_mov_b32 v13, 0
    v_mov_b32 v14, 0
    v_mov_b32 v15, 0
    v_mov_b32 v16, 0
    v_mov_b32 v17, 0
    v_mov_b32 v18, 0
    v_mov_b32 v19, 0
    v_mov_b32 v20, 0
    v_mov_b32 v21, 0
    v_mov_b32 v22, 0
    v_mov_b32 v23, 0
    v_mov_b32 v24, 0
    v_mov_b32 v25, 0
    v_mov_b32 v26, 0
    v_mov_b32 v27, 0
    v_mov_b32 v28, 0
    v_mov_b32 v29, 0
    v_mov_b32 v30, 0
    v_mov_b32 v31, 0
    v_mov_b32 v36, 0
    v_mov_b32 v37, 0
    v_mov_b32 v38, 0
    v_mov_b32 v39, 0
    v_mov_b32 v48, 0
    v_mov_b32 v49, 0
    v_mov_b32 v50, 0
    v_mov_b32 v51, 0
    v_mov_b32 v52, 0
    v_mov_b32 v53, 0
    v_mov_b32 v54, 0
    v_mov_b32 v55, 0
    s_mov_b32 s33, 19
l4_kernel_loop_35:
    s_waitcnt lgkmcnt(0)
    s_barrier
    ds_read_b128 v[32:35], v56 offset:0
    ds_read_b64_tr_b16 v[40:41], v72 offset:0
    ds_read_b64_tr_b16 v[42:43], v72 offset:1024
    ds_read_b64_tr_b16 v[44:45], v73 offset:0
    ds_read_b64_tr_b16 v[46:47], v73 offset:1024
    v_mfma_f32_32x32x16_bf16 v[0:15], v[48:51], v[36:39], v[0:15]
    v_mfma_f32_32x32x16_bf16 v[16:31], v[52:55], v[36:39], v[16:31]
    ds_read_b128 v[36:39], v57 offset:0
    ds_read_b64_tr_b16 v[48:49], v72 offset:4096
    ds_read_b64_tr_b16 v[50:51], v72 offset:5120
    ds_read_b64_tr_b16 v[52:53], v73 offset:4096
    ds_read_b64_tr_b16 v[54:55], v73 offset:5120
    s_waitcnt lgkmcnt(5)
    v_mfma_f32_32x32x16_bf16 v[0:15], v[40:43], v[32:35], v[0:15]
    v_mfma_f32_32x32x16_bf16 v[16:31], v[44:47], v[32:35], v[16:31]
    ds_read_b128 v[32:35], v58 offset:0
    ds_read_b64_tr_b16 v[40:41], v72 offset:8192
    ds_read_b64_tr_b16 v[42:43], v72 offset:9216
    ds_read_b64_tr_b16 v[44:45], v73 offset:8192
    ds_read_b64_tr_b16 v[46:47], v73 offset:9216
    s_waitcnt lgkmcnt(5)
    v_mfma_f32_32x32x16_bf16 v[0:15], v[48:51], v[36:39], v[0:15]
    v_mfma_f32_32x32x16_bf16 v[16:31], v[52:55], v[36:39], v[16:31]
    ds_read_b128 v[36:39], v59 offset:0
    ds_read_b64_tr_b16 v[48:49], v72 offset:12288
    ds_read_b64_tr_b16 v[50:51], v72 offset:13312
    ds_read_b64_tr_b16 v[52:53], v73 offset:12288
    ds_read_b64_tr_b16 v[54:55], v73 offset:13312
    s_waitcnt lgkmcnt(5)
    v_mfma_f32_32x32x16_bf16 v[0:15], v[40:43], v[32:35], v[0:15]
    v_mfma_f32_32x32x16_bf16 v[16:31], v[44:47], v[32:35], v[16:31]
    s_sub_u32 s33, s33, 1
    s_cmp_eq_u32 s33, 0
    s_cbranch_scc1 l4_kernel_exit_36
    s_waitcnt lgkmcnt(0)
    s_barrier
    ds_read_b128 v[32:35], v60 offset:0
    ds_read_b64_tr_b16 v[40:41], v74 offset:0
    ds_read_b64_tr_b16 v[42:43], v74 offset:1024
    ds_read_b64_tr_b16 v[44:45], v75 offset:0
    ds_read_b64_tr_b16 v[46:47], v75 offset:1024
    v_mfma_f32_32x32x16_bf16 v[0:15], v[48:51], v[36:39], v[0:15]
    v_mfma_f32_32x32x16_bf16 v[16:31], v[52:55], v[36:39], v[16:31]
    ds_read_b128 v[36:39], v61 offset:0
    ds_read_b64_tr_b16 v[48:49], v74 offset:4096
    ds_read_b64_tr_b16 v[50:51], v74 offset:5120
    ds_read_b64_tr_b16 v[52:53], v75 offset:4096
    ds_read_b64_tr_b16 v[54:55], v75 offset:5120
    s_waitcnt lgkmcnt(5)
    v_mfma_f32_32x32x16_bf16 v[0:15], v[40:43], v[32:35], v[0:15]
    v_mfma_f32_32x32x16_bf16 v[16:31], v[44:47], v[32:35], v[16:31]
    ds_read_b128 v[32:35], v62 offset:0
    ds_read_b64_tr_b16 v[40:41], v74 offset:8192
    ds_read_b64_tr_b16 v[42:43], v74 offset:9216
    ds_read_b64_tr_b16 v[44:45], v75 offset:8192
    ds_read_b64_tr_b16 v[46:47], v75 offset:9216
    s_waitcnt lgkmcnt(5)
    v_mfma_f32_32x32x16_bf16 v[0:15], v[48:51], v[36:39], v[0:15]
    v_mfma_f32_32x32x16_bf16 v[16:31], v[52:55], v[36:39], v[16:31]
    ds_read_b128 v[36:39], v63 offset:0
    ds_read_b64_tr_b16 v[48:49], v74 offset:12288
    ds_read_b64_tr_b16 v[50:51], v74 offset:13312
    ds_read_b64_tr_b16 v[52:53], v75 offset:12288
    ds_read_b64_tr_b16 v[54:55], v75 offset:13312
    s_waitcnt lgkmcnt(5)
    v_mfma_f32_32x32x16_bf16 v[0:15], v[40:43], v[32:35], v[0:15]
    v_mfma_f32_32x32x16_bf16 v[16:31], v[44:47], v[32:35], v[16:31]
    s_sub_u32 s33, s33, 1
    s_cmp_eq_u32 s33, 0
    s_cbranch_scc1 l4_kernel_exit_36
    s_waitcnt lgkmcnt(0)
    s_barrier
    ds_read_b128 v[32:35], v64 offset:0
    ds_read_b64_tr_b16 v[40:41], v76 offset:0
    ds_read_b64_tr_b16 v[42:43], v76 offset:1024
    ds_read_b64_tr_b16 v[44:45], v77 offset:0
    ds_read_b64_tr_b16 v[46:47], v77 offset:1024
    v_mfma_f32_32x32x16_bf16 v[0:15], v[48:51], v[36:39], v[0:15]
    v_mfma_f32_32x32x16_bf16 v[16:31], v[52:55], v[36:39], v[16:31]
    ds_read_b128 v[36:39], v65 offset:0
    ds_read_b64_tr_b16 v[48:49], v76 offset:4096
    ds_read_b64_tr_b16 v[50:51], v76 offset:5120
    ds_read_b64_tr_b16 v[52:53], v77 offset:4096
    ds_read_b64_tr_b16 v[54:55], v77 offset:5120
    s_waitcnt lgkmcnt(5)
    v_mfma_f32_32x32x16_bf16 v[0:15], v[40:43], v[32:35], v[0:15]
    v_mfma_f32_32x32x16_bf16 v[16:31], v[44:47], v[32:35], v[16:31]
    ds_read_b128 v[32:35], v66 offset:0
    ds_read_b64_tr_b16 v[40:41], v76 offset:8192
    ds_read_b64_tr_b16 v[42:43], v76 offset:9216
    ds_read_b64_tr_b16 v[44:45], v77 offset:8192
    ds_read_b64_tr_b16 v[46:47], v77 offset:9216
    s_waitcnt lgkmcnt(5)
    v_mfma_f32_32x32x16_bf16 v[0:15], v[48:51], v[36:39], v[0:15]
    v_mfma_f32_32x32x16_bf16 v[16:31], v[52:55], v[36:39], v[16:31]
    ds_read_b128 v[36:39], v67 offset:0
    ds_read_b64_tr_b16 v[48:49], v76 offset:12288
    ds_read_b64_tr_b16 v[50:51], v76 offset:13312
    ds_read_b64_tr_b16 v[52:53], v77 offset:12288
    ds_read_b64_tr_b16 v[54:55], v77 offset:13312
    s_waitcnt lgkmcnt(5)
    v_mfma_f32_32x32x16_bf16 v[0:15], v[40:43], v[32:35], v[0:15]
    v_mfma_f32_32x32x16_bf16 v[16:31], v[44:47], v[32:35], v[16:31]
    s_sub_u32 s33, s33, 1
    s_cmp_eq_u32 s33, 0
    s_cbranch_scc1 l4_kernel_exit_36
    s_waitcnt lgkmcnt(0)
    s_barrier
    ds_read_b128 v[32:35], v68 offset:0
    ds_read_b64_tr_b16 v[40:41], v78 offset:0
    ds_read_b64_tr_b16 v[42:43], v78 offset:1024
    ds_read_b64_tr_b16 v[44:45], v79 offset:0
    ds_read_b64_tr_b16 v[46:47], v79 offset:1024
    v_mfma_f32_32x32x16_bf16 v[0:15], v[48:51], v[36:39], v[0:15]
    v_mfma_f32_32x32x16_bf16 v[16:31], v[52:55], v[36:39], v[16:31]
    ds_read_b128 v[36:39], v69 offset:0
    ds_read_b64_tr_b16 v[48:49], v78 offset:4096
    ds_read_b64_tr_b16 v[50:51], v78 offset:5120
    ds_read_b64_tr_b16 v[52:53], v79 offset:4096
    ds_read_b64_tr_b16 v[54:55], v79 offset:5120
    s_waitcnt lgkmcnt(5)
    v_mfma_f32_32x32x16_bf16 v[0:15], v[40:43], v[32:35], v[0:15]
    v_mfma_f32_32x32x16_bf16 v[16:31], v[44:47], v[32:35], v[16:31]
    ds_read_b128 v[32:35], v70 offset:0
    ds_read_b64_tr_b16 v[40:41], v78 offset:8192
    ds_read_b64_tr_b16 v[42:43], v78 offset:9216
    ds_read_b64_tr_b16 v[44:45], v79 offset:8192
    ds_read_b64_tr_b16 v[46:47], v79 offset:9216
    s_waitcnt lgkmcnt(5)
    v_mfma_f32_32x32x16_bf16 v[0:15], v[48:51], v[36:39], v[0:15]
    v_mfma_f32_32x32x16_bf16 v[16:31], v[52:55], v[36:39], v[16:31]
    ds_read_b128 v[36:39], v71 offset:0
    ds_read_b64_tr_b16 v[48:49], v78 offset:12288
    ds_read_b64_tr_b16 v[50:51], v78 offset:13312
    ds_read_b64_tr_b16 v[52:53], v79 offset:12288
    ds_read_b64_tr_b16 v[54:55], v79 offset:13312
    s_waitcnt lgkmcnt(5)
    v_mfma_f32_32x32x16_bf16 v[0:15], v[40:43], v[32:35], v[0:15]
    v_mfma_f32_32x32x16_bf16 v[16:31], v[44:47], v[32:35], v[16:31]
    s_sub_u32 s33, s33, 1
    s_cmp_eq_u32 s33, 0
    s_cbranch_scc0 l4_kernel_loop_35
l4_kernel_exit_36:
    s_waitcnt lgkmcnt(0)
    v_mfma_f32_32x32x16_bf16 v[0:15], v[48:51], v[36:39], v[0:15]
    v_mfma_f32_32x32x16_bf16 v[16:31], v[52:55], v[36:39], v[16:31]
    s_branch l4_kernel_join_37
l4_kernel_h1_2:
    s_add_u32 s8, s40, 27262976
    s_addc_u32 s9, s41, 0
    s_and_b32 s9, s9, 0xffff
    s_mov_b32 s10, 14680064
    s_mov_b32 s11, 0x00020000
    s_mov_b32 s12, s6
    s_mov_b32 s13, s7
    s_and_b32 s13, s13, 0xffff
    s_mov_b32 s14, 7340032
    s_mov_b32 s15, 0x00020000
    s_mov_b32 s31, 2432
    s_mov_b32 s32, 2490368
    s_mov_b32 s33, 37
    s_cmp_lt_u32 s24, 8
    s_cbranch_scc1 l4_kernel_comp_38
    s_cmp_lt_u32 s24, 12
    s_cbranch_scc1 l4_kernel_lok_39
    s_endpgm
l4_kernel_lok_39:
    s_sub_u32 s24, s24, 8
    v_and_b32 v4, 63, v0
    s_mul_i32 s27, s24, 4096
    s_mul_i32 s28, s24, 4096
    s_add_u32 s28, s28, 16384
    v_lshrrev_b32 v6, 3, v4
    v_lshrrev_b32 v7, 4, v4
    v_and_b32 v8, 7, v4
    s_mul_i32 s29, s34, 128
    s_mul_i32 s30, s24, 32
    s_add_u32 s29, s29, s30
    s_mov_b32 s30, 7168
    v_add_u32 v9, s29, v6
    v_mul_lo_u32 v9, v9, s30
    v_xor_b32 v10, v7, v8
    v_lshlrev_b32 v10, 4, v10
    v_add_u32 v12, v9, v10
    v_add_u32 v9, s29, v6
    v_add_u32 v9, 8, v9
    v_mul_lo_u32 v9, v9, s30
    v_or_b32 v10, 4, v7
    v_xor_b32 v10, v10, v8
    v_lshlrev_b32 v10, 4, v10
    v_add_u32 v13, v9, v10
    v_add_u32 v9, s29, v6
    v_add_u32 v9, 16, v9
    v_mul_lo_u32 v9, v9, s30
    v_xor_b32 v10, v7, v8
    v_lshlrev_b32 v10, 4, v10
    v_add_u32 v14, v9, v10
    v_add_u32 v9, s29, v6
    v_add_u32 v9, 24, v9
    v_mul_lo_u32 v9, v9, s30
    v_or_b32 v10, 4, v7
    v_xor_b32 v10, v10, v8
    v_lshlrev_b32 v10, 4, v10
    v_add_u32 v15, v9, v10
    v_lshrrev_b32 v6, 4, v4
    v_and_b32 v8, 15, v4
    v_lshlrev_b32 v7, 2, v6
    v_xor_b32 v8, v8, v7
    v_lshlrev_b32 v8, 4, v8
    s_mul_i32 s30, s35, 256
    s_mul_i32 s29, s24, 16
    v_add_u32 v8, s30, v8
    s_mov_b32 s30, 2048
    v_add_u32 v9, s29, v6
    v_mul_lo_u32 v9, v9, s30
    v_add_u32 v16, v9, v8
    v_add_u32 v9, s29, v6
    v_add_u32 v9, 4, v9
    v_mul_lo_u32 v9, v9, s30
    v_add_u32 v17, v9, v8
    v_add_u32 v9, s29, v6
    v_add_u32 v9, 8, v9
    v_mul_lo_u32 v9, v9, s30
    v_add_u32 v18, v9, v8
    v_add_u32 v9, s29, v6
    v_add_u32 v9, 12, v9
    v_mul_lo_u32 v9, v9, s30
    v_add_u32 v19, v9, v8
    s_add_u32 m0, s27, 0
    s_nop 0
    buffer_load_dwordx4 v12, s[8:11], s31 offen lds
    s_add_u32 m0, s27, 1024
    s_nop 0
    buffer_load_dwordx4 v13, s[8:11], s31 offen lds
    s_add_u32 m0, s27, 2048
    s_nop 0
    buffer_load_dwordx4 v14, s[8:11], s31 offen lds
    s_add_u32 m0, s27, 3072
    s_nop 0
    buffer_load_dwordx4 v15, s[8:11], s31 offen lds
    s_add_u32 m0, s28, 0
    s_nop 0
    buffer_load_dwordx4 v16, s[12:15], s32 offen lds
    s_add_u32 m0, s28, 1024
    s_nop 0
    buffer_load_dwordx4 v17, s[12:15], s32 offen lds
    s_add_u32 m0, s28, 2048
    s_nop 0
    buffer_load_dwordx4 v18, s[12:15], s32 offen lds
    s_add_u32 m0, s28, 3072
    s_nop 0
    buffer_load_dwordx4 v19, s[12:15], s32 offen lds
    s_add_u32 s31, s31, 128
    s_add_u32 s32, s32, 131072
    s_add_u32 m0, s27, 32768
    s_nop 0
    buffer_load_dwordx4 v12, s[8:11], s31 offen lds
    s_add_u32 m0, s27, 33792
    s_nop 0
    buffer_load_dwordx4 v13, s[8:11], s31 offen lds
    s_add_u32 m0, s27, 34816
    s_nop 0
    buffer_load_dwordx4 v14, s[8:11], s31 offen lds
    s_add_u32 m0, s27, 35840
    s_nop 0
    buffer_load_dwordx4 v15, s[8:11], s31 offen lds
    s_add_u32 m0, s28, 32768
    s_nop 0
    buffer_load_dwordx4 v16, s[12:15], s32 offen lds
    s_add_u32 m0, s28, 33792
    s_nop 0
    buffer_load_dwordx4 v17, s[12:15], s32 offen lds
    s_add_u32 m0, s28, 34816
    s_nop 0
    buffer_load_dwordx4 v18, s[12:15], s32 offen lds
    s_add_u32 m0, s28, 35840
    s_nop 0
    buffer_load_dwordx4 v19, s[12:15], s32 offen lds
    s_add_u32 s31, s31, 128
    s_add_u32 s32, s32, 131072
    s_add_u32 m0, s27, 65536
    s_nop 0
    buffer_load_dwordx4 v12, s[8:11], s31 offen lds
    s_add_u32 m0, s27, 66560
    s_nop 0
    buffer_load_dwordx4 v13, s[8:11], s31 offen lds
    s_add_u32 m0, s27, 67584
    s_nop 0
    buffer_load_dwordx4 v14, s[8:11], s31 offen lds
    s_add_u32 m0, s27, 68608
    s_nop 0
    buffer_load_dwordx4 v15, s[8:11], s31 offen lds
    s_add_u32 m0, s28, 65536
    s_nop 0
    buffer_load_dwordx4 v16, s[12:15], s32 offen lds
    s_add_u32 m0, s28, 66560
    s_nop 0
    buffer_load_dwordx4 v17, s[12:15], s32 offen lds
    s_add_u32 m0, s28, 67584
    s_nop 0
    buffer_load_dwordx4 v18, s[12:15], s32 offen lds
    s_add_u32 m0, s28, 68608
    s_nop 0
    buffer_load_dwordx4 v19, s[12:15], s32 offen lds
    s_add_u32 s31, s31, 128
    s_add_u32 s32, s32, 131072
l4_kernel_lloop_40:
    s_cmp_lt_u32 s33, 3
    s_cbranch_scc1 l4_kernel_w0_42
    s_waitcnt vmcnt(16)
    s_branch l4_kernel_w1_43
l4_kernel_w0_42:
    s_waitcnt vmcnt(0)
l4_kernel_w1_43:
    s_barrier
    s_cmp_le_u32 s33, 3
    s_cbranch_scc1 l4_kernel_nd_44
    s_add_u32 m0, s27, 98304
    s_nop 0
    buffer_load_dwordx4 v12, s[8:11], s31 offen lds
    s_add_u32 m0, s27, 99328
    s_nop 0
    buffer_load_dwordx4 v13, s[8:11], s31 offen lds
    s_add_u32 m0, s27, 100352
    s_nop 0
    buffer_load_dwordx4 v14, s[8:11], s31 offen lds
    s_add_u32 m0, s27, 101376
    s_nop 0
    buffer_load_dwordx4 v15, s[8:11], s31 offen lds
    s_add_u32 m0, s28, 98304
    s_nop 0
    buffer_load_dwordx4 v16, s[12:15], s32 offen lds
    s_add_u32 m0, s28, 99328
    s_nop 0
    buffer_load_dwordx4 v17, s[12:15], s32 offen lds
    s_add_u32 m0, s28, 100352
    s_nop 0
    buffer_load_dwordx4 v18, s[12:15], s32 offen lds
    s_add_u32 m0, s28, 101376
    s_nop 0
    buffer_load_dwordx4 v19, s[12:15], s32 offen lds
    s_add_u32 s31, s31, 128
    s_add_u32 s32, s32, 131072
l4_kernel_nd_44:
    s_sub_u32 s33, s33, 1
    s_cmp_eq_u32 s33, 0
    s_cbranch_scc1 l4_kernel_ldone_41
    s_cmp_lt_u32 s33, 3
    s_cbranch_scc1 l4_kernel_w0_45
    s_waitcnt vmcnt(16)
    s_branch l4_kernel_w1_46
l4_kernel_w0_45:
    s_waitcnt vmcnt(0)
l4_kernel_w1_46:
    s_barrier
    s_cmp_le_u32 s33, 3
    s_cbranch_scc1 l4_kernel_nd_47
    s_add_u32 m0, s27, 0
    s_nop 0
    buffer_load_dwordx4 v12, s[8:11], s31 offen lds
    s_add_u32 m0, s27, 1024
    s_nop 0
    buffer_load_dwordx4 v13, s[8:11], s31 offen lds
    s_add_u32 m0, s27, 2048
    s_nop 0
    buffer_load_dwordx4 v14, s[8:11], s31 offen lds
    s_add_u32 m0, s27, 3072
    s_nop 0
    buffer_load_dwordx4 v15, s[8:11], s31 offen lds
    s_add_u32 m0, s28, 0
    s_nop 0
    buffer_load_dwordx4 v16, s[12:15], s32 offen lds
    s_add_u32 m0, s28, 1024
    s_nop 0
    buffer_load_dwordx4 v17, s[12:15], s32 offen lds
    s_add_u32 m0, s28, 2048
    s_nop 0
    buffer_load_dwordx4 v18, s[12:15], s32 offen lds
    s_add_u32 m0, s28, 3072
    s_nop 0
    buffer_load_dwordx4 v19, s[12:15], s32 offen lds
    s_add_u32 s31, s31, 128
    s_add_u32 s32, s32, 131072
l4_kernel_nd_47:
    s_sub_u32 s33, s33, 1
    s_cmp_eq_u32 s33, 0
    s_cbranch_scc1 l4_kernel_ldone_41
    s_cmp_lt_u32 s33, 3
    s_cbranch_scc1 l4_kernel_w0_48
    s_waitcnt vmcnt(16)
    s_branch l4_kernel_w1_49
l4_kernel_w0_48:
    s_waitcnt vmcnt(0)
l4_kernel_w1_49:
    s_barrier
    s_cmp_le_u32 s33, 3
    s_cbranch_scc1 l4_kernel_nd_50
    s_add_u32 m0, s27, 32768
    s_nop 0
    buffer_load_dwordx4 v12, s[8:11], s31 offen lds
    s_add_u32 m0, s27, 33792
    s_nop 0
    buffer_load_dwordx4 v13, s[8:11], s31 offen lds
    s_add_u32 m0, s27, 34816
    s_nop 0
    buffer_load_dwordx4 v14, s[8:11], s31 offen lds
    s_add_u32 m0, s27, 35840
    s_nop 0
    buffer_load_dwordx4 v15, s[8:11], s31 offen lds
    s_add_u32 m0, s28, 32768
    s_nop 0
    buffer_load_dwordx4 v16, s[12:15], s32 offen lds
    s_add_u32 m0, s28, 33792
    s_nop 0
    buffer_load_dwordx4 v17, s[12:15], s32 offen lds
    s_add_u32 m0, s28, 34816
    s_nop 0
    buffer_load_dwordx4 v18, s[12:15], s32 offen lds
    s_add_u32 m0, s28, 35840
    s_nop 0
    buffer_load_dwordx4 v19, s[12:15], s32 offen lds
    s_add_u32 s31, s31, 128
    s_add_u32 s32, s32, 131072
l4_kernel_nd_50:
    s_sub_u32 s33, s33, 1
    s_cmp_eq_u32 s33, 0
    s_cbranch_scc1 l4_kernel_ldone_41
    s_cmp_lt_u32 s33, 3
    s_cbranch_scc1 l4_kernel_w0_51
    s_waitcnt vmcnt(16)
    s_branch l4_kernel_w1_52
l4_kernel_w0_51:
    s_waitcnt vmcnt(0)
l4_kernel_w1_52:
    s_barrier
    s_cmp_le_u32 s33, 3
    s_cbranch_scc1 l4_kernel_nd_53
    s_add_u32 m0, s27, 65536
    s_nop 0
    buffer_load_dwordx4 v12, s[8:11], s31 offen lds
    s_add_u32 m0, s27, 66560
    s_nop 0
    buffer_load_dwordx4 v13, s[8:11], s31 offen lds
    s_add_u32 m0, s27, 67584
    s_nop 0
    buffer_load_dwordx4 v14, s[8:11], s31 offen lds
    s_add_u32 m0, s27, 68608
    s_nop 0
    buffer_load_dwordx4 v15, s[8:11], s31 offen lds
    s_add_u32 m0, s28, 65536
    s_nop 0
    buffer_load_dwordx4 v16, s[12:15], s32 offen lds
    s_add_u32 m0, s28, 66560
    s_nop 0
    buffer_load_dwordx4 v17, s[12:15], s32 offen lds
    s_add_u32 m0, s28, 67584
    s_nop 0
    buffer_load_dwordx4 v18, s[12:15], s32 offen lds
    s_add_u32 m0, s28, 68608
    s_nop 0
    buffer_load_dwordx4 v19, s[12:15], s32 offen lds
    s_add_u32 s31, s31, 128
    s_add_u32 s32, s32, 131072
l4_kernel_nd_53:
    s_sub_u32 s33, s33, 1
    s_cmp_eq_u32 s33, 0
    s_cbranch_scc0 l4_kernel_lloop_40
l4_kernel_ldone_41:
    s_endpgm
l4_kernel_comp_38:
    v_and_b32 v84, 63, v80
    s_lshr_b32 s25, s24, 1
    s_and_b32 s26, s24, 1
    v_and_b32 v86, 31, v84
    v_lshrrev_b32 v87, 5, v84
    v_lshrrev_b32 v88, 1, v84
    v_and_b32 v88, 7, v88
    s_mul_i32 s29, s25, 32
    v_add_u32 v89, s29, v86
    v_lshlrev_b32 v89, 7, v89
    v_add_u32 v90, 0, v87
    v_xor_b32 v90, v90, v88
    v_lshlrev_b32 v90, 4, v90
    v_add_u32 v56, v89, v90
    v_add_u32 v60, 32768, v56
    v_add_u32 v64, 65536, v56
    v_add_u32 v68, 98304, v56
    v_add_u32 v90, 2, v87
    v_xor_b32 v90, v90, v88
    v_lshlrev_b32 v90, 4, v90
    v_add_u32 v57, v89, v90
    v_add_u32 v61, 32768, v57
    v_add_u32 v65, 65536, v57
    v_add_u32 v69, 98304, v57
    v_add_u32 v90, 4, v87
    v_xor_b32 v90, v90, v88
    v_lshlrev_b32 v90, 4, v90
    v_add_u32 v58, v89, v90
    v_add_u32 v62, 32768, v58
    v_add_u32 v66, 65536, v58
    v_add_u32 v70, 98304, v58
    v_add_u32 v90, 6, v87
    v_xor_b32 v90, v90, v88
    v_lshlrev_b32 v90, 4, v90
    v_add_u32 v59, v89, v90
    v_add_u32 v63, 32768, v59
    v_add_u32 v67, 65536, v59
    v_add_u32 v71, 98304, v59
    v_lshrrev_b32 v86, 4, v84
    v_and_b32 v87, 15, v84
    v_lshrrev_b32 v87, 2, v87
    v_and_b32 v88, 3, v84
    v_lshrrev_b32 v89, 1, v86
    v_lshlrev_b32 v89, 3, v89
    v_add_u32 v89, v89, v87
    v_mul_u32_u24 v89, 256, v89
    v_and_b32 v90, 1, v86
    v_lshlrev_b32 v90, 1, v90
    v_lshrrev_b32 v91, 1, v88
    v_add_u32 v90, v90, v91
    s_mul_i32 s29, s26, 8
    v_add_u32 v90, s29, v90
    v_lshlrev_b32 v91, 2, v87
    v_and_b32 v88, 1, v88
    v_lshlrev_b32 v88, 3, v88
    v_add_u32 v89, v89, v88
    v_add_u32 v89, 16384, v89
    v_add_u32 v72, 0, v90
    v_xor_b32 v72, v72, v91
    v_lshlrev_b32 v72, 4, v72
    v_add_u32 v72, v72, v89
    v_add_u32 v74, 32768, v72
    v_add_u32 v76, 65536, v72
    v_add_u32 v78, 98304, v72
    v_add_u32 v73, 4, v90
    v_xor_b32 v73, v73, v91
    v_lshlrev_b32 v73, 4, v73
    v_add_u32 v73, v73, v89
    v_add_u32 v75, 32768, v73
    v_add_u32 v77, 65536, v73
    v_add_u32 v79, 98304, v73
    v_mov_b32 v0, 0
    v_mov_b32 v1, 0
    v_mov_b32 v2, 0
    v_mov_b32 v3, 0
    v_mov_b32 v4, 0
    v_mov_b32 v5, 0
    v_mov_b32 v6, 0
    v_mov_b32 v7, 0
    v_mov_b32 v8, 0
    v_mov_b32 v9, 0
    v_mov_b32 v10, 0
    v_mov_b32 v11, 0
    v_mov_b32 v12, 0
    v_mov_b32 v13, 0
    v_mov_b32 v14, 0
    v_mov_b32 v15, 0
    v_mov_b32 v16, 0
    v_mov_b32 v17, 0
    v_mov_b32 v18, 0
    v_mov_b32 v19, 0
    v_mov_b32 v20, 0
    v_mov_b32 v21, 0
    v_mov_b32 v22, 0
    v_mov_b32 v23, 0
    v_mov_b32 v24, 0
    v_mov_b32 v25, 0
    v_mov_b32 v26, 0
    v_mov_b32 v27, 0
    v_mov_b32 v28, 0
    v_mov_b32 v29, 0
    v_mov_b32 v30, 0
    v_mov_b32 v31, 0
    v_mov_b32 v36, 0
    v_mov_b32 v37, 0
    v_mov_b32 v38, 0
    v_mov_b32 v39, 0
    v_mov_b32 v48, 0
    v_mov_b32 v49, 0
    v_mov_b32 v50, 0
    v_mov_b32 v51, 0
    v_mov_b32 v52, 0
    v_mov_b32 v53, 0
    v_mov_b32 v54, 0
    v_mov_b32 v55, 0
l4_kernel_loop_54:
    s_waitcnt lgkmcnt(0)
    s_barrier
    ds_read_b128 v[32:35], v56 offset:0
    ds_read_b64_tr_b16 v[40:41], v72 offset:0
    ds_read_b64_tr_b16 v[42:43], v72 offset:1024
    ds_read_b64_tr_b16 v[44:45], v73 offset:0
    ds_read_b64_tr_b16 v[46:47], v73 offset:1024
    v_mfma_f32_32x32x16_bf16 v[0:15], v[48:51], v[36:39], v[0:15]
    v_mfma_f32_32x32x16_bf16 v[16:31], v[52:55], v[36:39], v[16:31]
    ds_read_b128 v[36:39], v57 offset:0
    ds_read_b64_tr_b16 v[48:49], v72 offset:4096
    ds_read_b64_tr_b16 v[50:51], v72 offset:5120
    ds_read_b64_tr_b16 v[52:53], v73 offset:4096
    ds_read_b64_tr_b16 v[54:55], v73 offset:5120
    s_waitcnt lgkmcnt(5)
    v_mfma_f32_32x32x16_bf16 v[0:15], v[40:43], v[32:35], v[0:15]
    v_mfma_f32_32x32x16_bf16 v[16:31], v[44:47], v[32:35], v[16:31]
    ds_read_b128 v[32:35], v58 offset:0
    ds_read_b64_tr_b16 v[40:41], v72 offset:8192
    ds_read_b64_tr_b16 v[42:43], v72 offset:9216
    ds_read_b64_tr_b16 v[44:45], v73 offset:8192
    ds_read_b64_tr_b16 v[46:47], v73 offset:9216
    s_waitcnt lgkmcnt(5)
    v_mfma_f32_32x32x16_bf16 v[0:15], v[48:51], v[36:39], v[0:15]
    v_mfma_f32_32x32x16_bf16 v[16:31], v[52:55], v[36:39], v[16:31]
    ds_read_b128 v[36:39], v59 offset:0
    ds_read_b64_tr_b16 v[48:49], v72 offset:12288
    ds_read_b64_tr_b16 v[50:51], v72 offset:13312
    ds_read_b64_tr_b16 v[52:53], v73 offset:12288
    ds_read_b64_tr_b16 v[54:55], v73 offset:13312
    s_waitcnt lgkmcnt(5)
    v_mfma_f32_32x32x16_bf16 v[0:15], v[40:43], v[32:35], v[0:15]
    v_mfma_f32_32x32x16_bf16 v[16:31], v[44:47], v[32:35], v[16:31]
    s_sub_u32 s33, s33, 1
    s_cmp_eq_u32 s33, 0
    s_cbranch_scc1 l4_kernel_exit_55
    s_waitcnt lgkmcnt(0)
    s_barrier
    ds_read_b128 v[32:35], v60 offset:0
    ds_read_b64_tr_b16 v[40:41], v74 offset:0
    ds_read_b64_tr_b16 v[42:43], v74 offset:1024
    ds_read_b64_tr_b16 v[44:45], v75 offset:0
    ds_read_b64_tr_b16 v[46:47], v75 offset:1024
    v_mfma_f32_32x32x16_bf16 v[0:15], v[48:51], v[36:39], v[0:15]
    v_mfma_f32_32x32x16_bf16 v[16:31], v[52:55], v[36:39], v[16:31]
    ds_read_b128 v[36:39], v61 offset:0
    ds_read_b64_tr_b16 v[48:49], v74 offset:4096
    ds_read_b64_tr_b16 v[50:51], v74 offset:5120
    ds_read_b64_tr_b16 v[52:53], v75 offset:4096
    ds_read_b64_tr_b16 v[54:55], v75 offset:5120
    s_waitcnt lgkmcnt(5)
    v_mfma_f32_32x32x16_bf16 v[0:15], v[40:43], v[32:35], v[0:15]
    v_mfma_f32_32x32x16_bf16 v[16:31], v[44:47], v[32:35], v[16:31]
    ds_read_b128 v[32:35], v62 offset:0
    ds_read_b64_tr_b16 v[40:41], v74 offset:8192
    ds_read_b64_tr_b16 v[42:43], v74 offset:9216
    ds_read_b64_tr_b16 v[44:45], v75 offset:8192
    ds_read_b64_tr_b16 v[46:47], v75 offset:9216
    s_waitcnt lgkmcnt(5)
    v_mfma_f32_32x32x16_bf16 v[0:15], v[48:51], v[36:39], v[0:15]
    v_mfma_f32_32x32x16_bf16 v[16:31], v[52:55], v[36:39], v[16:31]
    ds_read_b128 v[36:39], v63 offset:0
    ds_read_b64_tr_b16 v[48:49], v74 offset:12288
    ds_read_b64_tr_b16 v[50:51], v74 offset:13312
    ds_read_b64_tr_b16 v[52:53], v75 offset:12288
    ds_read_b64_tr_b16 v[54:55], v75 offset:13312
    s_waitcnt lgkmcnt(5)
    v_mfma_f32_32x32x16_bf16 v[0:15], v[40:43], v[32:35], v[0:15]
    v_mfma_f32_32x32x16_bf16 v[16:31], v[44:47], v[32:35], v[16:31]
    s_sub_u32 s33, s33, 1
    s_cmp_eq_u32 s33, 0
    s_cbranch_scc1 l4_kernel_exit_55
    s_waitcnt lgkmcnt(0)
    s_barrier
    ds_read_b128 v[32:35], v64 offset:0
    ds_read_b64_tr_b16 v[40:41], v76 offset:0
    ds_read_b64_tr_b16 v[42:43], v76 offset:1024
    ds_read_b64_tr_b16 v[44:45], v77 offset:0
    ds_read_b64_tr_b16 v[46:47], v77 offset:1024
    v_mfma_f32_32x32x16_bf16 v[0:15], v[48:51], v[36:39], v[0:15]
    v_mfma_f32_32x32x16_bf16 v[16:31], v[52:55], v[36:39], v[16:31]
    ds_read_b128 v[36:39], v65 offset:0
    ds_read_b64_tr_b16 v[48:49], v76 offset:4096
    ds_read_b64_tr_b16 v[50:51], v76 offset:5120
    ds_read_b64_tr_b16 v[52:53], v77 offset:4096
    ds_read_b64_tr_b16 v[54:55], v77 offset:5120
    s_waitcnt lgkmcnt(5)
    v_mfma_f32_32x32x16_bf16 v[0:15], v[40:43], v[32:35], v[0:15]
    v_mfma_f32_32x32x16_bf16 v[16:31], v[44:47], v[32:35], v[16:31]
    ds_read_b128 v[32:35], v66 offset:0
    ds_read_b64_tr_b16 v[40:41], v76 offset:8192
    ds_read_b64_tr_b16 v[42:43], v76 offset:9216
    ds_read_b64_tr_b16 v[44:45], v77 offset:8192
    ds_read_b64_tr_b16 v[46:47], v77 offset:9216
    s_waitcnt lgkmcnt(5)
    v_mfma_f32_32x32x16_bf16 v[0:15], v[48:51], v[36:39], v[0:15]
    v_mfma_f32_32x32x16_bf16 v[16:31], v[52:55], v[36:39], v[16:31]
    ds_read_b128 v[36:39], v67 offset:0
    ds_read_b64_tr_b16 v[48:49], v76 offset:12288
    ds_read_b64_tr_b16 v[50:51], v76 offset:13312
    ds_read_b64_tr_b16 v[52:53], v77 offset:12288
    ds_read_b64_tr_b16 v[54:55], v77 offset:13312
    s_waitcnt lgkmcnt(5)
    v_mfma_f32_32x32x16_bf16 v[0:15], v[40:43], v[32:35], v[0:15]
    v_mfma_f32_32x32x16_bf16 v[16:31], v[44:47], v[32:35], v[16:31]
    s_sub_u32 s33, s33, 1
    s_cmp_eq_u32 s33, 0
    s_cbranch_scc1 l4_kernel_exit_55
    s_waitcnt lgkmcnt(0)
    s_barrier
    ds_read_b128 v[32:35], v68 offset:0
    ds_read_b64_tr_b16 v[40:41], v78 offset:0
    ds_read_b64_tr_b16 v[42:43], v78 offset:1024
    ds_read_b64_tr_b16 v[44:45], v79 offset:0
    ds_read_b64_tr_b16 v[46:47], v79 offset:1024
    v_mfma_f32_32x32x16_bf16 v[0:15], v[48:51], v[36:39], v[0:15]
    v_mfma_f32_32x32x16_bf16 v[16:31], v[52:55], v[36:39], v[16:31]
    ds_read_b128 v[36:39], v69 offset:0
    ds_read_b64_tr_b16 v[48:49], v78 offset:4096
    ds_read_b64_tr_b16 v[50:51], v78 offset:5120
    ds_read_b64_tr_b16 v[52:53], v79 offset:4096
    ds_read_b64_tr_b16 v[54:55], v79 offset:5120
    s_waitcnt lgkmcnt(5)
    v_mfma_f32_32x32x16_bf16 v[0:15], v[40:43], v[32:35], v[0:15]
    v_mfma_f32_32x32x16_bf16 v[16:31], v[44:47], v[32:35], v[16:31]
    ds_read_b128 v[32:35], v70 offset:0
    ds_read_b64_tr_b16 v[40:41], v78 offset:8192
    ds_read_b64_tr_b16 v[42:43], v78 offset:9216
    ds_read_b64_tr_b16 v[44:45], v79 offset:8192
    ds_read_b64_tr_b16 v[46:47], v79 offset:9216
    s_waitcnt lgkmcnt(5)
    v_mfma_f32_32x32x16_bf16 v[0:15], v[48:51], v[36:39], v[0:15]
    v_mfma_f32_32x32x16_bf16 v[16:31], v[52:55], v[36:39], v[16:31]
    ds_read_b128 v[36:39], v71 offset:0
    ds_read_b64_tr_b16 v[48:49], v78 offset:12288
    ds_read_b64_tr_b16 v[50:51], v78 offset:13312
    ds_read_b64_tr_b16 v[52:53], v79 offset:12288
    ds_read_b64_tr_b16 v[54:55], v79 offset:13312
    s_waitcnt lgkmcnt(5)
    v_mfma_f32_32x32x16_bf16 v[0:15], v[40:43], v[32:35], v[0:15]
    v_mfma_f32_32x32x16_bf16 v[16:31], v[44:47], v[32:35], v[16:31]
    s_sub_u32 s33, s33, 1
    s_cmp_eq_u32 s33, 0
    s_cbranch_scc0 l4_kernel_loop_54
l4_kernel_exit_55:
    s_waitcnt lgkmcnt(0)
    v_mfma_f32_32x32x16_bf16 v[0:15], v[48:51], v[36:39], v[0:15]
    v_mfma_f32_32x32x16_bf16 v[16:31], v[52:55], v[36:39], v[16:31]
    v_mov_b32 v84, 0
    v_mov_b32 v85, 0
    v_mov_b32 v86, 0
    v_mov_b32 v87, 0
    v_mov_b32 v88, 0
    v_mov_b32 v89, 0
    v_mov_b32 v90, 0
    v_mov_b32 v91, 0
    v_mov_b32 v92, 0
    v_mov_b32 v93, 0
    v_mov_b32 v94, 0
    v_mov_b32 v95, 0
    v_mov_b32 v96, 0
    v_mov_b32 v97, 0
    v_mov_b32 v98, 0
    v_mov_b32 v99, 0
l4_kernel_join_37:
    s_add_u32 s20, s40, 22020096
    s_addc_u32 s21, s41, 0
    s_and_b32 s21, s21, 0xffff
    s_mov_b32 s22, 4194304
    s_mov_b32 s23, 0x00020000
    s_add_u32 s44, s40, 48234496
    s_addc_u32 s45, s41, 0
    s_and_b32 s45, s45, 0xffff
    s_mov_b32 s46, 8192
    s_mov_b32 s47, 0x00020000
    s_add_u32 s48, s40, 53477376
    s_addc_u32 s49, s41, 0
    s_and_b32 s49, s49, 0xffff
    s_mov_b32 s50, 9453568
    s_mov_b32 s51, 0x00020000
    v_and_b32 v120, 31, v80
    s_mul_i32 s29, s34, 128
    s_mul_i32 s30, s25, 32
    s_add_u32 s29, s29, s30
    v_add_u32 v120, s29, v120
    v_lshlrev_b32 v120, 2, v120
    buffer_load_dword v116, v120, s[44:47], 0 offen offset:0
    v_and_b32 v124, 31, v80
    v_add_u32 v124, s29, v124
    v_lshlrev_b32 v124, 11, v124
    v_bfe_u32 v125, v80, 5, 1
    v_lshl_add_u32 v124, v125, 3, v124
    s_mul_i32 s30, s35, 128
    s_mul_i32 s36, s26, 64
    s_add_u32 s30, s30, s36
    s_lshl_b32 s30, s30, 1
    v_add_u32 v124, s30, v124
    buffer_load_dwordx2 v[126:127], v124, s[20:23], 0 offen offset:0
    buffer_load_dwordx2 v[128:129], v124, s[20:23], 0 offen offset:16
    buffer_load_dwordx2 v[130:131], v124, s[20:23], 0 offen offset:32
    buffer_load_dwordx2 v[132:133], v124, s[20:23], 0 offen offset:48
    buffer_load_dwordx2 v[134:135], v124, s[20:23], 0 offen offset:64
    buffer_load_dwordx2 v[136:137], v124, s[20:23], 0 offen offset:80
    buffer_load_dwordx2 v[138:139], v124, s[20:23], 0 offen offset:96
    buffer_load_dwordx2 v[140:141], v124, s[20:23], 0 offen offset:112
    s_cmp_lg_u32 s24, 0
    s_cbranch_scc1 l4_kernel_na_56
    v_mov_b32 v121, 1
    v_mov_b32 v122, 0
    s_lshl_b32 s29, s62, 6
    s_mov_b64 s[56:57], exec
    s_mov_b64 exec, 1
    buffer_atomic_add v121, v122, s[48:51], s29 offen sc0 sc1
    s_waitcnt vmcnt(0)
    v_mov_b32 v122, 131072
    ds_write_b32 v122, v121 offset:0
    s_mov_b64 exec, s[56:57]
l4_kernel_na_56:
    s_waitcnt vmcnt(0)
    v_sub_f32 v118, 1.0, v116
    v_cvt_pk_bf16_f32 v123, v118, v118
    v_lshlrev_b32 v118, 16, v123
    v_lshlrev_b32 v120, 16, v84
    v_and_b32 v121, 0xffff0000, v84
    v_mul_f32 v0, v0, v118
    v_mul_f32 v1, v1, v118
    v_fmac_f32 v0, v120, v116
    v_fmac_f32 v1, v121, v116
    v_lshlrev_b32 v120, 16, v85
    v_and_b32 v121, 0xffff0000, v85
    v_mul_f32 v2, v2, v118
    v_mul_f32 v3, v3, v118
    v_fmac_f32 v2, v120, v116
    v_fmac_f32 v3, v121, v116
    v_lshlrev_b32 v120, 16, v86
    v_and_b32 v121, 0xffff0000, v86
    v_mul_f32 v4, v4, v118
    v_mul_f32 v5, v5, v118
    v_fmac_f32 v4, v120, v116
    v_fmac_f32 v5, v121, v116
    v_lshlrev_b32 v120, 16, v87
    v_and_b32 v121, 0xffff0000, v87
    v_mul_f32 v6, v6, v118
    v_mul_f32 v7, v7, v118
    v_fmac_f32 v6, v120, v116
    v_fmac_f32 v7, v121, v116
    v_lshlrev_b32 v120, 16, v88
    v_and_b32 v121, 0xffff0000, v88
    v_mul_f32 v8, v8, v118
    v_mul_f32 v9, v9, v118
    v_fmac_f32 v8, v120, v116
    v_fmac_f32 v9, v121, v116
    v_lshlrev_b32 v120, 16, v89
    v_and_b32 v121, 0xffff0000, v89
    v_mul_f32 v10, v10, v118
    v_mul_f32 v11, v11, v118
    v_fmac_f32 v10, v120, v116
    v_fmac_f32 v11, v121, v116
    v_lshlrev_b32 v120, 16, v90
    v_and_b32 v121, 0xffff0000, v90
    v_mul_f32 v12, v12, v118
    v_mul_f32 v13, v13, v118
    v_fmac_f32 v12, v120, v116
    v_fmac_f32 v13, v121, v116
    v_lshlrev_b32 v120, 16, v91
    v_and_b32 v121, 0xffff0000, v91
    v_mul_f32 v14, v14, v118
    v_mul_f32 v15, v15, v118
    v_fmac_f32 v14, v120, v116
    v_fmac_f32 v15, v121, v116
    v_lshlrev_b32 v120, 16, v92
    v_and_b32 v121, 0xffff0000, v92
    v_mul_f32 v16, v16, v118
    v_mul_f32 v17, v17, v118
    v_fmac_f32 v16, v120, v116
    v_fmac_f32 v17, v121, v116
    v_lshlrev_b32 v120, 16, v93
    v_and_b32 v121, 0xffff0000, v93
    v_mul_f32 v18, v18, v118
    v_mul_f32 v19, v19, v118
    v_fmac_f32 v18, v120, v116
    v_fmac_f32 v19, v121, v116
    v_lshlrev_b32 v120, 16, v94
    v_and_b32 v121, 0xffff0000, v94
    v_mul_f32 v20, v20, v118
    v_mul_f32 v21, v21, v118
    v_fmac_f32 v20, v120, v116
    v_fmac_f32 v21, v121, v116
    v_lshlrev_b32 v120, 16, v95
    v_and_b32 v121, 0xffff0000, v95
    v_mul_f32 v22, v22, v118
    v_mul_f32 v23, v23, v118
    v_fmac_f32 v22, v120, v116
    v_fmac_f32 v23, v121, v116
    v_lshlrev_b32 v120, 16, v96
    v_and_b32 v121, 0xffff0000, v96
    v_mul_f32 v24, v24, v118
    v_mul_f32 v25, v25, v118
    v_fmac_f32 v24, v120, v116
    v_fmac_f32 v25, v121, v116
    v_lshlrev_b32 v120, 16, v97
    v_and_b32 v121, 0xffff0000, v97
    v_mul_f32 v26, v26, v118
    v_mul_f32 v27, v27, v118
    v_fmac_f32 v26, v120, v116
    v_fmac_f32 v27, v121, v116
    v_lshlrev_b32 v120, 16, v98
    v_and_b32 v121, 0xffff0000, v98
    v_mul_f32 v28, v28, v118
    v_mul_f32 v29, v29, v118
    v_fmac_f32 v28, v120, v116
    v_fmac_f32 v29, v121, v116
    v_lshlrev_b32 v120, 16, v99
    v_and_b32 v121, 0xffff0000, v99
    v_mul_f32 v30, v30, v118
    v_mul_f32 v31, v31, v118
    v_fmac_f32 v30, v120, v116
    v_fmac_f32 v31, v121, v116
    s_waitcnt lgkmcnt(0)
    s_barrier
    v_mov_b32 v120, 131072
    ds_read_b32 v121, v120 offset:0
    s_waitcnt lgkmcnt(0)
    v_readfirstlane_b32 s36, v121
    v_and_b32 v122, 63, v80
    v_lshlrev_b32 v122, 4, v122
    s_lshl_b32 s29, s62, 16
    s_mul_i32 s30, s24, 8192
    s_add_u32 s29, s29, s30
    s_add_u32 s29, s29, 1048576
    s_cmp_lg_u32 s36, 0
    s_cbranch_scc1 l4_kernel_sec_58
    buffer_store_dwordx4 v[0:3], v122, s[48:51], s29 offen offset:0 sc0 sc1
    buffer_store_dwordx4 v[4:7], v122, s[48:51], s29 offen offset:1024 sc0 sc1
    buffer_store_dwordx4 v[8:11], v122, s[48:51], s29 offen offset:2048 sc0 sc1
    buffer_store_dwordx4 v[12:15], v122, s[48:51], s29 offen offset:3072 sc0 sc1
    s_add_u32 s29, s29, 4096
    buffer_store_dwordx4 v[16:19], v122, s[48:51], s29 offen offset:0 sc0 sc1
    buffer_store_dwordx4 v[20:23], v122, s[48:51], s29 offen offset:1024 sc0 sc1
    buffer_store_dwordx4 v[24:27], v122, s[48:51], s29 offen offset:2048 sc0 sc1
    buffer_store_dwordx4 v[28:31], v122, s[48:51], s29 offen offset:3072 sc0 sc1
    s_waitcnt vmcnt(0)
    s_barrier
    s_cmp_lg_u32 s24, 0
    s_cbranch_scc1 l4_kernel_end_1
    v_mov_b32 v121, 1
    v_mov_b32 v120, 0
    s_lshl_b32 s29, s62, 6
    s_add_u32 s29, s29, 8192
    s_mov_b64 exec, 1
    buffer_atomic_add v121, v120, s[48:51], s29 offen sc1
    s_endpgm
l4_kernel_sec_58:
    s_lshl_b32 s30, s62, 6
    s_add_u32 s30, s30, 8192
    v_mov_b32 v120, 0
l4_kernel_spin_59:
    buffer_load_dword v121, v120, s[48:51], s30 offen sc0 sc1
    s_waitcnt vmcnt(0)
    v_readfirstlane_b32 s36, v121
    s_nop 0
    s_cmp_lg_u32 s36, 0
    s_cbranch_scc1 l4_kernel_go_60
    s_sleep 4
    s_branch l4_kernel_spin_59
l4_kernel_go_60:
    buffer_load_dwordx4 v[84:87], v122, s[48:51], s29 offen offset:0 sc0 sc1
    buffer_load_dwordx4 v[88:91], v122, s[48:51], s29 offen offset:1024 sc0 sc1
    buffer_load_dwordx4 v[92:95], v122, s[48:51], s29 offen offset:2048 sc0 sc1
    buffer_load_dwordx4 v[96:99], v122, s[48:51], s29 offen offset:3072 sc0 sc1
    s_add_u32 s29, s29, 4096
    buffer_load_dwordx4 v[100:103], v122, s[48:51], s29 offen offset:0 sc0 sc1
    buffer_load_dwordx4 v[104:107], v122, s[48:51], s29 offen offset:1024 sc0 sc1
    buffer_load_dwordx4 v[108:111], v122, s[48:51], s29 offen offset:2048 sc0 sc1
    buffer_load_dwordx4 v[112:115], v122, s[48:51], s29 offen offset:3072 sc0 sc1
    s_waitcnt vmcnt(7)
    v_add_f32 v0, v0, v84
    v_add_f32 v1, v1, v85
    v_add_f32 v2, v2, v86
    v_add_f32 v3, v3, v87
    s_waitcnt vmcnt(6)
    v_add_f32 v4, v4, v88
    v_add_f32 v5, v5, v89
    v_add_f32 v6, v6, v90
    v_add_f32 v7, v7, v91
    s_waitcnt vmcnt(5)
    v_add_f32 v8, v8, v92
    v_add_f32 v9, v9, v93
    v_add_f32 v10, v10, v94
    v_add_f32 v11, v11, v95
    s_waitcnt vmcnt(4)
    v_add_f32 v12, v12, v96
    v_add_f32 v13, v13, v97
    v_add_f32 v14, v14, v98
    v_add_f32 v15, v15, v99
    s_waitcnt vmcnt(3)
    v_add_f32 v16, v16, v100
    v_add_f32 v17, v17, v101
    v_add_f32 v18, v18, v102
    v_add_f32 v19, v19, v103
    s_waitcnt vmcnt(2)
    v_add_f32 v20, v20, v104
    v_add_f32 v21, v21, v105
    v_add_f32 v22, v22, v106
    v_add_f32 v23, v23, v107
    s_waitcnt vmcnt(1)
    v_add_f32 v24, v24, v108
    v_add_f32 v25, v25, v109
    v_add_f32 v26, v26, v110
    v_add_f32 v27, v27, v111
    s_waitcnt vmcnt(0)
    v_add_f32 v28, v28, v112
    v_add_f32 v29, v29, v113
    v_add_f32 v30, v30, v114
    v_add_f32 v31, v31, v115
l4_kernel_fin_57:
    s_barrier
    v_and_b32 v32, 63, v80
    v_and_b32 v33, 31, v32
    v_lshrrev_b32 v34, 5, v32
    s_mul_i32 s36, s24, 4096
    v_lshlrev_b32 v36, 7, v33
    v_add_u32 v36, s36, v36
    v_and_b32 v37, 7, v33
    v_lshrrev_b32 v38, 3, v32
    v_and_b32 v39, 7, v32
    v_lshlrev_b32 v48, 7, v38
    v_lshl_add_u32 v48, v39, 4, v48
    v_add_u32 v48, s36, v48
    s_mul_i32 s29, s34, 128
    s_mul_i32 s30, s25, 32
    s_add_u32 s29, s29, s30
    s_mov_b32 s53, s29
    v_add_u32 v35, s29, v38
    s_mov_b32 s30, 2048
    v_mul_lo_u32 v35, v35, s30
    v_xor_b32 v39, v39, v38
    v_lshlrev_b32 v39, 4, v39
    s_mul_i32 s54, s35, 128
    s_mul_i32 s30, s26, 64
    s_add_u32 s54, s54, s30
    s_lshl_b32 s29, s54, 1
    v_add3_u32 v35, v35, v39, s29
    v_add_u32 v49, 0, v34
    v_xor_b32 v49, v49, v37
    v_lshl_add_u32 v49, v49, 4, v36
    v_add_u32 v50, 2, v34
    v_xor_b32 v50, v50, v37
    v_lshl_add_u32 v50, v50, 4, v36
    v_add_u32 v51, 4, v34
    v_xor_b32 v51, v51, v37
    v_lshl_add_u32 v51, v51, 4, v36
    v_add_u32 v52, 6, v34
    v_xor_b32 v52, v52, v37
    v_lshl_add_u32 v52, v52, 4, v36
    v_lshlrev_b32 v84, 16, v126
    v_fmac_f32 v0, v84, v118
    v_and_b32 v84, 0xffff0000, v126
    v_fmac_f32 v1, v84, v118
    v_lshlrev_b32 v84, 16, v127
    v_fmac_f32 v2, v84, v118
    v_and_b32 v84, 0xffff0000, v127
    v_fmac_f32 v3, v84, v118
    v_lshlrev_b32 v84, 16, v128
    v_fmac_f32 v4, v84, v118
    v_and_b32 v84, 0xffff0000, v128
    v_fmac_f32 v5, v84, v118
    v_lshlrev_b32 v84, 16, v129
    v_fmac_f32 v6, v84, v118
    v_and_b32 v84, 0xffff0000, v129
    v_fmac_f32 v7, v84, v118
    v_lshlrev_b32 v84, 16, v130
    v_fmac_f32 v8, v84, v118
    v_and_b32 v84, 0xffff0000, v130
    v_fmac_f32 v9, v84, v118
    v_lshlrev_b32 v84, 16, v131
    v_fmac_f32 v10, v84, v118
    v_and_b32 v84, 0xffff0000, v131
    v_fmac_f32 v11, v84, v118
    v_lshlrev_b32 v84, 16, v132
    v_fmac_f32 v12, v84, v118
    v_and_b32 v84, 0xffff0000, v132
    v_fmac_f32 v13, v84, v118
    v_lshlrev_b32 v84, 16, v133
    v_fmac_f32 v14, v84, v118
    v_and_b32 v84, 0xffff0000, v133
    v_fmac_f32 v15, v84, v118
    v_cvt_pk_bf16_f32 v40, v0, v1
    v_cvt_pk_bf16_f32 v41, v2, v3
    v_cvt_pk_bf16_f32 v42, v4, v5
    v_cvt_pk_bf16_f32 v43, v6, v7
    v_cvt_pk_bf16_f32 v44, v8, v9
    v_cvt_pk_bf16_f32 v45, v10, v11
    v_cvt_pk_bf16_f32 v46, v12, v13
    v_cvt_pk_bf16_f32 v47, v14, v15
    v_permlane32_swap_b32 v40, v42
    v_permlane32_swap_b32 v41, v43
    v_permlane32_swap_b32 v44, v46
    v_permlane32_swap_b32 v45, v47
    ds_write_b128 v49, v[40:43] offset:0
    ds_write_b128 v50, v[44:47] offset:0
    v_lshlrev_b32 v84, 16, v134
    v_fmac_f32 v16, v84, v118
    v_and_b32 v84, 0xffff0000, v134
    v_fmac_f32 v17, v84, v118
    v_lshlrev_b32 v84, 16, v135
    v_fmac_f32 v18, v84, v118
    v_and_b32 v84, 0xffff0000, v135
    v_fmac_f32 v19, v84, v118
    v_lshlrev_b32 v84, 16, v136
    v_fmac_f32 v20, v84, v118
    v_and_b32 v84, 0xffff0000, v136
    v_fmac_f32 v21, v84, v118
    v_lshlrev_b32 v84, 16, v137
    v_fmac_f32 v22, v84, v118
    v_and_b32 v84, 0xffff0000, v137
    v_fmac_f32 v23, v84, v118
    v_lshlrev_b32 v84, 16, v138
    v_fmac_f32 v24, v84, v118
    v_and_b32 v84, 0xffff0000, v138
    v_fmac_f32 v25, v84, v118
    v_lshlrev_b32 v84, 16, v139
    v_fmac_f32 v26, v84, v118
    v_and_b32 v84, 0xffff0000, v139
    v_fmac_f32 v27, v84, v118
    v_lshlrev_b32 v84, 16, v140
    v_fmac_f32 v28, v84, v118
    v_and_b32 v84, 0xffff0000, v140
    v_fmac_f32 v29, v84, v118
    v_lshlrev_b32 v84, 16, v141
    v_fmac_f32 v30, v84, v118
    v_and_b32 v84, 0xffff0000, v141
    v_fmac_f32 v31, v84, v118
    v_cvt_pk_bf16_f32 v40, v16, v17
    v_cvt_pk_bf16_f32 v41, v18, v19
    v_cvt_pk_bf16_f32 v42, v20, v21
    v_cvt_pk_bf16_f32 v43, v22, v23
    v_cvt_pk_bf16_f32 v44, v24, v25
    v_cvt_pk_bf16_f32 v45, v26, v27
    v_cvt_pk_bf16_f32 v46, v28, v29
    v_cvt_pk_bf16_f32 v47, v30, v31
    v_permlane32_swap_b32 v40, v42
    v_permlane32_swap_b32 v41, v43
    v_permlane32_swap_b32 v44, v46
    v_permlane32_swap_b32 v45, v47
    ds_write_b128 v51, v[40:43] offset:0
    ds_write_b128 v52, v[44:47] offset:0
    s_waitcnt lgkmcnt(0)
    ds_read_b128 v[0:3], v48 offset:0
    ds_read_b128 v[4:7], v48 offset:1024
    ds_read_b128 v[8:11], v48 offset:2048
    ds_read_b128 v[12:15], v48 offset:3072
    s_waitcnt lgkmcnt(3)
    buffer_store_dwordx4 v[0:3], v35, s[16:19], 0 offen
    v_add_u32 v35, 16384, v35
    s_waitcnt lgkmcnt(2)
    buffer_store_dwordx4 v[4:7], v35, s[16:19], 0 offen
    v_add_u32 v35, 16384, v35
    s_waitcnt lgkmcnt(1)
    buffer_store_dwordx4 v[8:11], v35, s[16:19], 0 offen
    v_add_u32 v35, 16384, v35
    s_waitcnt lgkmcnt(0)
    buffer_store_dwordx4 v[12:15], v35, s[16:19], 0 offen
l4_kernel_end_1:
    s_endpgm
.section .rodata,"a"
.p2align 6
.amdhsa_kernel l0_kernel
  .amdhsa_next_free_vgpr 64
  .amdhsa_next_free_sgpr 102
  .amdhsa_accum_offset 64
  .amdhsa_group_segment_fixed_size 0
  .amdhsa_kernarg_size 104
  .amdhsa_user_sgpr_count 2
  .amdhsa_user_sgpr_kernarg_segment_ptr 1
  .amdhsa_system_sgpr_workgroup_id_x 1
.end_amdhsa_kernel
.section .rodata,"a"
.p2align 6
.amdhsa_kernel l1_kernel
  .amdhsa_next_free_vgpr 168
  .amdhsa_next_free_sgpr 102
  .amdhsa_accum_offset 168
  .amdhsa_group_segment_fixed_size 0
  .amdhsa_kernarg_size 104
  .amdhsa_user_sgpr_count 2
  .amdhsa_user_sgpr_kernarg_segment_ptr 1
  .amdhsa_system_sgpr_workgroup_id_x 1
.end_amdhsa_kernel
.section .rodata,"a"
.p2align 6
.amdhsa_kernel l2_kernel
  .amdhsa_next_free_vgpr 168
  .amdhsa_next_free_sgpr 102
  .amdhsa_accum_offset 168
  .amdhsa_group_segment_fixed_size 0
  .amdhsa_kernarg_size 104
  .amdhsa_user_sgpr_count 2
  .amdhsa_user_sgpr_kernarg_segment_ptr 1
  .amdhsa_system_sgpr_workgroup_id_x 1
.end_amdhsa_kernel
.section .rodata,"a"
.p2align 6
.amdhsa_kernel l3_kernel
  .amdhsa_next_free_vgpr 168
  .amdhsa_next_free_sgpr 102
  .amdhsa_accum_offset 168
  .amdhsa_group_segment_fixed_size 0
  .amdhsa_kernarg_size 104
  .amdhsa_user_sgpr_count 2
  .amdhsa_user_sgpr_kernarg_segment_ptr 1
  .amdhsa_system_sgpr_workgroup_id_x 1
.end_amdhsa_kernel
.section .rodata,"a"
.p2align 6
.amdhsa_kernel l4_kernel
  .amdhsa_next_free_vgpr 168
  .amdhsa_next_free_sgpr 102
  .amdhsa_accum_offset 168
  .amdhsa_group_segment_fixed_size 0
  .amdhsa_kernarg_size 104
  .amdhsa_user_sgpr_count 2
  .amdhsa_user_sgpr_kernarg_segment_ptr 1
  .amdhsa_system_sgpr_workgroup_id_x 1
.end_amdhsa_kernel
```
